```python
import torch

def _softmax(x, axis=-1):
    return torch.softmax(x, dim=axis)

def _gelu(x):
    return torch.nn.functional.gelu(x, approximate='tanh')

def _silu(x):
    return torch.nn.functional.silu(x)

def _sigmoid(x):
    return torch.sigmoid(x)

def _layernorm(x, axis=-1, eps=1e-05):
    m = x.mean(dim=axis, keepdim=True)
    v = x.var(dim=axis, keepdim=True, unbiased=False)
    return (x - m) / torch.sqrt(v + eps)

def _scatter_add(tgt, idx, src, axis=0):
    return tgt.clone().index_add_(axis, idx, src)

def _segment_sum(src, seg, n):
    out = torch.zeros((n,) + src.shape[1:], dtype=src.dtype)
    return out.index_add_(0, seg, src)

def _pad(x, pw):
    flat = tuple((v for pair in reversed(pw) for v in pair))
    return torch.nn.functional.pad(x, flat)
kernel_name = 'gated_mix__spectral_fnet__mixer_gmlp__prompt'

def setup_inputs():

    _w = lambda a: (lambda t: t.to(torch.bfloat16) if t.is_floating_point() else t)(torch.as_tensor(a))

    def _A_setup():
        B, S, D = (1, 2048, 1024)
        ns = torch.arange(S)[:, None] * torch.arange(S)[None, :]
        nd = torch.arange(D)[:, None] * torch.arange(D)[None, :]
        Ws_re = torch.cos(-2.0 * torch.pi * ns / S).to(float)
        Ws_im = torch.sin(-2.0 * torch.pi * ns / S).to(float)
        Wd_re = torch.cos(-2.0 * torch.pi * nd / D).to(float)
        Wd_im = torch.sin(-2.0 * torch.pi * nd / D).to(float)
        return {'x': _w((lambda *s: torch.randn(*s, dtype=torch.bfloat16) * 0.05)(B, S, D)), 'dft_seq_re': _w(Ws_re), 'dft_seq_im': _w(Ws_im), 'dft_hid_re': _w(Wd_re), 'dft_hid_im': _w(Wd_im)}
    _A_in = _A_setup()

    def _B_setup():
        B, S, D, F = (1, 2048, 1024, 3584)
        Fh = F // 2
        return {'x': _w((lambda *s: torch.randn(*s, dtype=torch.bfloat16) * 0.05)(B, S, D)), 'w_in': _w((lambda *s: torch.randn(*s, dtype=torch.bfloat16) * 0.8)(D, 2 * Fh)), 'w_sp': _w(0.01 * (lambda *s: torch.randn(*s, dtype=torch.bfloat16) * 0.8)(S, S)), 'b_sp': _w(1.0 + 0.01 * (lambda *s: torch.randn(*s, dtype=torch.bfloat16) * 0.8)(S)), 'w_out': _w((lambda *s: torch.randn(*s, dtype=torch.bfloat16) * 0.8)(Fh, D))}
    _B_in = _B_setup()
    return {'A_x': _A_in['x'], 'A_dft_seq_re': _A_in['dft_seq_re'], 'A_dft_seq_im': _A_in['dft_seq_im'], 'A_dft_hid_re': _A_in['dft_hid_re'], 'A_dft_hid_im': _A_in['dft_hid_im'], 'B_x': _B_in['x'], 'B_w_in': _B_in['w_in'], 'B_w_sp': _B_in['w_sp'], 'B_b_sp': _B_in['b_sp'], 'B_w_out': _B_in['w_out'], 'gate_w': _w((lambda *s: torch.randn(*s, dtype=torch.bfloat16) * 0.05)(1024) * 16.0)}

def reference(A_x, A_dft_seq_re, A_dft_seq_im, A_dft_hid_re, A_dft_hid_im, B_x, B_w_in, B_w_sp, B_b_sp, B_w_out, gate_w):

    def _A_ref(x, dft_seq_re, dft_seq_im, dft_hid_re, dft_hid_im):
        a = torch.einsum('bsd,ed->bse', x, dft_hid_re)
        b = torch.einsum('bsd,ed->bse', x, dft_hid_im)
        y = torch.einsum('ts,bse->bte', dft_seq_re, a) - torch.einsum('ts,bse->bte', dft_seq_im, b)
        return y

    def _B_ref(x, w_in, w_sp, b_sp, w_out):
        B, S, D = x.shape
        F = w_in.shape[-1]
        Fh = F // 2
        z = _gelu(torch.einsum('bsd,df->bsf', x, w_in))
        z1 = z[..., :Fh].clone()
        z2 = _layernorm(z[..., Fh:], axis=-1)
        g = torch.einsum('ts,bsf->btf', w_sp, z2) + b_sp[None, :, None]
        return torch.einsum('bsf,fd->bsd', z1 * g, w_out)
    x = A_x
    g = _sigmoid((x * gate_w).sum(-1, keepdims=True))
    a = _A_ref(x, A_dft_seq_re, A_dft_seq_im, A_dft_hid_re, A_dft_hid_im)
    b = _B_ref(x, B_w_in, B_w_sp, B_b_sp, B_w_out)
    return g * a + (1 - g) * b
```

```asm
; @launch grid=(256,1,1) block=(512,1,1) lds=163840
.amdgcn_target "amdgcn-amd-amdhsa--gfx950"
.text
.globl gated_mix__spectral_fnet__mixer_gmlp__prompt_kernel
.p2align 8
.type gated_mix__spectral_fnet__mixer_gmlp__prompt_kernel,@function
gated_mix__spectral_fnet__mixer_gmlp__prompt_kernel:

    s_cmp_ge_u32 s2, 256
    s_cbranch_scc1 L_end
    s_load_dwordx2 s[8:9], s[0:1], 0
    s_load_dwordx2 s[12:13], s[0:1], 48
    s_load_dwordx2 s[16:17], s[0:1], 104
    s_load_dwordx2 s[20:21], s[0:1], 56
    s_load_dwordx2 s[24:25], s[0:1], 72
    s_load_dwordx2 s[28:29], s[0:1], 64
    s_load_dwordx2 s[32:33], s[0:1], 88
    s_load_dwordx2 s[36:37], s[0:1], 96
    v_lshrrev_b32 v1, 6, v0
    v_and_b32 v0, 63, v0
    s_and_b32 s53, s2, 7
    v_readfirstlane_b32 s43, v1
    s_lshr_b32 s54, s2, 3
    s_and_b32 s55, s54, 3
    s_lshr_b32 s56, s54, 2
    s_and_b32 s40, s53, 3
    s_lshl_b32 s40, s40, 2
    s_add_u32 s40, s40, s55
    s_lshr_b32 s57, s53, 2
    s_mul_i32 s41, s57, 7
    s_add_u32 s41, s41, s56
    s_mov_b32 s47, s41
    s_add_u32 s42, s55, s56
    s_and_b32 s42, s42, 3
    s_mov_b32 s10, 4194304
    s_mov_b32 s14, 7340032
    s_mov_b32 s18, 33554432
    s_mov_b32 s22, 8388608
    s_mov_b32 s26, 3670016
s_mov_b32 s11, 0x20000
s_mov_b32 s15, 0x20000
s_mov_b32 s19, 0x20000
s_mov_b32 s23, 0x20000
s_mov_b32 s27, 0x20000
s_mov_b32 s31, 0x20000
s_mov_b32 s35, 0x20000
s_mov_b32 s39, 0x20000

    s_xor_b32 s43, s43, 0
    s_cmp_eq_u32 s56, 7
    s_cbranch_scc1 L_fft0
    s_cmp_ge_u32 s43, 4
    s_cbranch_scc0 L_compute
s_branch L_loader
L_compute:

    s_and_b32 s44, s43, 1
    s_lshr_b32 s45, s43, 1
    v_and_b32 v2, 15, v0
    v_lshrrev_b32 v3, 4, v0
    v_lshlrev_b32 v4, 7, v2
    v_lshrrev_b32 v5, 1, v2
    v_xor_b32 v5, v5, v3
    v_lshl_add_u32 v4, v5, 4, v4
    s_lshl_b32 s53, s44, 13
    v_add_u32 v232, s53, v4
    v_xor_b32 v233, 64, v232
    v_lshrrev_b32 v4, 2, v2
    v_and_b32 v5, 3, v0
    v_lshl_add_u32 v6, v3, 3, v4
    v_lshlrev_b32 v6, 8, v6
    v_and_b32 v7, 1, v3
    v_lshl_add_u32 v4, v7, 2, v4
    v_lshlrev_b32 v4, 1, v4
    v_lshrrev_b32 v7, 1, v5
    v_xor_b32 v4, v4, v7
    s_lshl_b32 s53, s45, 3
    v_xor_b32 v4, s53, v4
    v_and_b32 v5, 1, v5
    v_lshl_add_u32 v6, v5, 3, v6
    v_add_u32 v6, 16384, v6
v_xor_b32 v5, 0, v4
v_lshl_add_u32 v234, v5, 4, v6
v_xor_b32 v5, 2, v4
v_lshl_add_u32 v235, v5, 4, v6
v_xor_b32 v5, 4, v4
v_lshl_add_u32 v236, v5, 4, v6
v_xor_b32 v5, 6, v4
v_lshl_add_u32 v237, v5, 4, v6

    s_lshl_b32 s53, s45, 13
    s_add_u32 s53, s53, 16384
    v_lshl_add_u32 v238, v0, 4, s53
    s_mov_b32 s51, 0
v_mov_b64 v[8:9], 0
v_mov_b64 v[10:11], 0
v_mov_b64 v[12:13], 0
v_mov_b64 v[14:15], 0
v_mov_b64 v[16:17], 0
v_mov_b64 v[18:19], 0
v_mov_b64 v[20:21], 0
v_mov_b64 v[22:23], 0
v_mov_b64 v[24:25], 0
v_mov_b64 v[26:27], 0
v_mov_b64 v[28:29], 0
v_mov_b64 v[30:31], 0
v_mov_b64 v[32:33], 0
v_mov_b64 v[34:35], 0
v_mov_b64 v[36:37], 0
v_mov_b64 v[38:39], 0
v_mov_b64 v[40:41], 0
v_mov_b64 v[42:43], 0
v_mov_b64 v[44:45], 0
v_mov_b64 v[46:47], 0
v_mov_b64 v[48:49], 0
v_mov_b64 v[50:51], 0
v_mov_b64 v[52:53], 0
v_mov_b64 v[54:55], 0
v_mov_b64 v[56:57], 0
v_mov_b64 v[58:59], 0
v_mov_b64 v[60:61], 0
v_mov_b64 v[62:63], 0
v_mov_b64 v[64:65], 0
v_mov_b64 v[66:67], 0
v_mov_b64 v[68:69], 0
v_mov_b64 v[70:71], 0
v_mov_b64 v[72:73], 0
v_mov_b64 v[74:75], 0
v_mov_b64 v[76:77], 0
v_mov_b64 v[78:79], 0
v_mov_b64 v[80:81], 0
v_mov_b64 v[82:83], 0
v_mov_b64 v[84:85], 0
v_mov_b64 v[86:87], 0
v_mov_b64 v[88:89], 0
v_mov_b64 v[90:91], 0
v_mov_b64 v[92:93], 0
v_mov_b64 v[94:95], 0
v_mov_b64 v[96:97], 0
v_mov_b64 v[98:99], 0
v_mov_b64 v[100:101], 0
v_mov_b64 v[102:103], 0
v_mov_b64 v[104:105], 0
v_mov_b64 v[106:107], 0
v_mov_b64 v[108:109], 0
v_mov_b64 v[110:111], 0
v_mov_b64 v[112:113], 0
v_mov_b64 v[114:115], 0
v_mov_b64 v[116:117], 0
v_mov_b64 v[118:119], 0
v_mov_b64 v[120:121], 0
v_mov_b64 v[122:123], 0
v_mov_b64 v[124:125], 0
v_mov_b64 v[126:127], 0
v_mov_b64 v[128:129], 0
v_mov_b64 v[130:131], 0
v_mov_b64 v[132:133], 0
v_mov_b64 v[134:135], 0
v_add_u32 v241, s51, v232
v_add_u32 v242, s51, v233
v_add_u32 v243, s51, v234
v_add_u32 v244, s51, v235
v_add_u32 v245, s51, v236
v_add_u32 v246, s51, v237

    v_and_b32 v2, 15, v0
    s_lshl_b32 s53, s40, 1
    s_add_u32 s53, s53, s44
    v_lshl_add_u32 v2, v2, 5, s53

    v_lshlrev_b32 v2, 1, v2
    s_waitcnt lgkmcnt(0)
    s_mov_b32 s30, 4096
    s_mov_b32 s34, 4194304
buffer_load_ushort v247, v2, s[28:31], 0 offen offset:0
buffer_load_ushort v248, v2, s[28:31], 0 offen offset:1024
buffer_load_ushort v249, v2, s[28:31], 0 offen offset:2048
buffer_load_ushort v250, v2, s[28:31], 0 offen offset:3072

    s_mov_b32 s38, 256
    s_or_b32 s53, s2, s43
    s_cmp_eq_u32 s53, 0
    s_cbranch_scc0 L_nonw
    s_memrealtime s[98:99]
    s_waitcnt lgkmcnt(0)
    s_or_b32 s53, s98, 1
    v_mov_b32 v1, s53
    s_mov_b64 exec, 1
    buffer_store_dword v1, off, s[36:39], 0 sc1
    s_mov_b64 exec, -1
L_nonw:
s_setprio 2
s_barrier
ds_read_b128 v[136:139], v241 offset:0
ds_read_b128 v[140:143], v241 offset:2048
ds_read_b128 v[144:147], v241 offset:4096
ds_read_b128 v[148:151], v241 offset:6144
ds_read_b64_tr_b16 v[152:153], v243 offset:0
ds_read_b64_tr_b16 v[154:155], v243 offset:1024
ds_read_b64_tr_b16 v[156:157], v244 offset:0
ds_read_b64_tr_b16 v[158:159], v244 offset:1024
ds_read_b64_tr_b16 v[160:161], v245 offset:0
ds_read_b64_tr_b16 v[162:163], v245 offset:1024
ds_read_b64_tr_b16 v[164:165], v246 offset:0
ds_read_b64_tr_b16 v[166:167], v246 offset:1024
s_mov_b32 s50, 15
.p2align 3
L_s1_1:
s_waitcnt lgkmcnt(6)
v_mfma_f32_16x16x32_bf16 v[8:11], v[136:139], v[152:155], v[8:11]
ds_read_b128 v[168:171], v242 offset:0
s_add_u32 s51, s51, 32768
v_mfma_f32_16x16x32_bf16 v[24:27], v[140:143], v[152:155], v[24:27]
ds_read_b128 v[172:175], v242 offset:2048
s_and_b32 s51, s51, 131071
v_mfma_f32_16x16x32_bf16 v[40:43], v[144:147], v[152:155], v[40:43]
ds_read_b128 v[176:179], v242 offset:4096
v_add_u32 v241, s51, v232
v_mfma_f32_16x16x32_bf16 v[56:59], v[148:151], v[152:155], v[56:59]
ds_read_b128 v[180:183], v242 offset:6144
s_waitcnt lgkmcnt(8)
v_mfma_f32_16x16x32_bf16 v[12:15], v[136:139], v[156:159], v[12:15]
ds_read_b64_tr_b16 v[184:185], v243 offset:8192
v_add_u32 v242, s51, v233
v_mfma_f32_16x16x32_bf16 v[28:31], v[140:143], v[156:159], v[28:31]
ds_read_b64_tr_b16 v[186:187], v243 offset:9216
v_mfma_f32_16x16x32_bf16 v[44:47], v[144:147], v[156:159], v[44:47]
ds_read_b64_tr_b16 v[188:189], v244 offset:8192
v_add_u32 v243, s51, v234
v_mfma_f32_16x16x32_bf16 v[60:63], v[148:151], v[156:159], v[60:63]
ds_read_b64_tr_b16 v[190:191], v244 offset:9216
s_waitcnt lgkmcnt(10)
v_mfma_f32_16x16x32_bf16 v[16:19], v[136:139], v[160:163], v[16:19]
ds_read_b64_tr_b16 v[192:193], v245 offset:8192
v_add_u32 v244, s51, v235
v_mfma_f32_16x16x32_bf16 v[32:35], v[140:143], v[160:163], v[32:35]
ds_read_b64_tr_b16 v[194:195], v245 offset:9216
v_mfma_f32_16x16x32_bf16 v[48:51], v[144:147], v[160:163], v[48:51]
ds_read_b64_tr_b16 v[196:197], v246 offset:8192
v_add_u32 v245, s51, v236
v_mfma_f32_16x16x32_bf16 v[64:67], v[148:151], v[160:163], v[64:67]
ds_read_b64_tr_b16 v[198:199], v246 offset:9216
s_waitcnt lgkmcnt(12)
v_mfma_f32_16x16x32_bf16 v[20:23], v[136:139], v[164:167], v[20:23]
v_add_u32 v246, s51, v237
v_mfma_f32_16x16x32_bf16 v[36:39], v[140:143], v[164:167], v[36:39]
v_mfma_f32_16x16x32_bf16 v[52:55], v[144:147], v[164:167], v[52:55]
v_mfma_f32_16x16x32_bf16 v[68:71], v[148:151], v[164:167], v[68:71]
s_waitcnt lgkmcnt(6)
v_mfma_f32_16x16x32_bf16 v[8:11], v[168:171], v[184:187], v[8:11]
v_mfma_f32_16x16x32_bf16 v[24:27], v[172:175], v[184:187], v[24:27]
v_mfma_f32_16x16x32_bf16 v[40:43], v[176:179], v[184:187], v[40:43]
v_mfma_f32_16x16x32_bf16 v[56:59], v[180:183], v[184:187], v[56:59]
s_waitcnt lgkmcnt(0)
s_barrier
ds_read_b128 v[136:139], v241 offset:0
v_mfma_f32_16x16x32_bf16 v[12:15], v[168:171], v[188:191], v[12:15]
ds_read_b128 v[140:143], v241 offset:2048
v_mfma_f32_16x16x32_bf16 v[28:31], v[172:175], v[188:191], v[28:31]
ds_read_b128 v[144:147], v241 offset:4096
v_mfma_f32_16x16x32_bf16 v[44:47], v[176:179], v[188:191], v[44:47]
ds_read_b128 v[148:151], v241 offset:6144
v_mfma_f32_16x16x32_bf16 v[60:63], v[180:183], v[188:191], v[60:63]
ds_read_b64_tr_b16 v[152:153], v243 offset:0
v_mfma_f32_16x16x32_bf16 v[16:19], v[168:171], v[192:195], v[16:19]
ds_read_b64_tr_b16 v[154:155], v243 offset:1024
v_mfma_f32_16x16x32_bf16 v[32:35], v[172:175], v[192:195], v[32:35]
ds_read_b64_tr_b16 v[156:157], v244 offset:0
v_mfma_f32_16x16x32_bf16 v[48:51], v[176:179], v[192:195], v[48:51]
ds_read_b64_tr_b16 v[158:159], v244 offset:1024
v_mfma_f32_16x16x32_bf16 v[64:67], v[180:183], v[192:195], v[64:67]
ds_read_b64_tr_b16 v[160:161], v245 offset:0
v_mfma_f32_16x16x32_bf16 v[20:23], v[168:171], v[196:199], v[20:23]
ds_read_b64_tr_b16 v[162:163], v245 offset:1024
v_mfma_f32_16x16x32_bf16 v[36:39], v[172:175], v[196:199], v[36:39]
s_sub_u32 s50, s50, 1
ds_read_b64_tr_b16 v[164:165], v246 offset:0
v_mfma_f32_16x16x32_bf16 v[52:55], v[176:179], v[196:199], v[52:55]
s_cmp_lg_u32 s50, 0
ds_read_b64_tr_b16 v[166:167], v246 offset:1024
v_mfma_f32_16x16x32_bf16 v[68:71], v[180:183], v[196:199], v[68:71]
s_cbranch_scc1 L_s1_1
s_waitcnt lgkmcnt(6)
v_mfma_f32_16x16x32_bf16 v[8:11], v[136:139], v[152:155], v[8:11]
ds_read_b128 v[168:171], v242 offset:0
s_add_u32 s51, s51, 32768
v_mfma_f32_16x16x32_bf16 v[24:27], v[140:143], v[152:155], v[24:27]
ds_read_b128 v[172:175], v242 offset:2048
s_and_b32 s51, s51, 131071
v_mfma_f32_16x16x32_bf16 v[40:43], v[144:147], v[152:155], v[40:43]
ds_read_b128 v[176:179], v242 offset:4096
v_mfma_f32_16x16x32_bf16 v[56:59], v[148:151], v[152:155], v[56:59]
ds_read_b128 v[180:183], v242 offset:6144
s_waitcnt lgkmcnt(8)
v_mfma_f32_16x16x32_bf16 v[12:15], v[136:139], v[156:159], v[12:15]
ds_read_b64_tr_b16 v[184:185], v243 offset:8192
v_mfma_f32_16x16x32_bf16 v[28:31], v[140:143], v[156:159], v[28:31]
ds_read_b64_tr_b16 v[186:187], v243 offset:9216
v_mfma_f32_16x16x32_bf16 v[44:47], v[144:147], v[156:159], v[44:47]
ds_read_b64_tr_b16 v[188:189], v244 offset:8192
v_mfma_f32_16x16x32_bf16 v[60:63], v[148:151], v[156:159], v[60:63]
ds_read_b64_tr_b16 v[190:191], v244 offset:9216
s_waitcnt lgkmcnt(10)
v_mfma_f32_16x16x32_bf16 v[16:19], v[136:139], v[160:163], v[16:19]
ds_read_b64_tr_b16 v[192:193], v245 offset:8192
v_mfma_f32_16x16x32_bf16 v[32:35], v[140:143], v[160:163], v[32:35]
ds_read_b64_tr_b16 v[194:195], v245 offset:9216
v_mfma_f32_16x16x32_bf16 v[48:51], v[144:147], v[160:163], v[48:51]
ds_read_b64_tr_b16 v[196:197], v246 offset:8192
v_mfma_f32_16x16x32_bf16 v[64:67], v[148:151], v[160:163], v[64:67]
ds_read_b64_tr_b16 v[198:199], v246 offset:9216
s_waitcnt lgkmcnt(12)
v_mfma_f32_16x16x32_bf16 v[20:23], v[136:139], v[164:167], v[20:23]
v_mfma_f32_16x16x32_bf16 v[36:39], v[140:143], v[164:167], v[36:39]
v_mfma_f32_16x16x32_bf16 v[52:55], v[144:147], v[164:167], v[52:55]
v_mfma_f32_16x16x32_bf16 v[68:71], v[148:151], v[164:167], v[68:71]
s_waitcnt lgkmcnt(6)
v_mfma_f32_16x16x32_bf16 v[8:11], v[168:171], v[184:187], v[8:11]
v_mfma_f32_16x16x32_bf16 v[24:27], v[172:175], v[184:187], v[24:27]
v_mfma_f32_16x16x32_bf16 v[40:43], v[176:179], v[184:187], v[40:43]
v_mfma_f32_16x16x32_bf16 v[56:59], v[180:183], v[184:187], v[56:59]
v_add_u32 v241, s51, v232
v_add_u32 v242, s51, v233
v_add_u32 v243, s51, v234
v_add_u32 v244, s51, v235
v_add_u32 v245, s51, v236
v_add_u32 v246, s51, v237
s_waitcnt lgkmcnt(0)
s_barrier
ds_read_b128 v[136:139], v241 offset:0
v_mfma_f32_16x16x32_bf16 v[12:15], v[168:171], v[188:191], v[12:15]
ds_read_b128 v[140:143], v241 offset:2048
v_mfma_f32_16x16x32_bf16 v[28:31], v[172:175], v[188:191], v[28:31]
ds_read_b128 v[144:147], v241 offset:4096
v_mfma_f32_16x16x32_bf16 v[44:47], v[176:179], v[188:191], v[44:47]
ds_read_b128 v[148:151], v241 offset:6144
v_mfma_f32_16x16x32_bf16 v[60:63], v[180:183], v[188:191], v[60:63]
ds_read_b64_tr_b16 v[152:153], v243 offset:0
v_mfma_f32_16x16x32_bf16 v[16:19], v[168:171], v[192:195], v[16:19]
ds_read_b64_tr_b16 v[154:155], v243 offset:1024
v_mfma_f32_16x16x32_bf16 v[32:35], v[172:175], v[192:195], v[32:35]
ds_read_b64_tr_b16 v[156:157], v244 offset:0
v_mfma_f32_16x16x32_bf16 v[48:51], v[176:179], v[192:195], v[48:51]
ds_read_b64_tr_b16 v[158:159], v244 offset:1024
v_mfma_f32_16x16x32_bf16 v[64:67], v[180:183], v[192:195], v[64:67]
ds_read_b64_tr_b16 v[160:161], v245 offset:0
v_mfma_f32_16x16x32_bf16 v[20:23], v[168:171], v[196:199], v[20:23]
ds_read_b64_tr_b16 v[162:163], v245 offset:1024
v_mfma_f32_16x16x32_bf16 v[36:39], v[172:175], v[196:199], v[36:39]
ds_read_b64_tr_b16 v[164:165], v246 offset:0
v_mfma_f32_16x16x32_bf16 v[52:55], v[176:179], v[196:199], v[52:55]
ds_read_b64_tr_b16 v[166:167], v246 offset:1024
v_mfma_f32_16x16x32_bf16 v[68:71], v[180:183], v[196:199], v[68:71]
s_nop 7

    s_lshl_b32 s53, s44, 14
    s_lshl_b32 s54, s45, 12
    s_add_u32 s53, s53, s54
    s_add_u32 s53, s53, 131072
    v_lshl_add_u32 v1, v0, 4, s53
s_mov_b32 s66, 0xbdd2d3e8
s_mov_b32 s67, 0xbdd2d3e8
s_mov_b32 s4, 1.0
s_mov_b32 s5, 1.0
v_mov_b32 v200, 0xc0135761
v_mov_b32 v201, 0xc0135761
v_pk_mul_f32 v[208:209], v[8:9], v[8:9]
v_pk_mul_f32 v[210:211], v[10:11], v[10:11]
v_pk_mul_f32 v[212:213], v[12:13], v[12:13]
v_pk_mul_f32 v[214:215], v[14:15], v[14:15]
v_pk_fma_f32 v[208:209], v[208:209], s[66:67], v[200:201]
v_pk_fma_f32 v[210:211], v[210:211], s[66:67], v[200:201]
v_pk_fma_f32 v[212:213], v[212:213], s[66:67], v[200:201]
v_pk_fma_f32 v[214:215], v[214:215], s[66:67], v[200:201]
v_pk_mul_f32 v[208:209], v[208:209], v[8:9]
v_pk_mul_f32 v[210:211], v[210:211], v[10:11]
v_pk_mul_f32 v[212:213], v[212:213], v[12:13]
v_pk_mul_f32 v[214:215], v[214:215], v[14:15]
v_exp_f32 v208, v208
v_pk_mul_f32 v[216:217], v[24:25], v[24:25]
v_exp_f32 v209, v209
v_pk_mul_f32 v[218:219], v[26:27], v[26:27]
v_exp_f32 v210, v210
v_pk_mul_f32 v[220:221], v[28:29], v[28:29]
v_exp_f32 v211, v211
v_pk_mul_f32 v[222:223], v[30:31], v[30:31]
v_exp_f32 v212, v212
v_exp_f32 v213, v213
v_exp_f32 v214, v214
v_exp_f32 v215, v215
v_pk_add_f32 v[208:209], v[208:209], s[4:5]
v_pk_add_f32 v[210:211], v[210:211], s[4:5]
v_pk_add_f32 v[212:213], v[212:213], s[4:5]
v_pk_add_f32 v[214:215], v[214:215], s[4:5]
v_rcp_f32 v208, v208
v_pk_fma_f32 v[216:217], v[216:217], s[66:67], v[200:201]
v_rcp_f32 v209, v209
v_pk_fma_f32 v[218:219], v[218:219], s[66:67], v[200:201]
v_rcp_f32 v210, v210
v_pk_fma_f32 v[220:221], v[220:221], s[66:67], v[200:201]
v_rcp_f32 v211, v211
v_pk_fma_f32 v[222:223], v[222:223], s[66:67], v[200:201]
v_rcp_f32 v212, v212
v_pk_mul_f32 v[216:217], v[216:217], v[24:25]
v_rcp_f32 v213, v213
v_pk_mul_f32 v[218:219], v[218:219], v[26:27]
v_rcp_f32 v214, v214
v_pk_mul_f32 v[220:221], v[220:221], v[28:29]
v_rcp_f32 v215, v215
v_pk_mul_f32 v[222:223], v[222:223], v[30:31]
v_exp_f32 v216, v216
v_pk_mul_f32 v[8:9], v[8:9], v[208:209]
v_exp_f32 v217, v217
v_pk_mul_f32 v[10:11], v[10:11], v[210:211]
v_exp_f32 v218, v218
v_pk_mul_f32 v[12:13], v[12:13], v[212:213]
v_exp_f32 v219, v219
v_pk_mul_f32 v[14:15], v[14:15], v[214:215]
v_exp_f32 v220, v220
v_pk_mul_f32 v[208:209], v[40:41], v[40:41]
v_exp_f32 v221, v221
v_pk_mul_f32 v[210:211], v[42:43], v[42:43]
v_exp_f32 v222, v222
v_pk_mul_f32 v[212:213], v[44:45], v[44:45]
v_exp_f32 v223, v223
v_pk_mul_f32 v[214:215], v[46:47], v[46:47]
v_pk_add_f32 v[216:217], v[216:217], s[4:5]
v_pk_add_f32 v[218:219], v[218:219], s[4:5]
v_pk_add_f32 v[220:221], v[220:221], s[4:5]
v_pk_add_f32 v[222:223], v[222:223], s[4:5]
v_rcp_f32 v216, v216
v_pk_fma_f32 v[208:209], v[208:209], s[66:67], v[200:201]
v_rcp_f32 v217, v217
v_pk_fma_f32 v[210:211], v[210:211], s[66:67], v[200:201]
v_rcp_f32 v218, v218
v_pk_fma_f32 v[212:213], v[212:213], s[66:67], v[200:201]
v_rcp_f32 v219, v219
v_pk_fma_f32 v[214:215], v[214:215], s[66:67], v[200:201]
v_rcp_f32 v220, v220
v_pk_mul_f32 v[208:209], v[208:209], v[40:41]
v_rcp_f32 v221, v221
v_pk_mul_f32 v[210:211], v[210:211], v[42:43]
v_rcp_f32 v222, v222
v_pk_mul_f32 v[212:213], v[212:213], v[44:45]
v_rcp_f32 v223, v223
v_pk_mul_f32 v[214:215], v[214:215], v[46:47]
v_exp_f32 v208, v208
v_pk_mul_f32 v[24:25], v[24:25], v[216:217]
v_exp_f32 v209, v209
v_pk_mul_f32 v[26:27], v[26:27], v[218:219]
v_exp_f32 v210, v210
v_pk_mul_f32 v[28:29], v[28:29], v[220:221]
v_exp_f32 v211, v211
v_pk_mul_f32 v[30:31], v[30:31], v[222:223]
v_exp_f32 v212, v212
v_pk_mul_f32 v[216:217], v[56:57], v[56:57]
v_exp_f32 v213, v213
v_pk_mul_f32 v[218:219], v[58:59], v[58:59]
v_exp_f32 v214, v214
v_pk_mul_f32 v[220:221], v[60:61], v[60:61]
v_exp_f32 v215, v215
v_pk_mul_f32 v[222:223], v[62:63], v[62:63]
v_pk_add_f32 v[208:209], v[208:209], s[4:5]
v_pk_add_f32 v[210:211], v[210:211], s[4:5]
v_pk_add_f32 v[212:213], v[212:213], s[4:5]
v_pk_add_f32 v[214:215], v[214:215], s[4:5]
v_rcp_f32 v208, v208
v_pk_fma_f32 v[216:217], v[216:217], s[66:67], v[200:201]
v_rcp_f32 v209, v209
v_pk_fma_f32 v[218:219], v[218:219], s[66:67], v[200:201]
v_rcp_f32 v210, v210
v_pk_fma_f32 v[220:221], v[220:221], s[66:67], v[200:201]
v_rcp_f32 v211, v211
v_pk_fma_f32 v[222:223], v[222:223], s[66:67], v[200:201]
v_rcp_f32 v212, v212
v_pk_mul_f32 v[216:217], v[216:217], v[56:57]
v_rcp_f32 v213, v213
v_pk_mul_f32 v[218:219], v[218:219], v[58:59]
v_rcp_f32 v214, v214
v_pk_mul_f32 v[220:221], v[220:221], v[60:61]
v_rcp_f32 v215, v215
v_pk_mul_f32 v[222:223], v[222:223], v[62:63]
v_exp_f32 v216, v216
v_pk_mul_f32 v[40:41], v[40:41], v[208:209]
v_exp_f32 v217, v217
v_pk_mul_f32 v[42:43], v[42:43], v[210:211]
v_exp_f32 v218, v218
v_pk_mul_f32 v[44:45], v[44:45], v[212:213]
v_exp_f32 v219, v219
v_pk_mul_f32 v[46:47], v[46:47], v[214:215]
v_exp_f32 v220, v220
v_exp_f32 v221, v221
v_exp_f32 v222, v222
v_exp_f32 v223, v223
v_pk_add_f32 v[216:217], v[216:217], s[4:5]
v_pk_add_f32 v[218:219], v[218:219], s[4:5]
v_pk_add_f32 v[220:221], v[220:221], s[4:5]
v_pk_add_f32 v[222:223], v[222:223], s[4:5]
v_rcp_f32 v216, v216
v_rcp_f32 v217, v217
v_rcp_f32 v218, v218
v_rcp_f32 v219, v219
v_rcp_f32 v220, v220
v_rcp_f32 v221, v221
v_rcp_f32 v222, v222
v_rcp_f32 v223, v223
s_nop 0
v_pk_mul_f32 v[56:57], v[56:57], v[216:217]
v_pk_mul_f32 v[58:59], v[58:59], v[218:219]
v_pk_mul_f32 v[60:61], v[60:61], v[220:221]
v_pk_mul_f32 v[62:63], v[62:63], v[222:223]
v_cvt_pk_bf16_f32 v168, v8, v9
v_cvt_pk_bf16_f32 v169, v10, v11
v_cvt_pk_bf16_f32 v170, v24, v25
v_cvt_pk_bf16_f32 v171, v26, v27
ds_write_b128 v1, v[168:171] offset:0
v_cvt_pk_bf16_f32 v172, v40, v41
v_cvt_pk_bf16_f32 v173, v42, v43
v_cvt_pk_bf16_f32 v174, v56, v57
v_cvt_pk_bf16_f32 v175, v58, v59
ds_write_b128 v1, v[172:175] offset:8192
v_cvt_pk_bf16_f32 v176, v12, v13
v_cvt_pk_bf16_f32 v177, v14, v15
v_cvt_pk_bf16_f32 v178, v28, v29
v_cvt_pk_bf16_f32 v179, v30, v31
ds_write_b128 v1, v[176:179] offset:1024
v_cvt_pk_bf16_f32 v180, v44, v45
v_cvt_pk_bf16_f32 v181, v46, v47
v_cvt_pk_bf16_f32 v182, v60, v61
v_cvt_pk_bf16_f32 v183, v62, v63
ds_write_b128 v1, v[180:183] offset:9216
v_cvt_pk_bf16_f32 v184, v16, v17
v_cvt_pk_bf16_f32 v185, v18, v19
v_cvt_pk_bf16_f32 v186, v32, v33
v_cvt_pk_bf16_f32 v187, v34, v35
ds_write_b128 v1, v[184:187] offset:2048
v_cvt_pk_bf16_f32 v188, v48, v49
v_cvt_pk_bf16_f32 v189, v50, v51
v_cvt_pk_bf16_f32 v190, v64, v65
v_cvt_pk_bf16_f32 v191, v66, v67
ds_write_b128 v1, v[188:191] offset:10240
v_cvt_pk_bf16_f32 v192, v20, v21
v_cvt_pk_bf16_f32 v193, v22, v23
v_cvt_pk_bf16_f32 v194, v36, v37
v_cvt_pk_bf16_f32 v195, v38, v39
ds_write_b128 v1, v[192:195] offset:3072
v_cvt_pk_bf16_f32 v196, v52, v53
v_cvt_pk_bf16_f32 v197, v54, v55
v_cvt_pk_bf16_f32 v198, v68, v69
v_cvt_pk_bf16_f32 v199, v70, v71
ds_write_b128 v1, v[196:199] offset:11264
s_waitcnt vmcnt(0)
v_lshlrev_b32 v200, 16, v247
v_lshlrev_b32 v201, 16, v247
v_lshlrev_b32 v202, 16, v248
v_lshlrev_b32 v203, 16, v248
v_lshlrev_b32 v204, 16, v249
v_lshlrev_b32 v205, 16, v249
v_lshlrev_b32 v206, 16, v250
v_lshlrev_b32 v207, 16, v250
s_waitcnt lgkmcnt(0)
s_waitcnt lgkmcnt(6)
v_mfma_f32_16x16x32_bf16 v[72:75], v[152:155], v[136:139], v[72:75]
ds_read_b128 v[168:171], v242 offset:0
s_add_u32 s51, s51, 32768
v_mfma_f32_16x16x32_bf16 v[88:91], v[152:155], v[140:143], v[88:91]
ds_read_b128 v[172:175], v242 offset:2048
s_and_b32 s51, s51, 131071
v_mfma_f32_16x16x32_bf16 v[104:107], v[152:155], v[144:147], v[104:107]
ds_read_b128 v[176:179], v242 offset:4096
v_add_u32 v241, s51, v232
v_mfma_f32_16x16x32_bf16 v[120:123], v[152:155], v[148:151], v[120:123]
ds_read_b128 v[180:183], v242 offset:6144
v_mov_b64 v[8:9], v[200:201]
s_waitcnt lgkmcnt(8)
v_mfma_f32_16x16x32_bf16 v[76:79], v[156:159], v[136:139], v[76:79]
ds_read_b64_tr_b16 v[184:185], v243 offset:8192
v_add_u32 v242, s51, v233
v_mfma_f32_16x16x32_bf16 v[92:95], v[156:159], v[140:143], v[92:95]
ds_read_b64_tr_b16 v[186:187], v243 offset:9216
v_mov_b64 v[10:11], v[200:201]
v_mfma_f32_16x16x32_bf16 v[108:111], v[156:159], v[144:147], v[108:111]
ds_read_b64_tr_b16 v[188:189], v244 offset:8192
v_add_u32 v243, s51, v234
v_mfma_f32_16x16x32_bf16 v[124:127], v[156:159], v[148:151], v[124:127]
ds_read_b64_tr_b16 v[190:191], v244 offset:9216
v_mov_b64 v[12:13], v[200:201]
s_waitcnt lgkmcnt(10)
v_mfma_f32_16x16x32_bf16 v[80:83], v[160:163], v[136:139], v[80:83]
ds_read_b64_tr_b16 v[192:193], v245 offset:8192
v_add_u32 v244, s51, v235
v_mfma_f32_16x16x32_bf16 v[96:99], v[160:163], v[140:143], v[96:99]
ds_read_b64_tr_b16 v[194:195], v245 offset:9216
v_mov_b64 v[14:15], v[200:201]
v_mfma_f32_16x16x32_bf16 v[112:115], v[160:163], v[144:147], v[112:115]
ds_read_b64_tr_b16 v[196:197], v246 offset:8192
v_add_u32 v245, s51, v236
v_mfma_f32_16x16x32_bf16 v[128:131], v[160:163], v[148:151], v[128:131]
ds_read_b64_tr_b16 v[198:199], v246 offset:9216
v_mov_b64 v[16:17], v[200:201]
s_waitcnt lgkmcnt(12)
v_mfma_f32_16x16x32_bf16 v[84:87], v[164:167], v[136:139], v[84:87]
v_add_u32 v246, s51, v237
v_mov_b64 v[18:19], v[200:201]
v_mfma_f32_16x16x32_bf16 v[100:103], v[164:167], v[140:143], v[100:103]
v_mov_b64 v[20:21], v[200:201]
v_mov_b64 v[22:23], v[200:201]
v_mfma_f32_16x16x32_bf16 v[116:119], v[164:167], v[144:147], v[116:119]
v_mov_b64 v[24:25], v[202:203]
v_mov_b64 v[26:27], v[202:203]
v_mfma_f32_16x16x32_bf16 v[132:135], v[164:167], v[148:151], v[132:135]
v_mov_b64 v[28:29], v[202:203]
v_mov_b64 v[30:31], v[202:203]
s_waitcnt lgkmcnt(6)
v_mfma_f32_16x16x32_bf16 v[72:75], v[184:187], v[168:171], v[72:75]
v_mov_b64 v[32:33], v[202:203]
v_mov_b64 v[34:35], v[202:203]
v_mfma_f32_16x16x32_bf16 v[88:91], v[184:187], v[172:175], v[88:91]
v_mov_b64 v[36:37], v[202:203]
v_mov_b64 v[38:39], v[202:203]
v_mfma_f32_16x16x32_bf16 v[104:107], v[184:187], v[176:179], v[104:107]
v_mfma_f32_16x16x32_bf16 v[120:123], v[184:187], v[180:183], v[120:123]
s_waitcnt lgkmcnt(0)
s_barrier
ds_read_b128 v[136:139], v241 offset:0
v_mfma_f32_16x16x32_bf16 v[76:79], v[188:191], v[168:171], v[76:79]
ds_read_b128 v[140:143], v241 offset:2048
v_mfma_f32_16x16x32_bf16 v[92:95], v[188:191], v[172:175], v[92:95]
ds_read_b128 v[144:147], v241 offset:4096
v_mfma_f32_16x16x32_bf16 v[108:111], v[188:191], v[176:179], v[108:111]
ds_read_b128 v[148:151], v241 offset:6144
v_mfma_f32_16x16x32_bf16 v[124:127], v[188:191], v[180:183], v[124:127]
ds_read_b64_tr_b16 v[152:153], v243 offset:0
v_mfma_f32_16x16x32_bf16 v[80:83], v[192:195], v[168:171], v[80:83]
ds_read_b64_tr_b16 v[154:155], v243 offset:1024
v_mfma_f32_16x16x32_bf16 v[96:99], v[192:195], v[172:175], v[96:99]
ds_read_b64_tr_b16 v[156:157], v244 offset:0
v_mfma_f32_16x16x32_bf16 v[112:115], v[192:195], v[176:179], v[112:115]
ds_read_b64_tr_b16 v[158:159], v244 offset:1024
v_mfma_f32_16x16x32_bf16 v[128:131], v[192:195], v[180:183], v[128:131]
ds_read_b64_tr_b16 v[160:161], v245 offset:0
v_mfma_f32_16x16x32_bf16 v[84:87], v[196:199], v[168:171], v[84:87]
ds_read_b64_tr_b16 v[162:163], v245 offset:1024
v_mfma_f32_16x16x32_bf16 v[100:103], v[196:199], v[172:175], v[100:103]
ds_read_b64_tr_b16 v[164:165], v246 offset:0
v_mfma_f32_16x16x32_bf16 v[116:119], v[196:199], v[176:179], v[116:119]
ds_read_b64_tr_b16 v[166:167], v246 offset:1024
v_mfma_f32_16x16x32_bf16 v[132:135], v[196:199], v[180:183], v[132:135]
s_waitcnt lgkmcnt(6)
v_mfma_f32_16x16x32_bf16 v[72:75], v[152:155], v[136:139], v[72:75]
ds_read_b128 v[168:171], v242 offset:0
s_add_u32 s51, s51, 32768
v_mfma_f32_16x16x32_bf16 v[88:91], v[152:155], v[140:143], v[88:91]
ds_read_b128 v[172:175], v242 offset:2048
s_and_b32 s51, s51, 131071
v_mfma_f32_16x16x32_bf16 v[104:107], v[152:155], v[144:147], v[104:107]
ds_read_b128 v[176:179], v242 offset:4096
v_add_u32 v241, s51, v232
v_mfma_f32_16x16x32_bf16 v[120:123], v[152:155], v[148:151], v[120:123]
ds_read_b128 v[180:183], v242 offset:6144
v_mov_b64 v[40:41], v[204:205]
s_waitcnt lgkmcnt(8)
v_mfma_f32_16x16x32_bf16 v[76:79], v[156:159], v[136:139], v[76:79]
ds_read_b64_tr_b16 v[184:185], v243 offset:8192
v_add_u32 v242, s51, v233
v_mfma_f32_16x16x32_bf16 v[92:95], v[156:159], v[140:143], v[92:95]
ds_read_b64_tr_b16 v[186:187], v243 offset:9216
v_mov_b64 v[42:43], v[204:205]
v_mfma_f32_16x16x32_bf16 v[108:111], v[156:159], v[144:147], v[108:111]
ds_read_b64_tr_b16 v[188:189], v244 offset:8192
v_add_u32 v243, s51, v234
v_mfma_f32_16x16x32_bf16 v[124:127], v[156:159], v[148:151], v[124:127]
ds_read_b64_tr_b16 v[190:191], v244 offset:9216
v_mov_b64 v[44:45], v[204:205]
s_waitcnt lgkmcnt(10)
v_mfma_f32_16x16x32_bf16 v[80:83], v[160:163], v[136:139], v[80:83]
ds_read_b64_tr_b16 v[192:193], v245 offset:8192
v_add_u32 v244, s51, v235
v_mfma_f32_16x16x32_bf16 v[96:99], v[160:163], v[140:143], v[96:99]
ds_read_b64_tr_b16 v[194:195], v245 offset:9216
v_mov_b64 v[46:47], v[204:205]
v_mfma_f32_16x16x32_bf16 v[112:115], v[160:163], v[144:147], v[112:115]
ds_read_b64_tr_b16 v[196:197], v246 offset:8192
v_add_u32 v245, s51, v236
v_mfma_f32_16x16x32_bf16 v[128:131], v[160:163], v[148:151], v[128:131]
ds_read_b64_tr_b16 v[198:199], v246 offset:9216
v_mov_b64 v[48:49], v[204:205]
s_waitcnt lgkmcnt(12)
v_mfma_f32_16x16x32_bf16 v[84:87], v[164:167], v[136:139], v[84:87]
v_add_u32 v246, s51, v237
v_mov_b64 v[50:51], v[204:205]
v_mfma_f32_16x16x32_bf16 v[100:103], v[164:167], v[140:143], v[100:103]
v_mov_b64 v[52:53], v[204:205]
v_mov_b64 v[54:55], v[204:205]
v_mfma_f32_16x16x32_bf16 v[116:119], v[164:167], v[144:147], v[116:119]
v_mov_b64 v[56:57], v[206:207]
v_mov_b64 v[58:59], v[206:207]
v_mfma_f32_16x16x32_bf16 v[132:135], v[164:167], v[148:151], v[132:135]
v_mov_b64 v[60:61], v[206:207]
v_mov_b64 v[62:63], v[206:207]
s_waitcnt lgkmcnt(6)
v_mfma_f32_16x16x32_bf16 v[72:75], v[184:187], v[168:171], v[72:75]
v_mov_b64 v[64:65], v[206:207]
v_mov_b64 v[66:67], v[206:207]
v_mfma_f32_16x16x32_bf16 v[88:91], v[184:187], v[172:175], v[88:91]
v_mov_b64 v[68:69], v[206:207]
v_mov_b64 v[70:71], v[206:207]
v_mfma_f32_16x16x32_bf16 v[104:107], v[184:187], v[176:179], v[104:107]
v_mfma_f32_16x16x32_bf16 v[120:123], v[184:187], v[180:183], v[120:123]
s_waitcnt lgkmcnt(0)
s_barrier
ds_read_b128 v[136:139], v241 offset:0
v_mfma_f32_16x16x32_bf16 v[76:79], v[188:191], v[168:171], v[76:79]
ds_read_b128 v[140:143], v241 offset:2048
v_mfma_f32_16x16x32_bf16 v[92:95], v[188:191], v[172:175], v[92:95]
ds_read_b128 v[144:147], v241 offset:4096
v_mfma_f32_16x16x32_bf16 v[108:111], v[188:191], v[176:179], v[108:111]
ds_read_b128 v[148:151], v241 offset:6144
v_mfma_f32_16x16x32_bf16 v[124:127], v[188:191], v[180:183], v[124:127]
ds_read_b64_tr_b16 v[152:153], v243 offset:0
v_mfma_f32_16x16x32_bf16 v[80:83], v[192:195], v[168:171], v[80:83]
ds_read_b64_tr_b16 v[154:155], v243 offset:1024
v_mfma_f32_16x16x32_bf16 v[96:99], v[192:195], v[172:175], v[96:99]
ds_read_b64_tr_b16 v[156:157], v244 offset:0
v_mfma_f32_16x16x32_bf16 v[112:115], v[192:195], v[176:179], v[112:115]
ds_read_b64_tr_b16 v[158:159], v244 offset:1024
v_mfma_f32_16x16x32_bf16 v[128:131], v[192:195], v[180:183], v[128:131]
ds_read_b64_tr_b16 v[160:161], v245 offset:0
v_mfma_f32_16x16x32_bf16 v[84:87], v[196:199], v[168:171], v[84:87]
ds_read_b64_tr_b16 v[162:163], v245 offset:1024
v_mfma_f32_16x16x32_bf16 v[100:103], v[196:199], v[172:175], v[100:103]
ds_read_b64_tr_b16 v[164:165], v246 offset:0
v_mfma_f32_16x16x32_bf16 v[116:119], v[196:199], v[176:179], v[116:119]
ds_read_b64_tr_b16 v[166:167], v246 offset:1024
v_mfma_f32_16x16x32_bf16 v[132:135], v[196:199], v[180:183], v[132:135]
s_mov_b32 s50, 13
.p2align 3
L_s2_2:
s_waitcnt lgkmcnt(6)
v_mfma_f32_16x16x32_bf16 v[72:75], v[152:155], v[136:139], v[72:75]
ds_read_b128 v[168:171], v242 offset:0
s_add_u32 s51, s51, 32768
v_mfma_f32_16x16x32_bf16 v[88:91], v[152:155], v[140:143], v[88:91]
ds_read_b128 v[172:175], v242 offset:2048
s_and_b32 s51, s51, 131071
v_mfma_f32_16x16x32_bf16 v[104:107], v[152:155], v[144:147], v[104:107]
ds_read_b128 v[176:179], v242 offset:4096
v_add_u32 v241, s51, v232
v_mfma_f32_16x16x32_bf16 v[120:123], v[152:155], v[148:151], v[120:123]
ds_read_b128 v[180:183], v242 offset:6144
s_waitcnt lgkmcnt(8)
v_mfma_f32_16x16x32_bf16 v[76:79], v[156:159], v[136:139], v[76:79]
ds_read_b64_tr_b16 v[184:185], v243 offset:8192
v_add_u32 v242, s51, v233
v_mfma_f32_16x16x32_bf16 v[92:95], v[156:159], v[140:143], v[92:95]
ds_read_b64_tr_b16 v[186:187], v243 offset:9216
v_mfma_f32_16x16x32_bf16 v[108:111], v[156:159], v[144:147], v[108:111]
ds_read_b64_tr_b16 v[188:189], v244 offset:8192
v_add_u32 v243, s51, v234
v_mfma_f32_16x16x32_bf16 v[124:127], v[156:159], v[148:151], v[124:127]
ds_read_b64_tr_b16 v[190:191], v244 offset:9216
s_waitcnt lgkmcnt(10)
v_mfma_f32_16x16x32_bf16 v[80:83], v[160:163], v[136:139], v[80:83]
ds_read_b64_tr_b16 v[192:193], v245 offset:8192
v_add_u32 v244, s51, v235
v_mfma_f32_16x16x32_bf16 v[96:99], v[160:163], v[140:143], v[96:99]
ds_read_b64_tr_b16 v[194:195], v245 offset:9216
v_mfma_f32_16x16x32_bf16 v[112:115], v[160:163], v[144:147], v[112:115]
ds_read_b64_tr_b16 v[196:197], v246 offset:8192
v_add_u32 v245, s51, v236
v_mfma_f32_16x16x32_bf16 v[128:131], v[160:163], v[148:151], v[128:131]
ds_read_b64_tr_b16 v[198:199], v246 offset:9216
s_waitcnt lgkmcnt(12)
v_mfma_f32_16x16x32_bf16 v[84:87], v[164:167], v[136:139], v[84:87]
v_add_u32 v246, s51, v237
v_mfma_f32_16x16x32_bf16 v[100:103], v[164:167], v[140:143], v[100:103]
v_mfma_f32_16x16x32_bf16 v[116:119], v[164:167], v[144:147], v[116:119]
v_mfma_f32_16x16x32_bf16 v[132:135], v[164:167], v[148:151], v[132:135]
s_waitcnt lgkmcnt(6)
v_mfma_f32_16x16x32_bf16 v[72:75], v[184:187], v[168:171], v[72:75]
v_mfma_f32_16x16x32_bf16 v[88:91], v[184:187], v[172:175], v[88:91]
v_mfma_f32_16x16x32_bf16 v[104:107], v[184:187], v[176:179], v[104:107]
v_mfma_f32_16x16x32_bf16 v[120:123], v[184:187], v[180:183], v[120:123]
s_waitcnt lgkmcnt(0)
s_barrier
ds_read_b128 v[136:139], v241 offset:0
v_mfma_f32_16x16x32_bf16 v[76:79], v[188:191], v[168:171], v[76:79]
ds_read_b128 v[140:143], v241 offset:2048
v_mfma_f32_16x16x32_bf16 v[92:95], v[188:191], v[172:175], v[92:95]
ds_read_b128 v[144:147], v241 offset:4096
v_mfma_f32_16x16x32_bf16 v[108:111], v[188:191], v[176:179], v[108:111]
ds_read_b128 v[148:151], v241 offset:6144
v_mfma_f32_16x16x32_bf16 v[124:127], v[188:191], v[180:183], v[124:127]
ds_read_b64_tr_b16 v[152:153], v243 offset:0
v_mfma_f32_16x16x32_bf16 v[80:83], v[192:195], v[168:171], v[80:83]
ds_read_b64_tr_b16 v[154:155], v243 offset:1024
v_mfma_f32_16x16x32_bf16 v[96:99], v[192:195], v[172:175], v[96:99]
ds_read_b64_tr_b16 v[156:157], v244 offset:0
v_mfma_f32_16x16x32_bf16 v[112:115], v[192:195], v[176:179], v[112:115]
ds_read_b64_tr_b16 v[158:159], v244 offset:1024
v_mfma_f32_16x16x32_bf16 v[128:131], v[192:195], v[180:183], v[128:131]
ds_read_b64_tr_b16 v[160:161], v245 offset:0
v_mfma_f32_16x16x32_bf16 v[84:87], v[196:199], v[168:171], v[84:87]
ds_read_b64_tr_b16 v[162:163], v245 offset:1024
v_mfma_f32_16x16x32_bf16 v[100:103], v[196:199], v[172:175], v[100:103]
s_sub_u32 s50, s50, 1
ds_read_b64_tr_b16 v[164:165], v246 offset:0
v_mfma_f32_16x16x32_bf16 v[116:119], v[196:199], v[176:179], v[116:119]
s_cmp_lg_u32 s50, 0
ds_read_b64_tr_b16 v[166:167], v246 offset:1024
v_mfma_f32_16x16x32_bf16 v[132:135], v[196:199], v[180:183], v[132:135]
s_cbranch_scc1 L_s2_2
s_waitcnt lgkmcnt(6)
v_mfma_f32_16x16x32_bf16 v[72:75], v[152:155], v[136:139], v[72:75]
ds_read_b128 v[168:171], v242 offset:0
s_add_u32 s51, s51, 32768
v_mfma_f32_16x16x32_bf16 v[88:91], v[152:155], v[140:143], v[88:91]
ds_read_b128 v[172:175], v242 offset:2048
s_and_b32 s51, s51, 131071
v_mfma_f32_16x16x32_bf16 v[104:107], v[152:155], v[144:147], v[104:107]
ds_read_b128 v[176:179], v242 offset:4096
v_mfma_f32_16x16x32_bf16 v[120:123], v[152:155], v[148:151], v[120:123]
ds_read_b128 v[180:183], v242 offset:6144
s_waitcnt lgkmcnt(8)
v_mfma_f32_16x16x32_bf16 v[76:79], v[156:159], v[136:139], v[76:79]
ds_read_b64_tr_b16 v[184:185], v243 offset:8192
v_mfma_f32_16x16x32_bf16 v[92:95], v[156:159], v[140:143], v[92:95]
ds_read_b64_tr_b16 v[186:187], v243 offset:9216
v_mfma_f32_16x16x32_bf16 v[108:111], v[156:159], v[144:147], v[108:111]
ds_read_b64_tr_b16 v[188:189], v244 offset:8192
v_mfma_f32_16x16x32_bf16 v[124:127], v[156:159], v[148:151], v[124:127]
ds_read_b64_tr_b16 v[190:191], v244 offset:9216
s_waitcnt lgkmcnt(10)
v_mfma_f32_16x16x32_bf16 v[80:83], v[160:163], v[136:139], v[80:83]
ds_read_b64_tr_b16 v[192:193], v245 offset:8192
v_mfma_f32_16x16x32_bf16 v[96:99], v[160:163], v[140:143], v[96:99]
ds_read_b64_tr_b16 v[194:195], v245 offset:9216
v_mfma_f32_16x16x32_bf16 v[112:115], v[160:163], v[144:147], v[112:115]
ds_read_b64_tr_b16 v[196:197], v246 offset:8192
v_mfma_f32_16x16x32_bf16 v[128:131], v[160:163], v[148:151], v[128:131]
ds_read_b64_tr_b16 v[198:199], v246 offset:9216
s_waitcnt lgkmcnt(12)
v_mfma_f32_16x16x32_bf16 v[84:87], v[164:167], v[136:139], v[84:87]
v_mfma_f32_16x16x32_bf16 v[100:103], v[164:167], v[140:143], v[100:103]
v_mfma_f32_16x16x32_bf16 v[116:119], v[164:167], v[144:147], v[116:119]
v_mfma_f32_16x16x32_bf16 v[132:135], v[164:167], v[148:151], v[132:135]
s_waitcnt lgkmcnt(6)
v_mfma_f32_16x16x32_bf16 v[72:75], v[184:187], v[168:171], v[72:75]
v_mfma_f32_16x16x32_bf16 v[88:91], v[184:187], v[172:175], v[88:91]
v_mfma_f32_16x16x32_bf16 v[104:107], v[184:187], v[176:179], v[104:107]
v_mfma_f32_16x16x32_bf16 v[120:123], v[184:187], v[180:183], v[120:123]
v_add_u32 v241, s51, v232
v_add_u32 v242, s51, v233
v_add_u32 v243, s51, v238
s_waitcnt lgkmcnt(0)
s_barrier
v_mfma_f32_16x16x32_bf16 v[76:79], v[188:191], v[168:171], v[76:79]
v_mfma_f32_16x16x32_bf16 v[92:95], v[188:191], v[172:175], v[92:95]
v_mfma_f32_16x16x32_bf16 v[108:111], v[188:191], v[176:179], v[108:111]
v_mfma_f32_16x16x32_bf16 v[124:127], v[188:191], v[180:183], v[124:127]
v_mfma_f32_16x16x32_bf16 v[80:83], v[192:195], v[168:171], v[80:83]
v_mfma_f32_16x16x32_bf16 v[96:99], v[192:195], v[172:175], v[96:99]
v_mfma_f32_16x16x32_bf16 v[112:115], v[192:195], v[176:179], v[112:115]
v_mfma_f32_16x16x32_bf16 v[128:131], v[192:195], v[180:183], v[128:131]
v_mfma_f32_16x16x32_bf16 v[84:87], v[196:199], v[168:171], v[84:87]
v_mfma_f32_16x16x32_bf16 v[100:103], v[196:199], v[172:175], v[100:103]
v_mfma_f32_16x16x32_bf16 v[116:119], v[196:199], v[176:179], v[116:119]
v_mfma_f32_16x16x32_bf16 v[132:135], v[196:199], v[180:183], v[132:135]
s_mov_b32 s66, 0xbdd2d3e8
s_mov_b32 s67, 0xbdd2d3e8
s_mov_b32 s4, 1.0
s_mov_b32 s5, 1.0
v_mov_b32 v200, 0xc0135761
v_mov_b32 v201, 0xc0135761
s_nop 1
v_pk_mul_f32 v[168:169], v[72:73], v[72:73]
v_pk_mul_f32 v[170:171], v[74:75], v[74:75]
v_pk_mul_f32 v[172:173], v[76:77], v[76:77]
v_pk_mul_f32 v[174:175], v[78:79], v[78:79]
v_pk_fma_f32 v[168:169], v[168:169], s[66:67], v[200:201]
v_pk_fma_f32 v[170:171], v[170:171], s[66:67], v[200:201]
v_pk_fma_f32 v[172:173], v[172:173], s[66:67], v[200:201]
v_pk_fma_f32 v[174:175], v[174:175], s[66:67], v[200:201]
v_pk_mul_f32 v[168:169], v[168:169], v[72:73]
v_pk_mul_f32 v[170:171], v[170:171], v[74:75]
v_pk_mul_f32 v[172:173], v[172:173], v[76:77]
v_pk_mul_f32 v[174:175], v[174:175], v[78:79]
v_exp_f32 v168, v168
v_pk_mul_f32 v[176:177], v[80:81], v[80:81]
v_exp_f32 v169, v169
v_pk_mul_f32 v[178:179], v[82:83], v[82:83]
v_exp_f32 v170, v170
v_pk_mul_f32 v[180:181], v[84:85], v[84:85]
v_exp_f32 v171, v171
v_pk_mul_f32 v[182:183], v[86:87], v[86:87]
v_exp_f32 v172, v172
v_exp_f32 v173, v173
v_exp_f32 v174, v174
v_exp_f32 v175, v175
v_pk_add_f32 v[168:169], v[168:169], s[4:5]
v_pk_add_f32 v[170:171], v[170:171], s[4:5]
v_pk_add_f32 v[172:173], v[172:173], s[4:5]
v_pk_add_f32 v[174:175], v[174:175], s[4:5]
v_rcp_f32 v168, v168
v_pk_fma_f32 v[176:177], v[176:177], s[66:67], v[200:201]
v_rcp_f32 v169, v169
v_pk_fma_f32 v[178:179], v[178:179], s[66:67], v[200:201]
v_rcp_f32 v170, v170
v_pk_fma_f32 v[180:181], v[180:181], s[66:67], v[200:201]
v_rcp_f32 v171, v171
v_pk_fma_f32 v[182:183], v[182:183], s[66:67], v[200:201]
v_rcp_f32 v172, v172
v_pk_mul_f32 v[176:177], v[176:177], v[80:81]
v_rcp_f32 v173, v173
v_pk_mul_f32 v[178:179], v[178:179], v[82:83]
v_rcp_f32 v174, v174
v_pk_mul_f32 v[180:181], v[180:181], v[84:85]
v_rcp_f32 v175, v175
v_pk_mul_f32 v[182:183], v[182:183], v[86:87]
v_exp_f32 v176, v176
v_pk_mul_f32 v[72:73], v[72:73], v[168:169]
v_exp_f32 v177, v177
v_pk_mul_f32 v[74:75], v[74:75], v[170:171]
v_exp_f32 v178, v178
v_pk_mul_f32 v[76:77], v[76:77], v[172:173]
v_exp_f32 v179, v179
v_pk_mul_f32 v[78:79], v[78:79], v[174:175]
v_exp_f32 v180, v180
v_pk_mul_f32 v[168:169], v[88:89], v[88:89]
v_exp_f32 v181, v181
v_pk_mul_f32 v[170:171], v[90:91], v[90:91]
v_exp_f32 v182, v182
v_pk_mul_f32 v[172:173], v[92:93], v[92:93]
v_exp_f32 v183, v183
v_pk_mul_f32 v[174:175], v[94:95], v[94:95]
v_pk_add_f32 v[176:177], v[176:177], s[4:5]
v_pk_add_f32 v[178:179], v[178:179], s[4:5]
v_pk_add_f32 v[180:181], v[180:181], s[4:5]
v_pk_add_f32 v[182:183], v[182:183], s[4:5]
v_rcp_f32 v176, v176
v_pk_fma_f32 v[168:169], v[168:169], s[66:67], v[200:201]
v_rcp_f32 v177, v177
v_pk_fma_f32 v[170:171], v[170:171], s[66:67], v[200:201]
v_rcp_f32 v178, v178
v_pk_fma_f32 v[172:173], v[172:173], s[66:67], v[200:201]
v_rcp_f32 v179, v179
v_pk_fma_f32 v[174:175], v[174:175], s[66:67], v[200:201]
v_rcp_f32 v180, v180
v_pk_mul_f32 v[168:169], v[168:169], v[88:89]
v_rcp_f32 v181, v181
v_pk_mul_f32 v[170:171], v[170:171], v[90:91]
v_rcp_f32 v182, v182
v_pk_mul_f32 v[172:173], v[172:173], v[92:93]
v_rcp_f32 v183, v183
v_pk_mul_f32 v[174:175], v[174:175], v[94:95]
v_exp_f32 v168, v168
v_pk_mul_f32 v[80:81], v[80:81], v[176:177]
v_exp_f32 v169, v169
v_pk_mul_f32 v[82:83], v[82:83], v[178:179]
v_exp_f32 v170, v170
v_pk_mul_f32 v[84:85], v[84:85], v[180:181]
v_exp_f32 v171, v171
v_pk_mul_f32 v[86:87], v[86:87], v[182:183]
v_exp_f32 v172, v172
v_pk_mul_f32 v[176:177], v[96:97], v[96:97]
v_exp_f32 v173, v173
v_pk_mul_f32 v[178:179], v[98:99], v[98:99]
v_exp_f32 v174, v174
v_pk_mul_f32 v[180:181], v[100:101], v[100:101]
v_exp_f32 v175, v175
v_pk_mul_f32 v[182:183], v[102:103], v[102:103]
v_pk_add_f32 v[168:169], v[168:169], s[4:5]
v_pk_add_f32 v[170:171], v[170:171], s[4:5]
v_pk_add_f32 v[172:173], v[172:173], s[4:5]
v_pk_add_f32 v[174:175], v[174:175], s[4:5]
v_rcp_f32 v168, v168
v_pk_fma_f32 v[176:177], v[176:177], s[66:67], v[200:201]
v_rcp_f32 v169, v169
v_pk_fma_f32 v[178:179], v[178:179], s[66:67], v[200:201]
v_rcp_f32 v170, v170
v_pk_fma_f32 v[180:181], v[180:181], s[66:67], v[200:201]
v_rcp_f32 v171, v171
v_pk_fma_f32 v[182:183], v[182:183], s[66:67], v[200:201]
v_rcp_f32 v172, v172
v_pk_mul_f32 v[176:177], v[176:177], v[96:97]
v_rcp_f32 v173, v173
v_pk_mul_f32 v[178:179], v[178:179], v[98:99]
v_rcp_f32 v174, v174
v_pk_mul_f32 v[180:181], v[180:181], v[100:101]
v_rcp_f32 v175, v175
v_pk_mul_f32 v[182:183], v[182:183], v[102:103]
v_exp_f32 v176, v176
v_pk_mul_f32 v[88:89], v[88:89], v[168:169]
v_exp_f32 v177, v177
v_pk_mul_f32 v[90:91], v[90:91], v[170:171]
v_exp_f32 v178, v178
v_pk_mul_f32 v[92:93], v[92:93], v[172:173]
v_exp_f32 v179, v179
v_pk_mul_f32 v[94:95], v[94:95], v[174:175]
v_exp_f32 v180, v180
v_pk_mul_f32 v[168:169], v[104:105], v[104:105]
v_exp_f32 v181, v181
v_pk_mul_f32 v[170:171], v[106:107], v[106:107]
v_exp_f32 v182, v182
v_pk_mul_f32 v[172:173], v[108:109], v[108:109]
v_exp_f32 v183, v183
v_pk_mul_f32 v[174:175], v[110:111], v[110:111]
v_pk_add_f32 v[176:177], v[176:177], s[4:5]
v_pk_add_f32 v[178:179], v[178:179], s[4:5]
v_pk_add_f32 v[180:181], v[180:181], s[4:5]
v_pk_add_f32 v[182:183], v[182:183], s[4:5]
v_rcp_f32 v176, v176
v_pk_fma_f32 v[168:169], v[168:169], s[66:67], v[200:201]
v_rcp_f32 v177, v177
v_pk_fma_f32 v[170:171], v[170:171], s[66:67], v[200:201]
v_rcp_f32 v178, v178
v_pk_fma_f32 v[172:173], v[172:173], s[66:67], v[200:201]
v_rcp_f32 v179, v179
v_pk_fma_f32 v[174:175], v[174:175], s[66:67], v[200:201]
v_rcp_f32 v180, v180
v_pk_mul_f32 v[168:169], v[168:169], v[104:105]
v_rcp_f32 v181, v181
v_pk_mul_f32 v[170:171], v[170:171], v[106:107]
v_rcp_f32 v182, v182
v_pk_mul_f32 v[172:173], v[172:173], v[108:109]
v_rcp_f32 v183, v183
v_pk_mul_f32 v[174:175], v[174:175], v[110:111]
v_exp_f32 v168, v168
v_pk_mul_f32 v[96:97], v[96:97], v[176:177]
v_exp_f32 v169, v169
v_pk_mul_f32 v[98:99], v[98:99], v[178:179]
v_exp_f32 v170, v170
v_pk_mul_f32 v[100:101], v[100:101], v[180:181]
v_exp_f32 v171, v171
v_pk_mul_f32 v[102:103], v[102:103], v[182:183]
v_exp_f32 v172, v172
v_pk_mul_f32 v[176:177], v[112:113], v[112:113]
v_exp_f32 v173, v173
v_pk_mul_f32 v[178:179], v[114:115], v[114:115]
v_exp_f32 v174, v174
v_pk_mul_f32 v[180:181], v[116:117], v[116:117]
v_exp_f32 v175, v175
v_pk_mul_f32 v[182:183], v[118:119], v[118:119]
v_pk_add_f32 v[168:169], v[168:169], s[4:5]
v_pk_add_f32 v[170:171], v[170:171], s[4:5]
v_pk_add_f32 v[172:173], v[172:173], s[4:5]
v_pk_add_f32 v[174:175], v[174:175], s[4:5]
v_rcp_f32 v168, v168
v_pk_fma_f32 v[176:177], v[176:177], s[66:67], v[200:201]
v_rcp_f32 v169, v169
v_pk_fma_f32 v[178:179], v[178:179], s[66:67], v[200:201]
v_rcp_f32 v170, v170
v_pk_fma_f32 v[180:181], v[180:181], s[66:67], v[200:201]
v_rcp_f32 v171, v171
v_pk_fma_f32 v[182:183], v[182:183], s[66:67], v[200:201]
v_rcp_f32 v172, v172
v_pk_mul_f32 v[176:177], v[176:177], v[112:113]
v_rcp_f32 v173, v173
v_pk_mul_f32 v[178:179], v[178:179], v[114:115]
v_rcp_f32 v174, v174
v_pk_mul_f32 v[180:181], v[180:181], v[116:117]
v_rcp_f32 v175, v175
v_pk_mul_f32 v[182:183], v[182:183], v[118:119]
v_exp_f32 v176, v176
v_pk_mul_f32 v[104:105], v[104:105], v[168:169]
v_exp_f32 v177, v177
v_pk_mul_f32 v[106:107], v[106:107], v[170:171]
v_exp_f32 v178, v178
v_pk_mul_f32 v[108:109], v[108:109], v[172:173]
v_exp_f32 v179, v179
v_pk_mul_f32 v[110:111], v[110:111], v[174:175]
v_exp_f32 v180, v180
v_pk_mul_f32 v[168:169], v[120:121], v[120:121]
v_exp_f32 v181, v181
v_pk_mul_f32 v[170:171], v[122:123], v[122:123]
v_exp_f32 v182, v182
v_pk_mul_f32 v[172:173], v[124:125], v[124:125]
v_exp_f32 v183, v183
v_pk_mul_f32 v[174:175], v[126:127], v[126:127]
v_pk_add_f32 v[176:177], v[176:177], s[4:5]
v_pk_add_f32 v[178:179], v[178:179], s[4:5]
v_pk_add_f32 v[180:181], v[180:181], s[4:5]
v_pk_add_f32 v[182:183], v[182:183], s[4:5]
v_rcp_f32 v176, v176
v_pk_fma_f32 v[168:169], v[168:169], s[66:67], v[200:201]
v_rcp_f32 v177, v177
v_pk_fma_f32 v[170:171], v[170:171], s[66:67], v[200:201]
v_rcp_f32 v178, v178
v_pk_fma_f32 v[172:173], v[172:173], s[66:67], v[200:201]
v_rcp_f32 v179, v179
v_pk_fma_f32 v[174:175], v[174:175], s[66:67], v[200:201]
v_rcp_f32 v180, v180
v_pk_mul_f32 v[168:169], v[168:169], v[120:121]
v_rcp_f32 v181, v181
v_pk_mul_f32 v[170:171], v[170:171], v[122:123]
v_rcp_f32 v182, v182
v_pk_mul_f32 v[172:173], v[172:173], v[124:125]
v_rcp_f32 v183, v183
v_pk_mul_f32 v[174:175], v[174:175], v[126:127]
v_exp_f32 v168, v168
v_pk_mul_f32 v[112:113], v[112:113], v[176:177]
v_exp_f32 v169, v169
v_pk_mul_f32 v[114:115], v[114:115], v[178:179]
v_exp_f32 v170, v170
v_pk_mul_f32 v[116:117], v[116:117], v[180:181]
v_exp_f32 v171, v171
v_pk_mul_f32 v[118:119], v[118:119], v[182:183]
v_exp_f32 v172, v172
v_pk_mul_f32 v[176:177], v[128:129], v[128:129]
v_exp_f32 v173, v173
v_pk_mul_f32 v[178:179], v[130:131], v[130:131]
v_exp_f32 v174, v174
v_pk_mul_f32 v[180:181], v[132:133], v[132:133]
v_exp_f32 v175, v175
v_pk_mul_f32 v[182:183], v[134:135], v[134:135]
v_pk_add_f32 v[168:169], v[168:169], s[4:5]
v_pk_add_f32 v[170:171], v[170:171], s[4:5]
v_pk_add_f32 v[172:173], v[172:173], s[4:5]
v_pk_add_f32 v[174:175], v[174:175], s[4:5]
v_rcp_f32 v168, v168
v_pk_fma_f32 v[176:177], v[176:177], s[66:67], v[200:201]
v_rcp_f32 v169, v169
v_pk_fma_f32 v[178:179], v[178:179], s[66:67], v[200:201]
v_rcp_f32 v170, v170
v_pk_fma_f32 v[180:181], v[180:181], s[66:67], v[200:201]
v_rcp_f32 v171, v171
v_pk_fma_f32 v[182:183], v[182:183], s[66:67], v[200:201]
v_rcp_f32 v172, v172
v_pk_mul_f32 v[176:177], v[176:177], v[128:129]
v_rcp_f32 v173, v173
v_pk_mul_f32 v[178:179], v[178:179], v[130:131]
v_rcp_f32 v174, v174
v_pk_mul_f32 v[180:181], v[180:181], v[132:133]
v_rcp_f32 v175, v175
v_pk_mul_f32 v[182:183], v[182:183], v[134:135]
v_exp_f32 v176, v176
v_pk_mul_f32 v[120:121], v[120:121], v[168:169]
v_exp_f32 v177, v177
v_pk_mul_f32 v[122:123], v[122:123], v[170:171]
v_exp_f32 v178, v178
v_pk_mul_f32 v[124:125], v[124:125], v[172:173]
v_exp_f32 v179, v179
v_pk_mul_f32 v[126:127], v[126:127], v[174:175]
v_exp_f32 v180, v180
v_exp_f32 v181, v181
v_exp_f32 v182, v182
v_exp_f32 v183, v183
v_pk_add_f32 v[176:177], v[176:177], s[4:5]
v_pk_add_f32 v[178:179], v[178:179], s[4:5]
v_pk_add_f32 v[180:181], v[180:181], s[4:5]
v_pk_add_f32 v[182:183], v[182:183], s[4:5]
v_rcp_f32 v176, v176
v_rcp_f32 v177, v177
v_rcp_f32 v178, v178
v_rcp_f32 v179, v179
v_rcp_f32 v180, v180
v_rcp_f32 v181, v181
v_rcp_f32 v182, v182
v_rcp_f32 v183, v183
s_nop 0
v_pk_mul_f32 v[128:129], v[128:129], v[176:177]
v_pk_mul_f32 v[130:131], v[130:131], v[178:179]
v_pk_mul_f32 v[132:133], v[132:133], v[180:181]
v_pk_mul_f32 v[134:135], v[134:135], v[182:183]
s_barrier
ds_read_b128 v[136:139], v241 offset:0
ds_read_b128 v[140:143], v241 offset:2048
ds_read_b128 v[144:147], v241 offset:4096
ds_read_b128 v[148:151], v241 offset:6144
ds_read_b128 v[152:155], v243 offset:0
ds_read_b128 v[156:159], v243 offset:2048
ds_read_b128 v[160:163], v243 offset:4096
ds_read_b128 v[164:167], v243 offset:6144
s_waitcnt lgkmcnt(3)
v_mfma_f32_16x16x32_bf16 v[8:11], v[152:155], v[136:139], v[8:11]
ds_read_b128 v[168:171], v242 offset:0
s_add_u32 s51, s51, 32768
v_mfma_f32_16x16x32_bf16 v[24:27], v[152:155], v[140:143], v[24:27]
ds_read_b128 v[172:175], v242 offset:2048
s_and_b32 s51, s51, 131071
v_mfma_f32_16x16x32_bf16 v[40:43], v[152:155], v[144:147], v[40:43]
ds_read_b128 v[176:179], v242 offset:4096
v_add_u32 v241, s51, v232
v_mfma_f32_16x16x32_bf16 v[56:59], v[152:155], v[148:151], v[56:59]
ds_read_b128 v[180:183], v242 offset:6144
v_mov_b64 v[200:201], 0
s_waitcnt lgkmcnt(6)
v_mfma_f32_16x16x32_bf16 v[12:15], v[156:159], v[136:139], v[12:15]
ds_read_b128 v[184:187], v243 offset:1024
v_add_u32 v242, s51, v233
v_mfma_f32_16x16x32_bf16 v[28:31], v[156:159], v[140:143], v[28:31]
ds_read_b128 v[188:191], v243 offset:3072
v_mov_b64 v[202:203], 0
v_mfma_f32_16x16x32_bf16 v[44:47], v[156:159], v[144:147], v[44:47]
ds_read_b128 v[192:195], v243 offset:5120
v_mov_b64 v[204:205], 0
v_mfma_f32_16x16x32_bf16 v[60:63], v[156:159], v[148:151], v[60:63]
ds_read_b128 v[196:199], v243 offset:7168
v_mov_b64 v[206:207], 0
s_waitcnt lgkmcnt(9)
v_mfma_f32_16x16x32_bf16 v[16:19], v[160:163], v[136:139], v[16:19]
v_add_u32 v243, s51, v238
v_mov_b64 v[208:209], 0
v_mfma_f32_16x16x32_bf16 v[32:35], v[160:163], v[140:143], v[32:35]
v_mov_b64 v[210:211], 0
v_mov_b64 v[212:213], 0
v_mfma_f32_16x16x32_bf16 v[48:51], v[160:163], v[144:147], v[48:51]
v_mov_b64 v[214:215], 0
v_mov_b64 v[216:217], 0
v_mfma_f32_16x16x32_bf16 v[64:67], v[160:163], v[148:151], v[64:67]
v_mov_b64 v[218:219], 0
v_mov_b64 v[220:221], 0
s_waitcnt lgkmcnt(8)
v_mfma_f32_16x16x32_bf16 v[20:23], v[164:167], v[136:139], v[20:23]
v_mov_b64 v[222:223], 0
v_mov_b64 v[224:225], 0
v_mfma_f32_16x16x32_bf16 v[36:39], v[164:167], v[140:143], v[36:39]
v_mov_b64 v[226:227], 0
v_mov_b64 v[228:229], 0
v_mfma_f32_16x16x32_bf16 v[52:55], v[164:167], v[144:147], v[52:55]
v_mov_b64 v[230:231], 0
v_mfma_f32_16x16x32_bf16 v[68:71], v[164:167], v[148:151], v[68:71]
s_waitcnt lgkmcnt(3)
v_mfma_f32_16x16x32_bf16 v[8:11], v[184:187], v[168:171], v[8:11]
v_mfma_f32_16x16x32_bf16 v[24:27], v[184:187], v[172:175], v[24:27]
v_mfma_f32_16x16x32_bf16 v[40:43], v[184:187], v[176:179], v[40:43]
v_mfma_f32_16x16x32_bf16 v[56:59], v[184:187], v[180:183], v[56:59]
s_waitcnt lgkmcnt(0)
s_barrier
ds_read_b128 v[136:139], v241 offset:0
v_mfma_f32_16x16x32_bf16 v[12:15], v[188:191], v[168:171], v[12:15]
ds_read_b128 v[140:143], v241 offset:2048
v_mfma_f32_16x16x32_bf16 v[28:31], v[188:191], v[172:175], v[28:31]
ds_read_b128 v[144:147], v241 offset:4096
v_mfma_f32_16x16x32_bf16 v[44:47], v[188:191], v[176:179], v[44:47]
ds_read_b128 v[148:151], v241 offset:6144
v_mfma_f32_16x16x32_bf16 v[60:63], v[188:191], v[180:183], v[60:63]
ds_read_b128 v[152:155], v243 offset:0
v_mfma_f32_16x16x32_bf16 v[16:19], v[192:195], v[168:171], v[16:19]
ds_read_b128 v[156:159], v243 offset:2048
v_mfma_f32_16x16x32_bf16 v[32:35], v[192:195], v[172:175], v[32:35]
ds_read_b128 v[160:163], v243 offset:4096
v_mfma_f32_16x16x32_bf16 v[48:51], v[192:195], v[176:179], v[48:51]
ds_read_b128 v[164:167], v243 offset:6144
v_mfma_f32_16x16x32_bf16 v[64:67], v[192:195], v[180:183], v[64:67]
v_mfma_f32_16x16x32_bf16 v[20:23], v[196:199], v[168:171], v[20:23]
v_mfma_f32_16x16x32_bf16 v[36:39], v[196:199], v[172:175], v[36:39]
v_mfma_f32_16x16x32_bf16 v[52:55], v[196:199], v[176:179], v[52:55]
v_mfma_f32_16x16x32_bf16 v[68:71], v[196:199], v[180:183], v[68:71]
s_mov_b32 s50, 29
.p2align 3
L_s3_3:
s_waitcnt lgkmcnt(3)
v_mfma_f32_16x16x32_bf16 v[8:11], v[152:155], v[136:139], v[8:11]
ds_read_b128 v[168:171], v242 offset:0
s_add_u32 s51, s51, 32768
v_mfma_f32_16x16x32_bf16 v[24:27], v[152:155], v[140:143], v[24:27]
ds_read_b128 v[172:175], v242 offset:2048
s_and_b32 s51, s51, 131071
v_mfma_f32_16x16x32_bf16 v[40:43], v[152:155], v[144:147], v[40:43]
ds_read_b128 v[176:179], v242 offset:4096
v_add_u32 v241, s51, v232
v_mfma_f32_16x16x32_bf16 v[56:59], v[152:155], v[148:151], v[56:59]
ds_read_b128 v[180:183], v242 offset:6144
s_waitcnt lgkmcnt(6)
v_mfma_f32_16x16x32_bf16 v[12:15], v[156:159], v[136:139], v[12:15]
ds_read_b128 v[184:187], v243 offset:1024
v_add_u32 v242, s51, v233
v_mfma_f32_16x16x32_bf16 v[28:31], v[156:159], v[140:143], v[28:31]
ds_read_b128 v[188:191], v243 offset:3072
v_mfma_f32_16x16x32_bf16 v[44:47], v[156:159], v[144:147], v[44:47]
ds_read_b128 v[192:195], v243 offset:5120
v_mfma_f32_16x16x32_bf16 v[60:63], v[156:159], v[148:151], v[60:63]
ds_read_b128 v[196:199], v243 offset:7168
s_waitcnt lgkmcnt(9)
v_mfma_f32_16x16x32_bf16 v[16:19], v[160:163], v[136:139], v[16:19]
v_add_u32 v243, s51, v238
v_mfma_f32_16x16x32_bf16 v[32:35], v[160:163], v[140:143], v[32:35]
v_mfma_f32_16x16x32_bf16 v[48:51], v[160:163], v[144:147], v[48:51]
v_mfma_f32_16x16x32_bf16 v[64:67], v[160:163], v[148:151], v[64:67]
s_waitcnt lgkmcnt(8)
v_mfma_f32_16x16x32_bf16 v[20:23], v[164:167], v[136:139], v[20:23]
v_mfma_f32_16x16x32_bf16 v[36:39], v[164:167], v[140:143], v[36:39]
v_mfma_f32_16x16x32_bf16 v[52:55], v[164:167], v[144:147], v[52:55]
v_mfma_f32_16x16x32_bf16 v[68:71], v[164:167], v[148:151], v[68:71]
s_waitcnt lgkmcnt(3)
v_mfma_f32_16x16x32_bf16 v[8:11], v[184:187], v[168:171], v[8:11]
v_mfma_f32_16x16x32_bf16 v[24:27], v[184:187], v[172:175], v[24:27]
v_mfma_f32_16x16x32_bf16 v[40:43], v[184:187], v[176:179], v[40:43]
v_mfma_f32_16x16x32_bf16 v[56:59], v[184:187], v[180:183], v[56:59]
s_waitcnt lgkmcnt(0)
s_barrier
ds_read_b128 v[136:139], v241 offset:0
v_mfma_f32_16x16x32_bf16 v[12:15], v[188:191], v[168:171], v[12:15]
ds_read_b128 v[140:143], v241 offset:2048
v_mfma_f32_16x16x32_bf16 v[28:31], v[188:191], v[172:175], v[28:31]
ds_read_b128 v[144:147], v241 offset:4096
v_mfma_f32_16x16x32_bf16 v[44:47], v[188:191], v[176:179], v[44:47]
ds_read_b128 v[148:151], v241 offset:6144
v_mfma_f32_16x16x32_bf16 v[60:63], v[188:191], v[180:183], v[60:63]
ds_read_b128 v[152:155], v243 offset:0
v_mfma_f32_16x16x32_bf16 v[16:19], v[192:195], v[168:171], v[16:19]
ds_read_b128 v[156:159], v243 offset:2048
v_mfma_f32_16x16x32_bf16 v[32:35], v[192:195], v[172:175], v[32:35]
ds_read_b128 v[160:163], v243 offset:4096
v_mfma_f32_16x16x32_bf16 v[48:51], v[192:195], v[176:179], v[48:51]
ds_read_b128 v[164:167], v243 offset:6144
v_mfma_f32_16x16x32_bf16 v[64:67], v[192:195], v[180:183], v[64:67]
v_mfma_f32_16x16x32_bf16 v[20:23], v[196:199], v[168:171], v[20:23]
v_mfma_f32_16x16x32_bf16 v[36:39], v[196:199], v[172:175], v[36:39]
s_sub_u32 s50, s50, 1
v_mfma_f32_16x16x32_bf16 v[52:55], v[196:199], v[176:179], v[52:55]
s_cmp_lg_u32 s50, 0
v_mfma_f32_16x16x32_bf16 v[68:71], v[196:199], v[180:183], v[68:71]
s_cbranch_scc1 L_s3_3
s_waitcnt lgkmcnt(3)
v_mfma_f32_16x16x32_bf16 v[8:11], v[152:155], v[136:139], v[8:11]
ds_read_b128 v[168:171], v242 offset:0
s_add_u32 s51, s51, 32768
v_mfma_f32_16x16x32_bf16 v[24:27], v[152:155], v[140:143], v[24:27]
ds_read_b128 v[172:175], v242 offset:2048
s_and_b32 s51, s51, 131071
v_mfma_f32_16x16x32_bf16 v[40:43], v[152:155], v[144:147], v[40:43]
ds_read_b128 v[176:179], v242 offset:4096
v_add_u32 v241, s51, v232
v_mfma_f32_16x16x32_bf16 v[56:59], v[152:155], v[148:151], v[56:59]
ds_read_b128 v[180:183], v242 offset:6144
v_lshlrev_b32 v1, 4, v0
s_waitcnt lgkmcnt(6)
v_mfma_f32_16x16x32_bf16 v[12:15], v[156:159], v[136:139], v[12:15]
ds_read_b128 v[184:187], v243 offset:1024
v_add_u32 v242, s51, v233
v_mfma_f32_16x16x32_bf16 v[28:31], v[156:159], v[140:143], v[28:31]
ds_read_b128 v[188:191], v243 offset:3072
s_mul_i32 s57, s40, 56
v_mfma_f32_16x16x32_bf16 v[44:47], v[156:159], v[144:147], v[44:47]
ds_read_b128 v[192:195], v243 offset:5120
s_lshl_b32 s54, s41, 2
v_mfma_f32_16x16x32_bf16 v[60:63], v[156:159], v[148:151], v[60:63]
ds_read_b128 v[196:199], v243 offset:7168
s_add_u32 s57, s57, s54
s_waitcnt lgkmcnt(9)
v_mfma_f32_16x16x32_bf16 v[16:19], v[160:163], v[136:139], v[16:19]
v_add_u32 v243, s51, v238
s_lshl_b32 s54, s45, 1
v_mfma_f32_16x16x32_bf16 v[32:35], v[160:163], v[140:143], v[32:35]
s_add_u32 s57, s57, s54
s_lshl_b32 s57, s57, 13
v_mfma_f32_16x16x32_bf16 v[48:51], v[160:163], v[144:147], v[48:51]
s_lshl_b32 s54, s44, 12
s_add_u32 s57, s57, s54
v_mfma_f32_16x16x32_bf16 v[64:67], v[160:163], v[148:151], v[64:67]
s_add_u32 s57, s57, 9437184
s_add_u32 s58, s57, 8192
s_waitcnt lgkmcnt(8)
v_mfma_f32_16x16x32_bf16 v[20:23], v[164:167], v[136:139], v[20:23]
v_mfma_f32_16x16x32_bf16 v[36:39], v[164:167], v[140:143], v[36:39]
v_mfma_f32_16x16x32_bf16 v[52:55], v[164:167], v[144:147], v[52:55]
v_mfma_f32_16x16x32_bf16 v[68:71], v[164:167], v[148:151], v[68:71]
s_waitcnt lgkmcnt(3)
v_mfma_f32_16x16x32_bf16 v[8:11], v[184:187], v[168:171], v[8:11]
v_mfma_f32_16x16x32_bf16 v[24:27], v[184:187], v[172:175], v[24:27]
v_mfma_f32_16x16x32_bf16 v[40:43], v[184:187], v[176:179], v[40:43]
v_mfma_f32_16x16x32_bf16 v[56:59], v[184:187], v[180:183], v[56:59]
s_waitcnt lgkmcnt(0)
s_barrier
ds_read_b128 v[136:139], v241 offset:0
v_mfma_f32_16x16x32_bf16 v[12:15], v[188:191], v[168:171], v[12:15]
ds_read_b128 v[140:143], v241 offset:2048
v_mfma_f32_16x16x32_bf16 v[28:31], v[188:191], v[172:175], v[28:31]
ds_read_b128 v[144:147], v241 offset:4096
v_mfma_f32_16x16x32_bf16 v[44:47], v[188:191], v[176:179], v[44:47]
ds_read_b128 v[148:151], v241 offset:6144
v_mfma_f32_16x16x32_bf16 v[60:63], v[188:191], v[180:183], v[60:63]
ds_read_b128 v[152:155], v243 offset:0
v_mfma_f32_16x16x32_bf16 v[16:19], v[192:195], v[168:171], v[16:19]
ds_read_b128 v[156:159], v243 offset:2048
v_mfma_f32_16x16x32_bf16 v[32:35], v[192:195], v[172:175], v[32:35]
ds_read_b128 v[160:163], v243 offset:4096
v_mfma_f32_16x16x32_bf16 v[48:51], v[192:195], v[176:179], v[48:51]
ds_read_b128 v[164:167], v243 offset:6144
v_mfma_f32_16x16x32_bf16 v[64:67], v[192:195], v[180:183], v[64:67]
v_mfma_f32_16x16x32_bf16 v[20:23], v[196:199], v[168:171], v[20:23]
v_mfma_f32_16x16x32_bf16 v[36:39], v[196:199], v[172:175], v[36:39]
v_mfma_f32_16x16x32_bf16 v[52:55], v[196:199], v[176:179], v[52:55]
v_mfma_f32_16x16x32_bf16 v[68:71], v[196:199], v[180:183], v[68:71]
s_waitcnt lgkmcnt(3)
v_mfma_f32_16x16x32_bf16 v[8:11], v[152:155], v[136:139], v[8:11]
ds_read_b128 v[168:171], v242 offset:0

    v_lshlrev_b32 v238, 4, v0
v_mfma_f32_16x16x32_bf16 v[24:27], v[152:155], v[140:143], v[24:27]
ds_read_b128 v[172:175], v242 offset:2048
    v_and_b32 v2, 15, v0
v_mfma_f32_16x16x32_bf16 v[40:43], v[152:155], v[144:147], v[40:43]
ds_read_b128 v[176:179], v242 offset:4096
    v_lshrrev_b32 v3, 4, v0
v_mfma_f32_16x16x32_bf16 v[56:59], v[152:155], v[148:151], v[56:59]
ds_read_b128 v[180:183], v242 offset:6144
    v_lshrrev_b32 v4, 2, v2
s_waitcnt lgkmcnt(6)
v_mfma_f32_16x16x32_bf16 v[12:15], v[156:159], v[136:139], v[12:15]
ds_read_b128 v[184:187], v243 offset:1024
    v_and_b32 v5, 3, v0
v_mfma_f32_16x16x32_bf16 v[28:31], v[156:159], v[140:143], v[28:31]
ds_read_b128 v[188:191], v243 offset:3072
    v_lshl_add_u32 v6, v3, 2, v4
v_mfma_f32_16x16x32_bf16 v[44:47], v[156:159], v[144:147], v[44:47]
ds_read_b128 v[192:195], v243 offset:5120
    v_lshrrev_b32 v7, 1, v6
v_mfma_f32_16x16x32_bf16 v[60:63], v[156:159], v[148:151], v[60:63]
ds_read_b128 v[196:199], v243 offset:7168
    v_and_b32 v7, 3, v7
s_waitcnt lgkmcnt(9)
v_mfma_f32_16x16x32_bf16 v[16:19], v[160:163], v[136:139], v[16:19]
    v_lshlrev_b32 v7, 1, v7
    v_lshrrev_b32 v4, 1, v5
v_mfma_f32_16x16x32_bf16 v[32:35], v[160:163], v[140:143], v[32:35]
    v_xor_b32 v7, v7, v4
    s_lshl_b32 s53, s45, 2
v_mfma_f32_16x16x32_bf16 v[48:51], v[160:163], v[144:147], v[48:51]
    v_xor_b32 v7, s53, v7
    v_lshlrev_b32 v6, 7, v6
v_mfma_f32_16x16x32_bf16 v[64:67], v[160:163], v[148:151], v[64:67]
    v_and_b32 v5, 1, v5
    v_lshl_add_u32 v6, v5, 3, v6
s_waitcnt lgkmcnt(8)
v_mfma_f32_16x16x32_bf16 v[20:23], v[164:167], v[136:139], v[20:23]
    s_lshl_b32 s53, s44, 13
    s_add_u32 s53, s53, 16384
v_mfma_f32_16x16x32_bf16 v[36:39], v[164:167], v[140:143], v[36:39]
    v_add_u32 v6, s53, v6
    v_lshl_add_u32 v239, v7, 4, v6
v_mfma_f32_16x16x32_bf16 v[52:55], v[164:167], v[144:147], v[52:55]
    v_xor_b32 v7, 2, v7
    v_lshl_add_u32 v240, v7, 4, v6
v_mfma_f32_16x16x32_bf16 v[68:71], v[164:167], v[148:151], v[68:71]
s_add_u32 s51, s51, 32768
s_and_b32 s51, s51, 131071
s_waitcnt lgkmcnt(3)
v_mfma_f32_16x16x32_bf16 v[8:11], v[184:187], v[168:171], v[8:11]
v_mfma_f32_16x16x32_bf16 v[24:27], v[184:187], v[172:175], v[24:27]
v_mfma_f32_16x16x32_bf16 v[40:43], v[184:187], v[176:179], v[40:43]
v_mfma_f32_16x16x32_bf16 v[56:59], v[184:187], v[180:183], v[56:59]
s_waitcnt lgkmcnt(2)
v_mfma_f32_16x16x32_bf16 v[12:15], v[188:191], v[168:171], v[12:15]
v_mfma_f32_16x16x32_bf16 v[28:31], v[188:191], v[172:175], v[28:31]
v_mfma_f32_16x16x32_bf16 v[44:47], v[188:191], v[176:179], v[44:47]
v_mfma_f32_16x16x32_bf16 v[60:63], v[188:191], v[180:183], v[60:63]
s_waitcnt lgkmcnt(1)
v_mfma_f32_16x16x32_bf16 v[16:19], v[192:195], v[168:171], v[16:19]
v_mfma_f32_16x16x32_bf16 v[32:35], v[192:195], v[172:175], v[32:35]
v_mfma_f32_16x16x32_bf16 v[48:51], v[192:195], v[176:179], v[48:51]
v_mfma_f32_16x16x32_bf16 v[64:67], v[192:195], v[180:183], v[64:67]
s_waitcnt lgkmcnt(0)
v_mfma_f32_16x16x32_bf16 v[20:23], v[196:199], v[168:171], v[20:23]
v_mfma_f32_16x16x32_bf16 v[36:39], v[196:199], v[172:175], v[36:39]
v_mfma_f32_16x16x32_bf16 v[52:55], v[196:199], v[176:179], v[52:55]
v_mfma_f32_16x16x32_bf16 v[68:71], v[196:199], v[180:183], v[68:71]
s_nop 7
v_pk_mul_f32 v[8:9], v[8:9], v[72:73]
v_pk_mul_f32 v[10:11], v[10:11], v[74:75]
v_pk_mul_f32 v[12:13], v[12:13], v[76:77]
v_pk_mul_f32 v[14:15], v[14:15], v[78:79]
v_cvt_pk_bf16_f32 v168, v8, v9
v_cvt_pk_bf16_f32 v169, v10, v11
v_cvt_pk_bf16_f32 v170, v12, v13
v_cvt_pk_bf16_f32 v171, v14, v15
buffer_store_dwordx4 v[168:171], v1, s[16:19], s57 offen offset:0 sc1
v_pk_mul_f32 v[24:25], v[24:25], v[88:89]
v_pk_mul_f32 v[26:27], v[26:27], v[90:91]
v_pk_mul_f32 v[28:29], v[28:29], v[92:93]
v_pk_mul_f32 v[30:31], v[30:31], v[94:95]
v_cvt_pk_bf16_f32 v172, v24, v25
v_cvt_pk_bf16_f32 v173, v26, v27
v_cvt_pk_bf16_f32 v174, v28, v29
v_cvt_pk_bf16_f32 v175, v30, v31
buffer_store_dwordx4 v[172:175], v1, s[16:19], s57 offen offset:1024 sc1
v_pk_mul_f32 v[40:41], v[40:41], v[104:105]
v_pk_mul_f32 v[42:43], v[42:43], v[106:107]
v_pk_mul_f32 v[44:45], v[44:45], v[108:109]
v_pk_mul_f32 v[46:47], v[46:47], v[110:111]
v_cvt_pk_bf16_f32 v176, v40, v41
v_cvt_pk_bf16_f32 v177, v42, v43
v_cvt_pk_bf16_f32 v178, v44, v45
v_cvt_pk_bf16_f32 v179, v46, v47
buffer_store_dwordx4 v[176:179], v1, s[16:19], s57 offen offset:2048 sc1
v_pk_mul_f32 v[56:57], v[56:57], v[120:121]
v_pk_mul_f32 v[58:59], v[58:59], v[122:123]
v_pk_mul_f32 v[60:61], v[60:61], v[124:125]
v_pk_mul_f32 v[62:63], v[62:63], v[126:127]
v_cvt_pk_bf16_f32 v180, v56, v57
v_cvt_pk_bf16_f32 v181, v58, v59
v_cvt_pk_bf16_f32 v182, v60, v61
v_cvt_pk_bf16_f32 v183, v62, v63
buffer_store_dwordx4 v[180:183], v1, s[16:19], s57 offen offset:3072 sc1
v_pk_mul_f32 v[16:17], v[16:17], v[80:81]
v_pk_mul_f32 v[18:19], v[18:19], v[82:83]
v_pk_mul_f32 v[20:21], v[20:21], v[84:85]
v_pk_mul_f32 v[22:23], v[22:23], v[86:87]
v_cvt_pk_bf16_f32 v184, v16, v17
v_cvt_pk_bf16_f32 v185, v18, v19
v_cvt_pk_bf16_f32 v186, v20, v21
v_cvt_pk_bf16_f32 v187, v22, v23
buffer_store_dwordx4 v[184:187], v1, s[16:19], s58 offen offset:0 sc1
v_pk_mul_f32 v[32:33], v[32:33], v[96:97]
v_pk_mul_f32 v[34:35], v[34:35], v[98:99]
v_pk_mul_f32 v[36:37], v[36:37], v[100:101]
v_pk_mul_f32 v[38:39], v[38:39], v[102:103]
v_cvt_pk_bf16_f32 v188, v32, v33
v_cvt_pk_bf16_f32 v189, v34, v35
v_cvt_pk_bf16_f32 v190, v36, v37
v_cvt_pk_bf16_f32 v191, v38, v39
buffer_store_dwordx4 v[188:191], v1, s[16:19], s58 offen offset:1024 sc1
v_pk_mul_f32 v[48:49], v[48:49], v[112:113]
v_pk_mul_f32 v[50:51], v[50:51], v[114:115]
v_pk_mul_f32 v[52:53], v[52:53], v[116:117]
v_pk_mul_f32 v[54:55], v[54:55], v[118:119]
v_cvt_pk_bf16_f32 v192, v48, v49
v_cvt_pk_bf16_f32 v193, v50, v51
v_cvt_pk_bf16_f32 v194, v52, v53
v_cvt_pk_bf16_f32 v195, v54, v55
buffer_store_dwordx4 v[192:195], v1, s[16:19], s58 offen offset:2048 sc1
v_pk_mul_f32 v[64:65], v[64:65], v[128:129]
v_pk_mul_f32 v[66:67], v[66:67], v[130:131]
v_pk_mul_f32 v[68:69], v[68:69], v[132:133]
v_pk_mul_f32 v[70:71], v[70:71], v[134:135]
v_cvt_pk_bf16_f32 v196, v64, v65
v_cvt_pk_bf16_f32 v197, v66, v67
v_cvt_pk_bf16_f32 v198, v68, v69
v_cvt_pk_bf16_f32 v199, v70, v71
buffer_store_dwordx4 v[196:199], v1, s[16:19], s58 offen offset:3072 sc1
L_s4_entry:
v_add_u32 v241, s51, v238
v_add_u32 v242, s51, v239
v_add_u32 v243, s51, v240
s_waitcnt vmcnt(0)
s_barrier
s_barrier
ds_read_b128 v[136:139], v241 offset:0
ds_read_b128 v[140:143], v241 offset:1024
ds_read_b128 v[144:147], v241 offset:2048
ds_read_b128 v[148:151], v241 offset:3072
ds_read_b64_tr_b16 v[152:153], v242 offset:0
ds_read_b64_tr_b16 v[154:155], v242 offset:2048
ds_read_b64_tr_b16 v[156:157], v243 offset:0
ds_read_b64_tr_b16 v[158:159], v243 offset:2048
s_waitcnt lgkmcnt(2)
v_mfma_f32_16x16x32_bf16 v[72:75], v[152:155], v[136:139], 0
ds_read_b128 v[168:171], v241 offset:8192
ds_read_b128 v[172:175], v241 offset:9216
s_add_u32 s51, s51, 32768
v_mfma_f32_16x16x32_bf16 v[80:83], v[152:155], v[140:143], 0
ds_read_b128 v[176:179], v241 offset:10240
s_and_b32 s51, s51, 131071
v_mfma_f32_16x16x32_bf16 v[88:91], v[152:155], v[144:147], 0
ds_read_b128 v[180:183], v241 offset:11264
v_mfma_f32_16x16x32_bf16 v[96:99], v[152:155], v[148:151], 0
ds_read_b64_tr_b16 v[184:185], v242 offset:4096
s_waitcnt lgkmcnt(5)
v_mfma_f32_16x16x32_bf16 v[76:79], v[156:159], v[136:139], 0
ds_read_b64_tr_b16 v[186:187], v242 offset:6144
v_add_u32 v241, s51, v238
v_mfma_f32_16x16x32_bf16 v[84:87], v[156:159], v[140:143], 0
ds_read_b64_tr_b16 v[188:189], v243 offset:4096
v_mfma_f32_16x16x32_bf16 v[92:95], v[156:159], v[144:147], 0
ds_read_b64_tr_b16 v[190:191], v243 offset:6144
v_add_u32 v242, s51, v239
v_mfma_f32_16x16x32_bf16 v[100:103], v[156:159], v[148:151], 0
v_add_u32 v243, s51, v240
s_waitcnt lgkmcnt(2)
v_mfma_f32_16x16x32_bf16 v[72:75], v[184:187], v[168:171], v[72:75]
v_mfma_f32_16x16x32_bf16 v[80:83], v[184:187], v[172:175], v[80:83]
s_waitcnt lgkmcnt(0)
s_barrier
ds_read_b128 v[136:139], v241 offset:0
ds_read_b128 v[140:143], v241 offset:1024
v_mfma_f32_16x16x32_bf16 v[88:91], v[184:187], v[176:179], v[88:91]
ds_read_b128 v[144:147], v241 offset:2048
v_mfma_f32_16x16x32_bf16 v[96:99], v[184:187], v[180:183], v[96:99]
ds_read_b128 v[148:151], v241 offset:3072
v_mfma_f32_16x16x32_bf16 v[76:79], v[188:191], v[168:171], v[76:79]
ds_read_b64_tr_b16 v[152:153], v242 offset:0
v_mfma_f32_16x16x32_bf16 v[84:87], v[188:191], v[172:175], v[84:87]
ds_read_b64_tr_b16 v[154:155], v242 offset:2048
v_mfma_f32_16x16x32_bf16 v[92:95], v[188:191], v[176:179], v[92:95]
ds_read_b64_tr_b16 v[156:157], v243 offset:0
v_mfma_f32_16x16x32_bf16 v[100:103], v[188:191], v[180:183], v[100:103]
ds_read_b64_tr_b16 v[158:159], v243 offset:2048
s_waitcnt lgkmcnt(2)
v_mfma_f32_16x16x32_bf16 v[72:75], v[152:155], v[136:139], v[72:75]
ds_read_b128 v[168:171], v241 offset:8192
ds_read_b128 v[172:175], v241 offset:9216
v_mfma_f32_16x16x32_bf16 v[80:83], v[152:155], v[140:143], v[80:83]
ds_read_b128 v[176:179], v241 offset:10240
v_mfma_f32_16x16x32_bf16 v[88:91], v[152:155], v[144:147], v[88:91]
ds_read_b128 v[180:183], v241 offset:11264
v_mfma_f32_16x16x32_bf16 v[96:99], v[152:155], v[148:151], v[96:99]
ds_read_b64_tr_b16 v[184:185], v242 offset:4096
s_waitcnt lgkmcnt(5)
v_mfma_f32_16x16x32_bf16 v[76:79], v[156:159], v[136:139], v[76:79]
ds_read_b64_tr_b16 v[186:187], v242 offset:6144
v_mfma_f32_16x16x32_bf16 v[84:87], v[156:159], v[140:143], v[84:87]
ds_read_b64_tr_b16 v[188:189], v243 offset:4096
v_mfma_f32_16x16x32_bf16 v[92:95], v[156:159], v[144:147], v[92:95]
ds_read_b64_tr_b16 v[190:191], v243 offset:6144
v_mfma_f32_16x16x32_bf16 v[100:103], v[156:159], v[148:151], v[100:103]
s_waitcnt lgkmcnt(2)
v_mfma_f32_16x16x32_bf16 v[72:75], v[184:187], v[168:171], v[72:75]
v_mfma_f32_16x16x32_bf16 v[80:83], v[184:187], v[172:175], v[80:83]
v_mfma_f32_16x16x32_bf16 v[88:91], v[184:187], v[176:179], v[88:91]
v_mfma_f32_16x16x32_bf16 v[96:99], v[184:187], v[180:183], v[96:99]
s_waitcnt lgkmcnt(0)
v_mfma_f32_16x16x32_bf16 v[76:79], v[188:191], v[168:171], v[76:79]
v_mfma_f32_16x16x32_bf16 v[84:87], v[188:191], v[172:175], v[84:87]
v_mfma_f32_16x16x32_bf16 v[92:95], v[188:191], v[176:179], v[92:95]
v_mfma_f32_16x16x32_bf16 v[100:103], v[188:191], v[180:183], v[100:103]
s_mov_b32 s51, 0
s_mov_b32 s69, 0

    s_lshl_b32 s53, s44, 12
    s_lshl_b32 s54, s44, 13
    s_sub_u32 s54, s54, 49152
    v_add_u32 v238, s53, v238
    v_subrev_u32 v239, s54, v239
    v_subrev_u32 v240, s54, v240
v_add_u32 v241, s51, v238
v_add_u32 v242, s69, v239
v_add_u32 v243, s69, v240
v_and_b32 v2, 15, v0
s_lshl_b32 s53, s44, 8
s_add_u32 s53, s53, 134656
v_lshl_add_u32 v2, v2, 2, s53
ds_read_b32 v251, v2 offset:0
ds_read_b32 v252, v2 offset:64
ds_read_b32 v253, v2 offset:128
ds_read_b32 v254, v2 offset:192
s_waitcnt lgkmcnt(0)
v_mul_f32 v72, v72, v251
v_mul_f32 v73, v73, v251
v_mul_f32 v74, v74, v251
v_mul_f32 v75, v75, v251
v_mul_f32 v76, v76, v251
v_mul_f32 v77, v77, v251
v_mul_f32 v78, v78, v251
v_mul_f32 v79, v79, v251
v_sub_f32 v8, 1.0, v251
v_sub_f32 v9, 1.0, v251
v_mul_f32 v80, v80, v252
v_mul_f32 v81, v81, v252
v_mul_f32 v82, v82, v252
v_mul_f32 v83, v83, v252
v_mul_f32 v84, v84, v252
v_mul_f32 v85, v85, v252
v_mul_f32 v86, v86, v252
v_mul_f32 v87, v87, v252
v_sub_f32 v10, 1.0, v252
v_sub_f32 v11, 1.0, v252
v_mul_f32 v88, v88, v253
v_mul_f32 v89, v89, v253
v_mul_f32 v90, v90, v253
v_mul_f32 v91, v91, v253
v_mul_f32 v92, v92, v253
v_mul_f32 v93, v93, v253
v_mul_f32 v94, v94, v253
v_mul_f32 v95, v95, v253
v_sub_f32 v12, 1.0, v253
v_sub_f32 v13, 1.0, v253
v_mul_f32 v96, v96, v254
v_mul_f32 v97, v97, v254
v_mul_f32 v98, v98, v254
v_mul_f32 v99, v99, v254
v_mul_f32 v100, v100, v254
v_mul_f32 v101, v101, v254
v_mul_f32 v102, v102, v254
v_mul_f32 v103, v103, v254
v_sub_f32 v14, 1.0, v254
v_sub_f32 v15, 1.0, v254

    v_and_b32 v2, 15, v0
    v_bfe_u32 v3, v0, 4, 1
    v_lshrrev_b32 v4, 5, v0
    v_lshl_add_u32 v3, v3, 1, v4
    s_lshl_b32 s53, s45, 2
    v_or_b32 v3, s53, v3
    v_and_b32 v4, 7, v0
    v_xor_b32 v3, v3, v4
    v_lshlrev_b32 v3, 4, v3
    v_lshl_add_u32 v3, v2, 7, v3
    s_lshl_b32 s53, s44, 13
    v_add_u32 v5, s53, v3
    v_lshrrev_b32 v2, 3, v0
    v_xor_b32 v3, v4, v2
    v_lshlrev_b32 v3, 4, v3
    v_lshl_add_u32 v3, v2, 7, v3
    s_lshl_b32 s54, s45, 12
    s_add_u32 s53, s53, s54
    v_add_u32 v6, s53, v3
    v_lshlrev_b32 v2, 16, v2
    v_lshl_add_u32 v1, v4, 4, v2
    s_lshl_b32 s53, s40, 1
    s_add_u32 s53, s53, s44
    s_lshl_b32 s53, s53, 11
    s_lshl_b32 s54, s45, 21
    s_add_u32 s53, s53, s54
    s_lshl_b32 s54, s47, 7
    s_add_u32 s53, s53, s54
    s_add_u32 s54, s53, 524288
    s_add_u32 s55, s53, 1048576
    s_add_u32 s56, s53, 1572864
s_barrier
ds_read_b128 v[136:139], v241 offset:0
ds_read_b128 v[140:143], v241 offset:1024
ds_read_b128 v[144:147], v241 offset:2048
ds_read_b128 v[148:151], v241 offset:3072
ds_read_b64_tr_b16 v[152:153], v242 offset:0
ds_read_b64_tr_b16 v[154:155], v242 offset:2048
ds_read_b64_tr_b16 v[156:157], v243 offset:0
ds_read_b64_tr_b16 v[158:159], v243 offset:2048
s_mov_b32 s50, 27
.p2align 3
L_s5_4:
s_waitcnt lgkmcnt(2)
v_mfma_f32_16x16x32_bf16 v[200:203], v[152:155], v[136:139], v[200:203]
ds_read_b128 v[168:171], v241 offset:8192
ds_read_b128 v[172:175], v241 offset:9216
s_add_u32 s51, s51, 16384
s_and_b32 s51, s51, 65535
v_mfma_f32_16x16x32_bf16 v[208:211], v[152:155], v[140:143], v[208:211]
ds_read_b128 v[176:179], v241 offset:10240
s_add_u32 s69, s69, 8192
s_cmp_eq_u32 s69, 98304
s_cselect_b32 s69, 0, s69
v_mfma_f32_16x16x32_bf16 v[216:219], v[152:155], v[144:147], v[216:219]
ds_read_b128 v[180:183], v241 offset:11264
v_mfma_f32_16x16x32_bf16 v[224:227], v[152:155], v[148:151], v[224:227]
ds_read_b64_tr_b16 v[184:185], v242 offset:4096
s_waitcnt lgkmcnt(5)
v_mfma_f32_16x16x32_bf16 v[204:207], v[156:159], v[136:139], v[204:207]
ds_read_b64_tr_b16 v[186:187], v242 offset:6144
v_add_u32 v241, s51, v238
v_mfma_f32_16x16x32_bf16 v[212:215], v[156:159], v[140:143], v[212:215]
ds_read_b64_tr_b16 v[188:189], v243 offset:4096
v_mfma_f32_16x16x32_bf16 v[220:223], v[156:159], v[144:147], v[220:223]
ds_read_b64_tr_b16 v[190:191], v243 offset:6144
v_add_u32 v242, s69, v239
v_mfma_f32_16x16x32_bf16 v[228:231], v[156:159], v[148:151], v[228:231]
v_add_u32 v243, s69, v240
s_waitcnt lgkmcnt(2)
v_mfma_f32_16x16x32_bf16 v[200:203], v[184:187], v[168:171], v[200:203]
v_mfma_f32_16x16x32_bf16 v[208:211], v[184:187], v[172:175], v[208:211]
s_waitcnt lgkmcnt(0)
s_barrier
ds_read_b128 v[136:139], v241 offset:0
ds_read_b128 v[140:143], v241 offset:1024
v_mfma_f32_16x16x32_bf16 v[216:219], v[184:187], v[176:179], v[216:219]
ds_read_b128 v[144:147], v241 offset:2048
v_mfma_f32_16x16x32_bf16 v[224:227], v[184:187], v[180:183], v[224:227]
ds_read_b128 v[148:151], v241 offset:3072
v_mfma_f32_16x16x32_bf16 v[204:207], v[188:191], v[168:171], v[204:207]
ds_read_b64_tr_b16 v[152:153], v242 offset:0
v_mfma_f32_16x16x32_bf16 v[212:215], v[188:191], v[172:175], v[212:215]
s_sub_u32 s50, s50, 1
ds_read_b64_tr_b16 v[154:155], v242 offset:2048
v_mfma_f32_16x16x32_bf16 v[220:223], v[188:191], v[176:179], v[220:223]
s_cmp_lg_u32 s50, 0
ds_read_b64_tr_b16 v[156:157], v243 offset:0
v_mfma_f32_16x16x32_bf16 v[228:231], v[188:191], v[180:183], v[228:231]
ds_read_b64_tr_b16 v[158:159], v243 offset:2048
s_cbranch_scc1 L_s5_4
s_waitcnt lgkmcnt(2)
v_mfma_f32_16x16x32_bf16 v[200:203], v[152:155], v[136:139], v[200:203]
ds_read_b128 v[168:171], v241 offset:8192
ds_read_b128 v[172:175], v241 offset:9216
v_mfma_f32_16x16x32_bf16 v[208:211], v[152:155], v[140:143], v[208:211]
ds_read_b128 v[176:179], v241 offset:10240
v_mfma_f32_16x16x32_bf16 v[216:219], v[152:155], v[144:147], v[216:219]
ds_read_b128 v[180:183], v241 offset:11264
v_mfma_f32_16x16x32_bf16 v[224:227], v[152:155], v[148:151], v[224:227]
ds_read_b64_tr_b16 v[184:185], v242 offset:4096
s_waitcnt lgkmcnt(5)
v_mfma_f32_16x16x32_bf16 v[204:207], v[156:159], v[136:139], v[204:207]
ds_read_b64_tr_b16 v[186:187], v242 offset:6144
v_mfma_f32_16x16x32_bf16 v[212:215], v[156:159], v[140:143], v[212:215]
ds_read_b64_tr_b16 v[188:189], v243 offset:4096
v_mfma_f32_16x16x32_bf16 v[220:223], v[156:159], v[144:147], v[220:223]
ds_read_b64_tr_b16 v[190:191], v243 offset:6144
v_mfma_f32_16x16x32_bf16 v[228:231], v[156:159], v[148:151], v[228:231]
s_waitcnt lgkmcnt(2)
v_mfma_f32_16x16x32_bf16 v[200:203], v[184:187], v[168:171], v[200:203]
v_mfma_f32_16x16x32_bf16 v[208:211], v[184:187], v[172:175], v[208:211]
v_mfma_f32_16x16x32_bf16 v[216:219], v[184:187], v[176:179], v[216:219]
v_mfma_f32_16x16x32_bf16 v[224:227], v[184:187], v[180:183], v[224:227]
s_waitcnt lgkmcnt(0)
v_mfma_f32_16x16x32_bf16 v[204:207], v[188:191], v[168:171], v[204:207]
v_mfma_f32_16x16x32_bf16 v[212:215], v[188:191], v[172:175], v[212:215]
v_mfma_f32_16x16x32_bf16 v[220:223], v[188:191], v[176:179], v[220:223]
v_mfma_f32_16x16x32_bf16 v[228:231], v[188:191], v[180:183], v[228:231]
s_nop 7
v_pk_fma_f32 v[200:201], v[200:201], v[8:9], v[72:73]
v_pk_fma_f32 v[202:203], v[202:203], v[8:9], v[74:75]
v_pk_fma_f32 v[204:205], v[204:205], v[8:9], v[76:77]
v_pk_fma_f32 v[206:207], v[206:207], v[8:9], v[78:79]
v_cvt_pk_bf16_f32 v168, v200, v201
v_cvt_pk_bf16_f32 v169, v202, v203
v_cvt_pk_bf16_f32 v170, v204, v205
v_cvt_pk_bf16_f32 v171, v206, v207
v_pk_fma_f32 v[208:209], v[208:209], v[10:11], v[80:81]
v_pk_fma_f32 v[210:211], v[210:211], v[10:11], v[82:83]
v_pk_fma_f32 v[212:213], v[212:213], v[10:11], v[84:85]
v_pk_fma_f32 v[214:215], v[214:215], v[10:11], v[86:87]
v_cvt_pk_bf16_f32 v172, v208, v209
v_cvt_pk_bf16_f32 v173, v210, v211
v_cvt_pk_bf16_f32 v174, v212, v213
v_cvt_pk_bf16_f32 v175, v214, v215
v_permlane16_swap_b32 v168, v170
v_permlane16_swap_b32 v169, v171
ds_write_b128 v5, v[168:171] offset:0
v_pk_fma_f32 v[216:217], v[216:217], v[12:13], v[88:89]
v_pk_fma_f32 v[218:219], v[218:219], v[12:13], v[90:91]
v_pk_fma_f32 v[220:221], v[220:221], v[12:13], v[92:93]
v_pk_fma_f32 v[222:223], v[222:223], v[12:13], v[94:95]
v_cvt_pk_bf16_f32 v176, v216, v217
v_cvt_pk_bf16_f32 v177, v218, v219
v_cvt_pk_bf16_f32 v178, v220, v221
v_cvt_pk_bf16_f32 v179, v222, v223
v_permlane16_swap_b32 v172, v174
v_permlane16_swap_b32 v173, v175
ds_write_b128 v5, v[172:175] offset:2048
v_pk_fma_f32 v[224:225], v[224:225], v[14:15], v[96:97]
v_pk_fma_f32 v[226:227], v[226:227], v[14:15], v[98:99]
v_pk_fma_f32 v[228:229], v[228:229], v[14:15], v[100:101]
v_pk_fma_f32 v[230:231], v[230:231], v[14:15], v[102:103]
v_cvt_pk_bf16_f32 v180, v224, v225
v_cvt_pk_bf16_f32 v181, v226, v227
v_cvt_pk_bf16_f32 v182, v228, v229
v_cvt_pk_bf16_f32 v183, v230, v231
v_permlane16_swap_b32 v176, v178
v_permlane16_swap_b32 v177, v179
ds_write_b128 v5, v[176:179] offset:4096
v_permlane16_swap_b32 v180, v182
v_permlane16_swap_b32 v181, v183
ds_write_b128 v5, v[180:183] offset:6144
s_waitcnt lgkmcnt(0)
s_barrier
ds_read_b128 v[184:187], v6 offset:0
ds_read_b128 v[188:191], v6 offset:1024
ds_read_b128 v[192:195], v6 offset:2048
ds_read_b128 v[196:199], v6 offset:3072
s_waitcnt lgkmcnt(3)
buffer_store_dwordx4 v[184:187], v1, s[32:35], s53 offen sc1
s_waitcnt lgkmcnt(2)
buffer_store_dwordx4 v[188:191], v1, s[32:35], s54 offen sc1
s_waitcnt lgkmcnt(1)
buffer_store_dwordx4 v[192:195], v1, s[32:35], s55 offen sc1
s_waitcnt lgkmcnt(0)
buffer_store_dwordx4 v[196:199], v1, s[32:35], s56 offen sc1
s_endpgm
L_loader:
s_setprio 3
s_sub_u32 s46, s43, 4
s_and_b32 s3, s2, 1
s_lshl_b32 s3, s3, 3
s_bfe_u32 s6, s2, 0x10002
s_lshl_b32 s6, s6, 1
s_add_u32 s6, s6, s2
s_and_b32 s6, s6, 3
s_lshl_b32 s6, s6, 3

    v_and_b32 v3, 7, v0
    v_lshrrev_b32 v4, 4, v0
    v_xor_b32 v3, v3, v4

    v_lshrrev_b32 v2, 5, v0
    v_bfe_u32 v5, v0, 3, 2
    v_lshl_add_u32 v2, v2, 3, v5
    v_lshlrev_b32 v2, 11, v2
    s_lshl_b32 s53, s40, 18
    s_lshl_b32 s54, s46, 16
    s_add_u32 s53, s53, s54
    v_add_u32 v2, s53, v2
    v_lshl_add_u32 v8, v3, 4, v2
    v_xor_b32 v5, 64, v8
    v_add_u32 v9, 31744, v5
    v_add_u32 v10, 6144, v8
    v_add_u32 v11, 6144, v9
    v_mul_u32_u24 v6, 7168, v4
    v_and_b32 v5, 15, v0
    v_lshlrev_b32 v4, 1, v4
    v_xor_b32 v5, v5, v4
    s_lshl_b32 s53, s41, 8
    s_mul_i32 s54, s46, 114688
    s_add_u32 s53, s53, s54
    v_add_u32 v6, s53, v6
    v_lshl_add_u32 v12, v5, 4, v6
    v_add_u32 v13, 27648, v12
    v_xor_b32 v5, 8, v5
    v_lshl_add_u32 v5, v5, 4, v6
    v_add_u32 v14, 55296, v5
    v_add_u32 v15, 82944, v5
    s_lshl_b32 s63, s46, 12
    s_add_u32 s64, s63, 16384
s_mov_b32 s52, 0
s_mov_b32 s51, 0
s_sub_u32 s53, s52, 1
s_and_b32 s7, s53, 3
s_cmp_eq_u32 s7, s42
s_cselect_b32 s7, 4, 0
s_add_u32 s53, s53, s7
s_add_u32 s7, s42, 13
s_cmp_ge_u32 s52, s7
s_cselect_b32 s53, s52, s53
s_cmp_eq_u32 s52, 0
s_cselect_b32 s53, s42, s53
s_add_u32 s53, s53, s3
s_and_b32 s53, s53, 15
s_lshl_b32 s59, s53, 7
s_mul_i32 s60, s53, 458752
s_add_u32 s60, s60, 3584
s_add_u32 s61, s51, s63
s_add_u32 s62, s51, s64
s_waitcnt lgkmcnt(0)
s_mov_b32 m0, s61
s_add_u32 s52, s52, 1
buffer_load_dwordx4 v8, s[8:11], s59 offen lds
s_add_u32 s51, s51, 32768
s_and_b32 s51, s51, 131071
s_sub_u32 s53, s52, 1
buffer_load_dwordx4 v9, s[8:11], s59 offen offset:1024 lds
s_and_b32 s7, s53, 3
s_cmp_eq_u32 s7, s42
s_cselect_b32 s7, 4, 0
s_add_u32 s53, s53, s7
buffer_load_dwordx4 v10, s[8:11], s59 offen offset:2048 lds
s_add_u32 s7, s42, 13
s_cmp_ge_u32 s52, s7
s_cselect_b32 s53, s52, s53
s_cmp_eq_u32 s52, 0
s_cselect_b32 s53, s42, s53
s_add_u32 s53, s53, s3
buffer_load_dwordx4 v11, s[8:11], s59 offen offset:3072 lds
s_and_b32 s53, s53, 15
s_add_u32 s61, s51, s63
s_mov_b32 m0, s62
s_lshl_b32 s59, s53, 7
buffer_load_dwordx4 v12, s[12:15], s60 offen lds
s_add_u32 s62, s51, s64
buffer_load_dwordx4 v13, s[12:15], s60 offen offset:1024 lds
s_mul_i32 s55, s53, 458752
buffer_load_dwordx4 v14, s[12:15], s60 offen offset:2048 lds
s_add_u32 s55, s55, 3584
buffer_load_dwordx4 v15, s[12:15], s60 offen offset:3072 lds
s_mov_b32 s60, s55
s_mov_b32 m0, s61
s_add_u32 s52, s52, 1
buffer_load_dwordx4 v8, s[8:11], s59 offen lds
s_add_u32 s51, s51, 32768
s_and_b32 s51, s51, 131071
s_sub_u32 s53, s52, 1
buffer_load_dwordx4 v9, s[8:11], s59 offen offset:1024 lds
s_and_b32 s7, s53, 3
s_cmp_eq_u32 s7, s42
s_cselect_b32 s7, 4, 0
s_add_u32 s53, s53, s7
buffer_load_dwordx4 v10, s[8:11], s59 offen offset:2048 lds
s_add_u32 s7, s42, 13
s_cmp_ge_u32 s52, s7
s_cselect_b32 s53, s52, s53
s_cmp_eq_u32 s52, 0
s_cselect_b32 s53, s42, s53
s_add_u32 s53, s53, s3
buffer_load_dwordx4 v11, s[8:11], s59 offen offset:3072 lds
s_and_b32 s53, s53, 15
s_add_u32 s61, s51, s63
s_mov_b32 m0, s62
s_lshl_b32 s59, s53, 7
buffer_load_dwordx4 v12, s[12:15], s60 offen lds
s_add_u32 s62, s51, s64
s_waitcnt vmcnt(5)
s_barrier
buffer_load_dwordx4 v13, s[12:15], s60 offen offset:1024 lds
s_mul_i32 s55, s53, 458752
buffer_load_dwordx4 v14, s[12:15], s60 offen offset:2048 lds
s_add_u32 s55, s55, 3584
buffer_load_dwordx4 v15, s[12:15], s60 offen offset:3072 lds
s_mov_b32 s60, s55
s_mov_b32 m0, s61
s_add_u32 s52, s52, 1
buffer_load_dwordx4 v8, s[8:11], s59 offen lds
s_add_u32 s51, s51, 32768
s_and_b32 s51, s51, 131071
s_sub_u32 s53, s52, 1
buffer_load_dwordx4 v9, s[8:11], s59 offen offset:1024 lds
s_and_b32 s7, s53, 3
s_cmp_eq_u32 s7, s42
s_cselect_b32 s7, 4, 0
s_add_u32 s53, s53, s7
buffer_load_dwordx4 v10, s[8:11], s59 offen offset:2048 lds
s_add_u32 s7, s42, 13
s_cmp_ge_u32 s52, s7
s_cselect_b32 s53, s52, s53
s_cmp_eq_u32 s52, 0
s_cselect_b32 s53, s42, s53
s_add_u32 s53, s53, s3
buffer_load_dwordx4 v11, s[8:11], s59 offen offset:3072 lds
s_and_b32 s53, s53, 15
s_add_u32 s61, s51, s63
s_mov_b32 m0, s62
s_lshl_b32 s59, s53, 7
buffer_load_dwordx4 v12, s[12:15], s60 offen lds
s_add_u32 s62, s51, s64
buffer_load_dwordx4 v13, s[12:15], s60 offen offset:1024 lds
s_mul_i32 s55, s53, 458752
buffer_load_dwordx4 v14, s[12:15], s60 offen offset:2048 lds
s_add_u32 s55, s55, 3584
buffer_load_dwordx4 v15, s[12:15], s60 offen offset:3072 lds
s_mov_b32 s60, s55
s_waitcnt vmcnt(8)
s_barrier
s_mov_b32 m0, s61
s_add_u32 s52, s52, 1
buffer_load_dwordx4 v8, s[8:11], s59 offen lds
s_add_u32 s51, s51, 32768
s_and_b32 s51, s51, 131071
s_sub_u32 s53, s52, 1
buffer_load_dwordx4 v9, s[8:11], s59 offen offset:1024 lds
s_and_b32 s7, s53, 3
s_cmp_eq_u32 s7, s42
s_cselect_b32 s7, 4, 0
s_add_u32 s53, s53, s7
buffer_load_dwordx4 v10, s[8:11], s59 offen offset:2048 lds
s_add_u32 s7, s42, 13
s_cmp_ge_u32 s52, s7
s_cselect_b32 s53, s52, s53
s_cmp_eq_u32 s52, 0
s_cselect_b32 s53, s42, s53
s_add_u32 s53, s53, s3
buffer_load_dwordx4 v11, s[8:11], s59 offen offset:3072 lds
s_and_b32 s53, s53, 15
s_add_u32 s61, s51, s63
s_mov_b32 m0, s62
s_lshl_b32 s59, s53, 7
buffer_load_dwordx4 v12, s[12:15], s60 offen lds
s_add_u32 s62, s51, s64
buffer_load_dwordx4 v13, s[12:15], s60 offen offset:1024 lds
s_mul_i32 s55, s53, 458752
buffer_load_dwordx4 v14, s[12:15], s60 offen offset:2048 lds
s_add_u32 s55, s55, 3584
buffer_load_dwordx4 v15, s[12:15], s60 offen offset:3072 lds
s_mov_b32 s60, s55
s_setprio 0
s_mov_b32 s38, 256
s_mov_b32 m0, s61
s_add_u32 s52, s52, 1
buffer_load_dwordx4 v8, s[8:11], s59 offen lds
s_add_u32 s51, s51, 32768
s_and_b32 s51, s51, 131071
s_sub_u32 s53, s52, 1
    v_and_b32 v3, 7, v0
    v_lshrrev_b32 v4, 4, v0
    v_xor_b32 v3, v3, v4
    v_lshrrev_b32 v2, 3, v0
buffer_load_dwordx4 v9, s[8:11], s59 offen offset:1024 lds
s_and_b32 s7, s53, 3
s_cmp_eq_u32 s7, s42
s_cselect_b32 s7, 4, 0
s_add_u32 s53, s53, s7
    v_lshlrev_b32 v2, 5, v2
    s_lshl_b32 s57, s40, 1
    s_lshr_b32 s58, s46, 1
    s_add_u32 s57, s57, s58
buffer_load_dwordx4 v10, s[8:11], s59 offen offset:2048 lds
s_add_u32 s7, s42, 13
s_cmp_ge_u32 s52, s7
s_cselect_b32 s53, s52, s53
s_cmp_eq_u32 s52, 0
s_cselect_b32 s53, s42, s53
s_add_u32 s53, s53, s3
    s_and_b32 s58, s46, 1
    s_lshl_b32 s58, s58, 10
    s_add_u32 s57, s57, s58
    v_add_u32 v2, s57, v2
s_waitcnt vmcnt(11)
s_barrier
buffer_load_dwordx4 v11, s[8:11], s59 offen offset:3072 lds
s_and_b32 s53, s53, 15
s_add_u32 s61, s51, s63
    v_lshlrev_b32 v3, 4, v3
    v_lshl_add_u32 v16, v2, 11, v3
    v_xor_b32 v5, 64, v16
    v_add_u32 v17, 523264, v5
s_mov_b32 m0, s62
s_lshl_b32 s59, s53, 7
buffer_load_dwordx4 v12, s[12:15], s60 offen lds
s_add_u32 s62, s51, s64
    v_add_u32 v18, 1046528, v16
    v_add_u32 v19, 1046528, v17
    v_lshl_add_u32 v20, v2, 12, v3
    v_xor_b32 v5, 64, v20
buffer_load_dwordx4 v13, s[12:15], s60 offen offset:1024 lds
s_mul_i32 s55, s53, 458752
    v_add_u32 v21, 1047552, v5
    v_add_u32 v22, 2095104, v20
    v_add_u32 v23, 2095104, v21
    s_lshl_b32 s57, s41, 14
buffer_load_dwordx4 v14, s[12:15], s60 offen offset:2048 lds
s_add_u32 s55, s55, 3584
    s_lshl_b32 s58, s46, 12
    s_add_u32 s57, s57, s58
    v_lshl_add_u32 v24, v0, 4, s57
    v_add_u32 v25, 0, v24
buffer_load_dwordx4 v15, s[12:15], s60 offen offset:3072 lds
s_mov_b32 s60, s55
s_load_dwordx2 s[28:29], s[0:1], 8
s_load_dwordx2 s[32:33], s[0:1], 16
s_mov_b32 s30, 8388608
s_mov_b32 s34, 8388608
s_mov_b32 m0, s61
s_add_u32 s52, s52, 1
buffer_load_dwordx4 v8, s[8:11], s59 offen lds
s_add_u32 s51, s51, 32768
s_and_b32 s51, s51, 131071
s_sub_u32 s53, s52, 1
s_bfe_u32 s100, s2, 0x10002
s_lshl_b32 s100, s100, 1
s_add_u32 s100, s100, s2
s_and_b32 s100, s100, 3
buffer_load_dwordx4 v9, s[8:11], s59 offen offset:1024 lds
s_and_b32 s7, s53, 3
s_cmp_eq_u32 s7, s42
s_cselect_b32 s7, 4, 0
s_add_u32 s53, s53, s7
s_mul_i32 s100, s100, 7
    s_mul_i32 s57, s40, 458752
    s_lshl_b32 s58, s46, 12
    s_add_u32 s57, s57, s58
buffer_load_dwordx4 v10, s[8:11], s59 offen offset:2048 lds
s_add_u32 s7, s42, 13
s_cmp_ge_u32 s52, s7
s_cselect_b32 s53, s52, s53
s_cmp_eq_u32 s52, 0
s_cselect_b32 s53, s42, s53
s_add_u32 s53, s53, s3
    v_lshl_add_u32 v26, v0, 4, s57
    v_and_b32 v3, 7, v0
    v_lshrrev_b32 v4, 4, v0
    v_lshlrev_b32 v4, 1, v4
s_waitcnt vmcnt(11)
s_barrier
buffer_load_dwordx4 v11, s[8:11], s59 offen offset:3072 lds
s_and_b32 s53, s53, 15
s_add_u32 s61, s51, s63
    v_xor_b32 v3, v3, v4
    v_lshlrev_b32 v3, 4, v3
    s_lshl_b32 s57, s47, 7
    v_add_u32 v3, s57, v3
s_mov_b32 m0, s62
s_lshl_b32 s59, s53, 7
buffer_load_dwordx4 v12, s[12:15], s60 offen lds
s_add_u32 s62, s51, s64
    v_lshrrev_b32 v2, 3, v0
    s_lshl_b32 s57, s46, 4
    v_add_u32 v4, s57, v2
    v_lshl_add_u32 v27, v4, 11, v3
buffer_load_dwordx4 v13, s[12:15], s60 offen offset:1024 lds
s_mul_i32 s55, s53, 458752
    v_add_u32 v28, 15360, v27
    v_lshrrev_b32 v4, 5, v0
    v_and_b32 v2, 3, v2
    v_lshl_add_u32 v2, v4, 3, v2
buffer_load_dwordx4 v14, s[12:15], s60 offen offset:2048 lds
s_add_u32 s55, s55, 3584
    s_lshr_b32 s57, s46, 1
    s_lshl_b32 s57, s57, 5
    s_and_b32 s58, s46, 1
    s_lshl_b32 s58, s58, 2
buffer_load_dwordx4 v15, s[12:15], s60 offen offset:3072 lds
s_mov_b32 s60, s55
    s_add_u32 s57, s57, s58
    s_lshl_b32 s58, s40, 8
    s_add_u32 s57, s57, s58
    v_add_u32 v2, s57, v2
s_mov_b32 m0, s61
s_add_u32 s52, s52, 1
buffer_load_dwordx4 v8, s[8:11], s59 offen lds
s_add_u32 s51, s51, 32768
s_and_b32 s51, s51, 131071
s_sub_u32 s53, s52, 1
    v_lshl_add_u32 v31, v2, 11, v3
    v_add_u32 v32, 31744, v31
    v_add_u32 v33, 262144, v31
    v_add_u32 v34, 293888, v31
buffer_load_dwordx4 v9, s[8:11], s59 offen offset:1024 lds
s_and_b32 s7, s53, 3
s_cmp_eq_u32 s7, s42
s_cselect_b32 s7, 4, 0
s_add_u32 s53, s53, s7
    v_and_b32 v2, 15, v0
    s_lshl_b32 s57, s46, 4
    v_add_u32 v2, s57, v2
    v_lshlrev_b32 v2, 17, v2
buffer_load_dwordx4 v10, s[8:11], s59 offen offset:2048 lds
s_add_u32 s7, s42, 13
s_cmp_ge_u32 s52, s7
s_cselect_b32 s53, s52, s53
s_cmp_eq_u32 s52, 0
s_cselect_b32 s53, s42, s53
s_add_u32 s53, s53, s3
    v_lshrrev_b32 v4, 4, v0
    v_lshl_add_u32 v29, v4, 4, v2
    v_add_u32 v30, 64, v29
v_lshrrev_b32 v2, 1, v0
s_waitcnt vmcnt(11)
s_barrier
buffer_load_dwordx4 v11, s[8:11], s59 offen offset:3072 lds
s_and_b32 s53, s53, 15
s_add_u32 s61, s51, s63
s_lshl_b32 s57, s46, 5
v_add_u32 v2, s57, v2
v_lshlrev_b32 v2, 4, v2
v_and_b32 v3, 1, v0
s_mov_b32 m0, s62
s_lshl_b32 s59, s53, 7
buffer_load_dwordx4 v12, s[12:15], s60 offen lds
s_add_u32 s62, s51, s64
v_mul_u32_u24 v3, 14336, v3
v_add_u32 v35, v2, v3
buffer_load_dwordx4 v13, s[12:15], s60 offen offset:1024 lds
s_mul_i32 s55, s53, 458752
buffer_load_dwordx4 v14, s[12:15], s60 offen offset:2048 lds
s_add_u32 s55, s55, 3584
buffer_load_dwordx4 v15, s[12:15], s60 offen offset:3072 lds
s_mov_b32 s60, s55
s_mov_b32 s56, 3
L_ll_13:
s_mov_b32 m0, s61
s_add_u32 s52, s52, 1
buffer_load_dwordx4 v8, s[8:11], s59 offen lds
s_add_u32 s51, s51, 32768
s_and_b32 s51, s51, 131071
s_sub_u32 s53, s52, 1
buffer_load_dwordx4 v9, s[8:11], s59 offen offset:1024 lds
s_and_b32 s7, s53, 3
s_cmp_eq_u32 s7, s42
s_cselect_b32 s7, 4, 0
s_add_u32 s53, s53, s7
buffer_load_dwordx4 v10, s[8:11], s59 offen offset:2048 lds
s_add_u32 s7, s42, 13
s_cmp_ge_u32 s52, s7
s_cselect_b32 s53, s52, s53
s_cmp_eq_u32 s52, 0
s_cselect_b32 s53, s42, s53
s_add_u32 s53, s53, s3
s_waitcnt vmcnt(11)
s_barrier
buffer_load_dwordx4 v11, s[8:11], s59 offen offset:3072 lds
s_and_b32 s53, s53, 15
s_add_u32 s61, s51, s63
s_mov_b32 m0, s62
s_lshl_b32 s59, s53, 7
buffer_load_dwordx4 v12, s[12:15], s60 offen lds
s_add_u32 s62, s51, s64
buffer_load_dwordx4 v13, s[12:15], s60 offen offset:1024 lds
s_mul_i32 s55, s53, 458752
buffer_load_dwordx4 v14, s[12:15], s60 offen offset:2048 lds
s_add_u32 s55, s55, 3584
s_sub_u32 s56, s56, 1
s_cmp_lg_u32 s56, 0
buffer_load_dwordx4 v15, s[12:15], s60 offen offset:3072 lds
s_mov_b32 s60, s55
s_cbranch_scc1 L_ll_13
s_mov_b32 m0, s61
s_add_u32 s52, s52, 1
buffer_load_dwordx4 v8, s[8:11], s59 offen lds
s_add_u32 s51, s51, 32768
s_and_b32 s51, s51, 131071
s_sub_u32 s53, s52, 1
buffer_load_dwordx4 v9, s[8:11], s59 offen offset:1024 lds
s_and_b32 s7, s53, 3
s_cmp_eq_u32 s7, s42
s_cselect_b32 s7, 4, 0
s_add_u32 s53, s53, s7
buffer_load_dwordx4 v10, s[8:11], s59 offen offset:2048 lds
s_add_u32 s7, s42, 13
s_cmp_ge_u32 s52, s7
s_cselect_b32 s53, s52, s53
s_cmp_eq_u32 s52, 0
s_cselect_b32 s53, s42, s53
s_add_u32 s53, s53, s3
s_waitcnt vmcnt(11)
s_barrier
buffer_load_dwordx4 v11, s[8:11], s59 offen offset:3072 lds
s_and_b32 s53, s53, 15
s_add_u32 s61, s51, s63
s_mov_b32 m0, s62
s_lshl_b32 s59, s53, 7
buffer_load_dwordx4 v12, s[12:15], s60 offen lds
s_add_u32 s62, s51, s64
buffer_load_dwordx4 v13, s[12:15], s60 offen offset:1024 lds
s_mul_i32 s55, s53, 458752
buffer_load_dwordx4 v14, s[12:15], s60 offen offset:2048 lds
s_add_u32 s55, s55, 3584
buffer_load_dwordx4 v15, s[12:15], s60 offen offset:3072 lds
s_mov_b32 s60, s55
buffer_load_dword v44, off, s[36:39], 0 sc1
s_mov_b32 m0, s61
s_add_u32 s52, s52, 1
buffer_load_dwordx4 v8, s[8:11], s59 offen lds
s_add_u32 s51, s51, 32768
s_and_b32 s51, s51, 131071
s_sub_u32 s53, s52, 1
buffer_load_dwordx4 v9, s[8:11], s59 offen offset:1024 lds
s_and_b32 s7, s53, 3
s_cmp_eq_u32 s7, s42
s_cselect_b32 s7, 4, 0
s_add_u32 s53, s53, s7
buffer_load_dwordx4 v10, s[8:11], s59 offen offset:2048 lds
s_add_u32 s7, s42, 13
s_cmp_ge_u32 s52, s7
s_cselect_b32 s53, s52, s53
s_cmp_eq_u32 s52, 0
s_cselect_b32 s53, s42, s53
s_add_u32 s53, s53, s3
s_waitcnt vmcnt(12)
s_barrier
buffer_load_dwordx4 v11, s[8:11], s59 offen offset:3072 lds
s_and_b32 s53, s53, 15
s_add_u32 s61, s51, s63
s_mov_b32 m0, s62
s_lshl_b32 s59, s53, 7
buffer_load_dwordx4 v12, s[12:15], s60 offen lds
s_add_u32 s62, s51, s64
buffer_load_dwordx4 v13, s[12:15], s60 offen offset:1024 lds
s_mul_i32 s55, s53, 458752
buffer_load_dwordx4 v14, s[12:15], s60 offen offset:2048 lds
s_add_u32 s55, s55, 3584
buffer_load_dwordx4 v15, s[12:15], s60 offen offset:3072 lds
s_mov_b32 s60, s55
s_mov_b32 m0, s61
s_add_u32 s52, s52, 1
buffer_load_dwordx4 v8, s[8:11], s59 offen lds
s_add_u32 s51, s51, 32768
s_and_b32 s51, s51, 131071
s_sub_u32 s53, s52, 1
buffer_load_dwordx4 v9, s[8:11], s59 offen offset:1024 lds
s_and_b32 s7, s53, 3
s_cmp_eq_u32 s7, s42
s_cselect_b32 s7, 4, 0
s_add_u32 s53, s53, s7
buffer_load_dwordx4 v10, s[8:11], s59 offen offset:2048 lds
s_add_u32 s7, s42, 13
s_cmp_ge_u32 s52, s7
s_cselect_b32 s53, s52, s53
s_cmp_eq_u32 s52, 0
s_cselect_b32 s53, s42, s53
s_add_u32 s53, s53, s3
s_waitcnt vmcnt(12)
s_barrier
buffer_load_dwordx4 v11, s[8:11], s59 offen offset:3072 lds
s_and_b32 s53, s53, 15
s_add_u32 s61, s51, s63
s_mov_b32 m0, s62
s_lshl_b32 s59, s53, 7
buffer_load_dwordx4 v12, s[12:15], s60 offen lds
s_add_u32 s62, s51, s64
buffer_load_dwordx4 v13, s[12:15], s60 offen offset:1024 lds
s_mul_i32 s55, s53, 458752
buffer_load_dwordx4 v14, s[12:15], s60 offen offset:2048 lds
s_add_u32 s55, s55, 3584
buffer_load_dwordx4 v15, s[12:15], s60 offen offset:3072 lds
s_mov_b32 s60, s55
s_waitcnt vmcnt(16)
s_mov_b32 s68, 200000
L_ng_5:
    v_readfirstlane_b32 s48, v44
s_nop 1
    s_cmp_lg_u32 s48, 0
    s_cbranch_scc1 L_ngd_6
    s_sub_u32 s68, s68, 1
    s_cbranch_scc1 L_ngd_6
    s_sleep 2
buffer_load_dword v44, off, s[36:39], 0 sc1
s_waitcnt vmcnt(0)
s_branch L_ng_5
L_ngd_6:
s_mov_b32 m0, s61
s_add_u32 s52, s52, 1
buffer_load_dwordx4 v8, s[8:11], s59 offen lds
s_add_u32 s51, s51, 32768
s_and_b32 s51, s51, 131071
s_sub_u32 s53, s52, 1
buffer_load_dwordx4 v9, s[8:11], s59 offen offset:1024 lds
s_and_b32 s7, s53, 3
s_cmp_eq_u32 s7, s42
s_cselect_b32 s7, 4, 0
s_add_u32 s53, s53, s7
buffer_load_dwordx4 v10, s[8:11], s59 offen offset:2048 lds
s_add_u32 s7, s42, 13
s_cmp_ge_u32 s52, s7
s_cselect_b32 s53, s52, s53
s_cmp_eq_u32 s52, 0
s_cselect_b32 s53, s42, s53
s_add_u32 s53, s53, s3
s_waitcnt vmcnt(11)
s_barrier
buffer_load_dwordx4 v11, s[8:11], s59 offen offset:3072 lds
s_and_b32 s53, s53, 15
s_add_u32 s61, s51, s63
s_mov_b32 m0, s62
s_lshl_b32 s59, s53, 7
buffer_load_dwordx4 v12, s[12:15], s60 offen lds
s_add_u32 s62, s51, s64
buffer_load_dwordx4 v13, s[12:15], s60 offen offset:1024 lds
s_mul_i32 s55, s53, 458752
buffer_load_dwordx4 v14, s[12:15], s60 offen offset:2048 lds
s_add_u32 s55, s55, 3584
buffer_load_dwordx4 v15, s[12:15], s60 offen offset:3072 lds
s_mov_b32 s60, s55
s_mov_b32 m0, s61
s_add_u32 s52, s52, 1
buffer_load_dwordx4 v8, s[8:11], s59 offen lds
s_add_u32 s51, s51, 32768
s_and_b32 s51, s51, 131071
s_sub_u32 s53, s52, 1
buffer_load_dwordx4 v9, s[8:11], s59 offen offset:1024 lds
s_and_b32 s7, s53, 3
s_cmp_eq_u32 s7, s42
s_cselect_b32 s7, 4, 0
s_add_u32 s53, s53, s7
buffer_load_dwordx4 v10, s[8:11], s59 offen offset:2048 lds
s_add_u32 s7, s42, 13
s_cmp_ge_u32 s52, s7
s_cselect_b32 s53, s52, s53
s_cmp_eq_u32 s52, 0
s_cselect_b32 s53, s42, s53
s_add_u32 s53, s53, s3
s_waitcnt vmcnt(11)
s_barrier
buffer_load_dwordx4 v11, s[8:11], s59 offen offset:3072 lds
s_and_b32 s53, s53, 15
s_add_u32 s61, s51, s63
s_mov_b32 m0, s62
s_lshl_b32 s59, s53, 7
buffer_load_dwordx4 v12, s[12:15], s60 offen lds
s_add_u32 s62, s51, s64
buffer_load_dwordx4 v13, s[12:15], s60 offen offset:1024 lds
s_mul_i32 s55, s53, 458752
buffer_load_dwordx4 v14, s[12:15], s60 offen offset:2048 lds
s_add_u32 s55, s55, 3584
buffer_load_dwordx4 v15, s[12:15], s60 offen offset:3072 lds
s_mov_b32 s60, s55
s_mov_b32 m0, s61
s_mov_b32 s52, 0
buffer_load_dwordx4 v8, s[8:11], s59 offen lds
s_add_u32 s51, s51, 32768
s_and_b32 s51, s51, 131071
s_sub_u32 s53, s52, 1
buffer_load_dwordx4 v9, s[8:11], s59 offen offset:1024 lds
s_and_b32 s7, s53, 3
s_cmp_eq_u32 s7, s42
s_cselect_b32 s7, 4, 0
s_add_u32 s53, s53, s7
buffer_load_dwordx4 v10, s[8:11], s59 offen offset:2048 lds
s_add_u32 s7, s42, 13
s_cmp_ge_u32 s52, s7
s_cselect_b32 s53, s52, s53
s_cmp_eq_u32 s52, 0
s_cselect_b32 s53, s42, s53
s_lshr_b32 s7, s6, 1
s_add_u32 s53, s53, s7
s_waitcnt vmcnt(11)
s_barrier
buffer_load_dwordx4 v11, s[8:11], s59 offen offset:3072 lds
s_and_b32 s53, s53, 15
s_add_u32 s61, s51, s63
s_mov_b32 m0, s62
s_lshl_b32 s59, s53, 7
buffer_load_dwordx4 v12, s[12:15], s60 offen lds
s_add_u32 s62, s51, s64
buffer_load_dwordx4 v13, s[12:15], s60 offen offset:1024 lds
s_mul_i32 s55, s53, 458752
buffer_load_dwordx4 v14, s[12:15], s60 offen offset:2048 lds
buffer_load_dwordx4 v15, s[12:15], s60 offen offset:3072 lds
s_mov_b32 s60, s55
s_mov_b32 s56, 3
L_ll_14:
s_mov_b32 m0, s61
s_add_u32 s52, s52, 1
buffer_load_dwordx4 v16, s[8:11], s59 offen lds
s_add_u32 s51, s51, 32768
s_and_b32 s51, s51, 131071
s_sub_u32 s53, s52, 1
buffer_load_dwordx4 v17, s[8:11], s59 offen offset:1024 lds
s_and_b32 s7, s53, 3
s_cmp_eq_u32 s7, s42
s_cselect_b32 s7, 4, 0
s_add_u32 s53, s53, s7
buffer_load_dwordx4 v18, s[8:11], s59 offen offset:2048 lds
s_add_u32 s7, s42, 13
s_cmp_ge_u32 s52, s7
s_cselect_b32 s53, s52, s53
s_cmp_eq_u32 s52, 0
s_cselect_b32 s53, s42, s53
s_lshr_b32 s7, s6, 1
s_add_u32 s53, s53, s7
s_waitcnt vmcnt(11)
s_barrier
buffer_load_dwordx4 v19, s[8:11], s59 offen offset:3072 lds
s_and_b32 s53, s53, 15
s_add_u32 s61, s51, s63
s_mov_b32 m0, s62
s_lshl_b32 s59, s53, 7
buffer_load_dwordx4 v12, s[12:15], s60 offen lds
s_add_u32 s62, s51, s64
buffer_load_dwordx4 v13, s[12:15], s60 offen offset:1024 lds
s_mul_i32 s55, s53, 458752
buffer_load_dwordx4 v14, s[12:15], s60 offen offset:2048 lds
s_sub_u32 s56, s56, 1
s_cmp_lg_u32 s56, 0
buffer_load_dwordx4 v15, s[12:15], s60 offen offset:3072 lds
s_mov_b32 s60, s55
s_cbranch_scc1 L_ll_14
s_mov_b32 m0, s61
s_add_u32 s52, s52, 1
buffer_load_dwordx4 v16, s[8:11], s59 offen lds
s_add_u32 s51, s51, 32768
s_and_b32 s51, s51, 131071
s_sub_u32 s53, s52, 1
buffer_load_dwordx4 v17, s[8:11], s59 offen offset:1024 lds
s_and_b32 s7, s53, 3
s_cmp_eq_u32 s7, s42
s_cselect_b32 s7, 4, 0
s_add_u32 s53, s53, s7
buffer_load_dwordx4 v18, s[8:11], s59 offen offset:2048 lds
s_add_u32 s7, s42, 13
s_cmp_ge_u32 s52, s7
s_cselect_b32 s53, s52, s53
s_cmp_eq_u32 s52, 0
s_cselect_b32 s53, s42, s53
s_lshr_b32 s7, s6, 1
s_add_u32 s53, s53, s7
buffer_load_dwordx4 v19, s[8:11], s59 offen offset:3072 lds
s_and_b32 s53, s53, 15
s_add_u32 s61, s51, s63
s_mov_b32 m0, s62
s_lshl_b32 s59, s53, 7
buffer_load_dwordx4 v12, s[12:15], s60 offen lds
s_add_u32 s62, s51, s64
buffer_load_dwordx4 v13, s[12:15], s60 offen offset:1024 lds
s_mul_i32 s55, s53, 458752
buffer_load_dwordx4 v14, s[12:15], s60 offen offset:2048 lds
buffer_load_dwordx4 v15, s[12:15], s60 offen offset:3072 lds
s_mov_b32 s60, s55
s_mul_i32 s53, s40, 14
s_add_u32 s53, s53, s41
s_lshl_b32 s53, s53, 2
s_add_u32 s53, s53, s46
s_mul_i32 s53, s53, 2048
v_lshlrev_b32 v2, 4, v0
buffer_load_dwordx4 v[36:39], v2, s[20:23], s53 offen
buffer_load_dwordx4 v[36:39], v2, s[20:23], s53 offen offset:1024
s_lshl_b32 s54, s46, 13
s_add_u32 s54, s54, 131072
v_lshl_add_u32 v2, v0, 4, s54
s_mov_b32 s66, 0xbdd2d3e8
s_mov_b32 s67, 0xbdd2d3e8
s_mov_b32 s4, 1.0
s_mov_b32 s5, 1.0
v_mov_b32 v200, 0xc0135761
v_mov_b32 v201, 0xc0135761
s_waitcnt vmcnt(18)
s_barrier
ds_read_b128 v[136:139], v2 offset:0
ds_read_b128 v[140:143], v2 offset:1024
ds_read_b128 v[144:147], v2 offset:2048
ds_read_b128 v[148:151], v2 offset:3072
ds_read_b128 v[152:155], v2 offset:4096
ds_read_b128 v[156:159], v2 offset:5120
ds_read_b128 v[160:163], v2 offset:6144
ds_read_b128 v[164:167], v2 offset:7168
s_setprio 0
s_mov_b32 m0, s61
s_add_u32 s52, s52, 1
buffer_load_dwordx4 v16, s[8:11], s59 offen lds
s_add_u32 s51, s51, 32768
s_and_b32 s51, s51, 131071
s_sub_u32 s53, s52, 1
buffer_load_dwordx4 v17, s[8:11], s59 offen offset:1024 lds
s_and_b32 s7, s53, 3
s_cmp_eq_u32 s7, s42
s_cselect_b32 s7, 4, 0
s_add_u32 s53, s53, s7
s_waitcnt lgkmcnt(0)
v_lshlrev_b32 v72, 16, v136
v_and_b32 v73, 0xffff0000, v136
v_lshlrev_b32 v74, 16, v137
v_and_b32 v75, 0xffff0000, v137
v_lshlrev_b32 v76, 16, v140
v_and_b32 v77, 0xffff0000, v140
v_lshlrev_b32 v78, 16, v141
v_and_b32 v79, 0xffff0000, v141
v_lshlrev_b32 v80, 16, v144
v_and_b32 v81, 0xffff0000, v144
v_lshlrev_b32 v82, 16, v145
buffer_load_dwordx4 v18, s[8:11], s59 offen offset:2048 lds
s_add_u32 s7, s42, 13
s_cmp_ge_u32 s52, s7
s_cselect_b32 s53, s52, s53
s_cmp_eq_u32 s52, 0
s_cselect_b32 s53, s42, s53
s_lshr_b32 s7, s6, 1
s_add_u32 s53, s53, s7
v_and_b32 v83, 0xffff0000, v145
v_lshlrev_b32 v84, 16, v148
v_and_b32 v85, 0xffff0000, v148
v_lshlrev_b32 v86, 16, v149
v_and_b32 v87, 0xffff0000, v149
v_mul_f32 v168, v80, v80
v_mul_f32 v169, v81, v81
v_mul_f32 v170, v82, v82
v_mul_f32 v171, v83, v83
v_mul_f32 v172, v84, v84
v_mul_f32 v173, v85, v85
v_mul_f32 v174, v86, v86
s_waitcnt vmcnt(13)
s_barrier
buffer_load_dwordx4 v19, s[8:11], s59 offen offset:3072 lds
s_and_b32 s53, s53, 15
s_add_u32 s61, s51, s63
v_mul_f32 v175, v87, v87
v_fma_f32 v168, v168, s66, v200
v_fma_f32 v169, v169, s66, v200
v_fma_f32 v170, v170, s66, v200
v_fma_f32 v171, v171, s66, v200
v_fma_f32 v172, v172, s66, v200
v_fma_f32 v173, v173, s66, v200
v_fma_f32 v174, v174, s66, v200
v_fma_f32 v175, v175, s66, v200
v_mul_f32 v168, v168, v80
v_mul_f32 v169, v169, v81
v_mul_f32 v170, v170, v82
s_mov_b32 m0, s62
s_lshl_b32 s59, s53, 7
buffer_load_dwordx4 v12, s[12:15], s60 offen lds
s_add_u32 s62, s51, s64
v_mul_f32 v171, v171, v83
v_mul_f32 v172, v172, v84
v_mul_f32 v173, v173, v85
v_mul_f32 v174, v174, v86
v_mul_f32 v175, v175, v87
v_exp_f32 v168, v168
v_exp_f32 v169, v169
v_exp_f32 v170, v170
v_exp_f32 v171, v171
buffer_load_dwordx4 v13, s[12:15], s60 offen offset:1024 lds
s_mul_i32 s55, s53, 458752
v_exp_f32 v172, v172
v_exp_f32 v173, v173
v_exp_f32 v174, v174
v_exp_f32 v175, v175
v_add_f32 v168, 1.0, v168
v_add_f32 v169, 1.0, v169
v_add_f32 v170, 1.0, v170
v_add_f32 v171, 1.0, v171
buffer_load_dwordx4 v14, s[12:15], s60 offen offset:2048 lds
v_add_f32 v172, 1.0, v172
v_add_f32 v173, 1.0, v173
v_add_f32 v174, 1.0, v174
v_add_f32 v175, 1.0, v175
v_rcp_f32 v168, v168
v_rcp_f32 v169, v169
v_rcp_f32 v170, v170
v_rcp_f32 v171, v171
buffer_load_dwordx4 v15, s[12:15], s60 offen offset:3072 lds
s_mov_b32 s60, s55
v_rcp_f32 v172, v172
v_rcp_f32 v173, v173
v_rcp_f32 v174, v174
v_rcp_f32 v175, v175
v_mul_f32 v80, v80, v168
v_mul_f32 v81, v81, v169
v_mul_f32 v82, v82, v170
v_mul_f32 v83, v83, v171
s_mov_b32 m0, s61
s_add_u32 s52, s52, 1
buffer_load_dwordx4 v16, s[8:11], s59 offen lds
s_add_u32 s51, s51, 32768
s_and_b32 s51, s51, 131071
s_sub_u32 s53, s52, 1
v_mul_f32 v84, v84, v172
v_mul_f32 v85, v85, v173
v_mul_f32 v86, v86, v174
v_mul_f32 v87, v87, v175
v_lshlrev_b32 v88, 16, v152
v_and_b32 v89, 0xffff0000, v152
v_lshlrev_b32 v90, 16, v153
v_and_b32 v91, 0xffff0000, v153
v_lshlrev_b32 v92, 16, v156
v_and_b32 v93, 0xffff0000, v156
v_lshlrev_b32 v94, 16, v157
v_and_b32 v95, 0xffff0000, v157
buffer_load_dwordx4 v17, s[8:11], s59 offen offset:1024 lds
s_and_b32 s7, s53, 3
s_cmp_eq_u32 s7, s42
s_cselect_b32 s7, 4, 0
s_add_u32 s53, s53, s7
v_lshlrev_b32 v96, 16, v160
v_and_b32 v97, 0xffff0000, v160
v_lshlrev_b32 v98, 16, v161
v_and_b32 v99, 0xffff0000, v161
v_lshlrev_b32 v100, 16, v164
v_and_b32 v101, 0xffff0000, v164
v_lshlrev_b32 v102, 16, v165
v_and_b32 v103, 0xffff0000, v165
v_mul_f32 v168, v96, v96
v_mul_f32 v169, v97, v97
v_mul_f32 v170, v98, v98
v_mul_f32 v171, v99, v99
buffer_load_dwordx4 v18, s[8:11], s59 offen offset:2048 lds
s_add_u32 s7, s42, 13
s_cmp_ge_u32 s52, s7
s_cselect_b32 s53, s52, s53
s_cmp_eq_u32 s52, 0
s_cselect_b32 s53, s42, s53
s_lshr_b32 s7, s6, 1
s_add_u32 s53, s53, s7
v_mul_f32 v172, v100, v100
v_mul_f32 v173, v101, v101
v_mul_f32 v174, v102, v102
v_mul_f32 v175, v103, v103
v_fma_f32 v168, v168, s66, v200
v_fma_f32 v169, v169, s66, v200
v_fma_f32 v170, v170, s66, v200
v_fma_f32 v171, v171, s66, v200
v_fma_f32 v172, v172, s66, v200
v_fma_f32 v173, v173, s66, v200
v_fma_f32 v174, v174, s66, v200
v_fma_f32 v175, v175, s66, v200
s_waitcnt vmcnt(13)
s_barrier
buffer_load_dwordx4 v19, s[8:11], s59 offen offset:3072 lds
s_and_b32 s53, s53, 15
s_add_u32 s61, s51, s63
v_mul_f32 v168, v168, v96
v_mul_f32 v169, v169, v97
v_mul_f32 v170, v170, v98
v_mul_f32 v171, v171, v99
v_mul_f32 v172, v172, v100
v_mul_f32 v173, v173, v101
v_mul_f32 v174, v174, v102
v_mul_f32 v175, v175, v103
v_exp_f32 v168, v168
v_exp_f32 v169, v169
s_mov_b32 m0, s62
s_lshl_b32 s59, s53, 7
buffer_load_dwordx4 v12, s[12:15], s60 offen lds
s_add_u32 s62, s51, s64
v_exp_f32 v170, v170
v_exp_f32 v171, v171
v_exp_f32 v172, v172
v_exp_f32 v173, v173
v_exp_f32 v174, v174
v_exp_f32 v175, v175
buffer_load_dwordx4 v13, s[12:15], s60 offen offset:1024 lds
s_mul_i32 s55, s53, 458752
v_add_f32 v168, 1.0, v168
v_add_f32 v169, 1.0, v169
v_add_f32 v170, 1.0, v170
v_add_f32 v171, 1.0, v171
v_add_f32 v172, 1.0, v172
v_add_f32 v173, 1.0, v173
v_add_f32 v174, 1.0, v174
v_add_f32 v175, 1.0, v175
v_rcp_f32 v168, v168
v_rcp_f32 v169, v169
buffer_load_dwordx4 v14, s[12:15], s60 offen offset:2048 lds
v_rcp_f32 v170, v170
v_rcp_f32 v171, v171
v_rcp_f32 v172, v172
v_rcp_f32 v173, v173
v_rcp_f32 v174, v174
v_rcp_f32 v175, v175
buffer_load_dwordx4 v15, s[12:15], s60 offen offset:3072 lds
s_mov_b32 s60, s55
v_mul_f32 v96, v96, v168
v_mul_f32 v97, v97, v169
v_mul_f32 v98, v98, v170
v_mul_f32 v99, v99, v171
v_mul_f32 v100, v100, v172
v_mul_f32 v101, v101, v173
v_mul_f32 v102, v102, v174
v_mul_f32 v103, v103, v175
v_lshlrev_b32 v104, 16, v138
v_and_b32 v105, 0xffff0000, v138
v_lshlrev_b32 v106, 16, v139
v_and_b32 v107, 0xffff0000, v139
s_mov_b32 m0, s61
s_add_u32 s52, s52, 1
buffer_load_dwordx4 v16, s[8:11], s59 offen lds
s_add_u32 s51, s51, 32768
s_and_b32 s51, s51, 131071
s_sub_u32 s53, s52, 1
v_lshlrev_b32 v108, 16, v142
v_and_b32 v109, 0xffff0000, v142
v_lshlrev_b32 v110, 16, v143
v_and_b32 v111, 0xffff0000, v143
v_lshlrev_b32 v112, 16, v146
v_and_b32 v113, 0xffff0000, v146
v_lshlrev_b32 v114, 16, v147
v_and_b32 v115, 0xffff0000, v147
v_lshlrev_b32 v116, 16, v150
v_and_b32 v117, 0xffff0000, v150
v_lshlrev_b32 v118, 16, v151
v_and_b32 v119, 0xffff0000, v151
buffer_load_dwordx4 v17, s[8:11], s59 offen offset:1024 lds
s_and_b32 s7, s53, 3
s_cmp_eq_u32 s7, s42
s_cselect_b32 s7, 4, 0
s_add_u32 s53, s53, s7
v_mul_f32 v168, v112, v112
v_mul_f32 v169, v113, v113
v_mul_f32 v170, v114, v114
v_mul_f32 v171, v115, v115
v_mul_f32 v172, v116, v116
v_mul_f32 v173, v117, v117
v_mul_f32 v174, v118, v118
v_mul_f32 v175, v119, v119
v_fma_f32 v168, v168, s66, v200
v_fma_f32 v169, v169, s66, v200
v_fma_f32 v170, v170, s66, v200
v_fma_f32 v171, v171, s66, v200
buffer_load_dwordx4 v18, s[8:11], s59 offen offset:2048 lds
s_add_u32 s7, s42, 13
s_cmp_ge_u32 s52, s7
s_cselect_b32 s53, s52, s53
s_cmp_eq_u32 s52, 0
s_cselect_b32 s53, s42, s53
s_lshr_b32 s7, s6, 1
s_add_u32 s53, s53, s7
v_fma_f32 v172, v172, s66, v200
v_fma_f32 v173, v173, s66, v200
v_fma_f32 v174, v174, s66, v200
v_fma_f32 v175, v175, s66, v200
v_mul_f32 v168, v168, v112
v_mul_f32 v169, v169, v113
v_mul_f32 v170, v170, v114
v_mul_f32 v171, v171, v115
v_mul_f32 v172, v172, v116
v_mul_f32 v173, v173, v117
v_mul_f32 v174, v174, v118
v_mul_f32 v175, v175, v119
buffer_load_dwordx4 v19, s[8:11], s59 offen offset:3072 lds
s_and_b32 s53, s53, 15
s_add_u32 s61, s51, s63
v_exp_f32 v168, v168
v_exp_f32 v169, v169
v_exp_f32 v170, v170
v_exp_f32 v171, v171
v_exp_f32 v172, v172
v_exp_f32 v173, v173
s_mov_b32 m0, s62
s_lshl_b32 s59, s53, 7
buffer_load_dwordx4 v12, s[12:15], s60 offen lds
s_add_u32 s62, s51, s64
v_exp_f32 v174, v174
v_exp_f32 v175, v175
v_add_f32 v168, 1.0, v168
v_add_f32 v169, 1.0, v169
v_add_f32 v170, 1.0, v170
v_add_f32 v171, 1.0, v171
v_add_f32 v172, 1.0, v172
v_add_f32 v173, 1.0, v173
v_add_f32 v174, 1.0, v174
v_add_f32 v175, 1.0, v175
buffer_load_dwordx4 v13, s[12:15], s60 offen offset:1024 lds
s_mul_i32 s55, s53, 458752
v_rcp_f32 v168, v168
v_rcp_f32 v169, v169
v_rcp_f32 v170, v170
v_rcp_f32 v171, v171
v_rcp_f32 v172, v172
v_rcp_f32 v173, v173
buffer_load_dwordx4 v14, s[12:15], s60 offen offset:2048 lds
v_rcp_f32 v174, v174
v_rcp_f32 v175, v175
v_mul_f32 v112, v112, v168
v_mul_f32 v113, v113, v169
v_mul_f32 v114, v114, v170
v_mul_f32 v115, v115, v171
v_mul_f32 v116, v116, v172
v_mul_f32 v117, v117, v173
v_mul_f32 v118, v118, v174
v_mul_f32 v119, v119, v175
buffer_load_dwordx4 v15, s[12:15], s60 offen offset:3072 lds
s_mov_b32 s60, s55
v_lshlrev_b32 v120, 16, v154
v_and_b32 v121, 0xffff0000, v154
v_lshlrev_b32 v122, 16, v155
v_and_b32 v123, 0xffff0000, v155
v_lshlrev_b32 v124, 16, v158
v_and_b32 v125, 0xffff0000, v158
v_lshlrev_b32 v126, 16, v159
v_and_b32 v127, 0xffff0000, v159
v_lshlrev_b32 v128, 16, v162
v_and_b32 v129, 0xffff0000, v162
v_lshlrev_b32 v130, 16, v163
v_and_b32 v131, 0xffff0000, v163
s_waitcnt vmcnt(16)
s_barrier
s_mov_b32 m0, s61
s_add_u32 s52, s52, 1
buffer_load_dwordx4 v16, s[8:11], s59 offen lds
s_add_u32 s51, s51, 32768
s_and_b32 s51, s51, 131071
s_sub_u32 s53, s52, 1
v_lshlrev_b32 v132, 16, v166
v_and_b32 v133, 0xffff0000, v166
v_lshlrev_b32 v134, 16, v167
v_and_b32 v135, 0xffff0000, v167
v_mul_f32 v168, v128, v128
v_mul_f32 v169, v129, v129
v_mul_f32 v170, v130, v130
v_mul_f32 v171, v131, v131
v_mul_f32 v172, v132, v132
v_mul_f32 v173, v133, v133
v_mul_f32 v174, v134, v134
v_mul_f32 v175, v135, v135
buffer_load_dwordx4 v17, s[8:11], s59 offen offset:1024 lds
s_and_b32 s7, s53, 3
s_cmp_eq_u32 s7, s42
s_cselect_b32 s7, 4, 0
s_add_u32 s53, s53, s7
v_fma_f32 v168, v168, s66, v200
v_fma_f32 v169, v169, s66, v200
v_fma_f32 v170, v170, s66, v200
v_fma_f32 v171, v171, s66, v200
v_fma_f32 v172, v172, s66, v200
v_fma_f32 v173, v173, s66, v200
v_fma_f32 v174, v174, s66, v200
v_fma_f32 v175, v175, s66, v200
v_mul_f32 v168, v168, v128
v_mul_f32 v169, v169, v129
v_mul_f32 v170, v170, v130
v_mul_f32 v171, v171, v131
buffer_load_dwordx4 v18, s[8:11], s59 offen offset:2048 lds
s_add_u32 s7, s42, 13
s_cmp_ge_u32 s52, s7
s_cselect_b32 s53, s52, s53
s_cmp_eq_u32 s52, 0
s_cselect_b32 s53, s42, s53
s_lshr_b32 s7, s6, 1
s_add_u32 s53, s53, s7
v_mul_f32 v172, v172, v132
v_mul_f32 v173, v173, v133
v_mul_f32 v174, v174, v134
v_mul_f32 v175, v175, v135
v_exp_f32 v168, v168
v_exp_f32 v169, v169
v_exp_f32 v170, v170
v_exp_f32 v171, v171
buffer_load_dwordx4 v19, s[8:11], s59 offen offset:3072 lds
s_and_b32 s53, s53, 15
s_add_u32 s61, s51, s63
v_exp_f32 v172, v172
v_exp_f32 v173, v173
v_exp_f32 v174, v174
v_exp_f32 v175, v175
v_add_f32 v168, 1.0, v168
v_add_f32 v169, 1.0, v169
v_add_f32 v170, 1.0, v170
v_add_f32 v171, 1.0, v171
s_mov_b32 m0, s62
s_lshl_b32 s59, s53, 7
buffer_load_dwordx4 v12, s[12:15], s60 offen lds
s_add_u32 s62, s51, s64
v_add_f32 v172, 1.0, v172
v_add_f32 v173, 1.0, v173
v_add_f32 v174, 1.0, v174
v_add_f32 v175, 1.0, v175
v_rcp_f32 v168, v168
v_rcp_f32 v169, v169
v_rcp_f32 v170, v170
v_rcp_f32 v171, v171
buffer_load_dwordx4 v13, s[12:15], s60 offen offset:1024 lds
s_mul_i32 s55, s53, 458752
v_rcp_f32 v172, v172
v_rcp_f32 v173, v173
v_rcp_f32 v174, v174
v_rcp_f32 v175, v175
v_mul_f32 v128, v128, v168
v_mul_f32 v129, v129, v169
v_mul_f32 v130, v130, v170
v_mul_f32 v131, v131, v171
buffer_load_dwordx4 v14, s[12:15], s60 offen offset:2048 lds
v_mul_f32 v132, v132, v172
v_mul_f32 v133, v133, v173
v_mul_f32 v134, v134, v174
v_mul_f32 v135, v135, v175
v_add_f32 v168, v72, v76
v_mul_f32 v176, v72, v72
v_add_f32 v169, v73, v77
v_mul_f32 v177, v73, v73
v_add_f32 v170, v74, v78
v_mul_f32 v178, v74, v74
v_add_f32 v171, v75, v79
v_mul_f32 v179, v75, v75
buffer_load_dwordx4 v15, s[12:15], s60 offen offset:3072 lds
s_mov_b32 s60, s55
v_add_f32 v172, v104, v108
v_mul_f32 v180, v104, v104
v_add_f32 v173, v105, v109
v_mul_f32 v181, v105, v105
v_add_f32 v174, v106, v110
v_mul_f32 v182, v106, v106
v_add_f32 v175, v107, v111
v_mul_f32 v183, v107, v107
v_fmac_f32 v176, v76, v76
v_fmac_f32 v177, v77, v77
v_fmac_f32 v178, v78, v78
v_fmac_f32 v179, v79, v79
s_waitcnt vmcnt(16)
s_barrier
s_mov_b32 m0, s61
s_add_u32 s52, s52, 1
buffer_load_dwordx4 v16, s[8:11], s59 offen lds
s_add_u32 s51, s51, 32768
s_and_b32 s51, s51, 131071
s_sub_u32 s53, s52, 1
v_fmac_f32 v180, v108, v108
v_fmac_f32 v181, v109, v109
v_fmac_f32 v182, v110, v110
v_fmac_f32 v183, v111, v111
v_add_f32 v168, v168, v80
v_fmac_f32 v176, v80, v80
v_add_f32 v169, v169, v81
v_fmac_f32 v177, v81, v81
v_add_f32 v170, v170, v82
v_fmac_f32 v178, v82, v82
v_add_f32 v171, v171, v83
v_fmac_f32 v179, v83, v83
buffer_load_dwordx4 v17, s[8:11], s59 offen offset:1024 lds
s_and_b32 s7, s53, 3
s_cmp_eq_u32 s7, s42
s_cselect_b32 s7, 4, 0
s_add_u32 s53, s53, s7
v_add_f32 v172, v172, v112
v_fmac_f32 v180, v112, v112
v_add_f32 v173, v173, v113
v_fmac_f32 v181, v113, v113
v_add_f32 v174, v174, v114
v_fmac_f32 v182, v114, v114
v_add_f32 v175, v175, v115
v_fmac_f32 v183, v115, v115
v_add_f32 v168, v168, v84
v_fmac_f32 v176, v84, v84
v_add_f32 v169, v169, v85
v_fmac_f32 v177, v85, v85
buffer_load_dwordx4 v18, s[8:11], s59 offen offset:2048 lds
s_add_u32 s7, s42, 13
s_cmp_ge_u32 s52, s7
s_cselect_b32 s53, s52, s53
s_cmp_eq_u32 s52, 0
s_cselect_b32 s53, s42, s53
s_lshr_b32 s7, s6, 1
s_add_u32 s53, s53, s7
v_add_f32 v170, v170, v86
v_fmac_f32 v178, v86, v86
v_add_f32 v171, v171, v87
v_fmac_f32 v179, v87, v87
v_add_f32 v172, v172, v116
v_fmac_f32 v180, v116, v116
v_add_f32 v173, v173, v117
v_fmac_f32 v181, v117, v117
v_add_f32 v174, v174, v118
v_fmac_f32 v182, v118, v118
v_add_f32 v175, v175, v119
v_fmac_f32 v183, v119, v119
buffer_load_dwordx4 v19, s[8:11], s59 offen offset:3072 lds
s_and_b32 s53, s53, 15
s_add_u32 s61, s51, s63
v_add_f32 v168, v168, v88
v_fmac_f32 v176, v88, v88
v_add_f32 v169, v169, v89
v_fmac_f32 v177, v89, v89
v_add_f32 v170, v170, v90
v_fmac_f32 v178, v90, v90
v_add_f32 v171, v171, v91
v_fmac_f32 v179, v91, v91
v_add_f32 v172, v172, v120
v_fmac_f32 v180, v120, v120
v_add_f32 v173, v173, v121
v_fmac_f32 v181, v121, v121
s_mov_b32 m0, s62
s_lshl_b32 s59, s53, 7
buffer_load_dwordx4 v12, s[12:15], s60 offen lds
s_add_u32 s62, s51, s64
v_add_f32 v174, v174, v122
v_fmac_f32 v182, v122, v122
v_add_f32 v175, v175, v123
v_fmac_f32 v183, v123, v123
v_add_f32 v168, v168, v92
v_fmac_f32 v176, v92, v92
v_add_f32 v169, v169, v93
v_fmac_f32 v177, v93, v93
v_add_f32 v170, v170, v94
v_fmac_f32 v178, v94, v94
v_add_f32 v171, v171, v95
v_fmac_f32 v179, v95, v95
buffer_load_dwordx4 v13, s[12:15], s60 offen offset:1024 lds
s_mul_i32 s55, s53, 458752
v_add_f32 v172, v172, v124
v_fmac_f32 v180, v124, v124
v_add_f32 v173, v173, v125
v_fmac_f32 v181, v125, v125
v_add_f32 v174, v174, v126
v_fmac_f32 v182, v126, v126
v_add_f32 v175, v175, v127
v_fmac_f32 v183, v127, v127
v_add_f32 v168, v168, v96
v_fmac_f32 v176, v96, v96
v_add_f32 v169, v169, v97
v_fmac_f32 v177, v97, v97
buffer_load_dwordx4 v14, s[12:15], s60 offen offset:2048 lds
v_add_f32 v170, v170, v98
v_fmac_f32 v178, v98, v98
v_add_f32 v171, v171, v99
v_fmac_f32 v179, v99, v99
v_add_f32 v172, v172, v128
v_fmac_f32 v180, v128, v128
v_add_f32 v173, v173, v129
v_fmac_f32 v181, v129, v129
v_add_f32 v174, v174, v130
v_fmac_f32 v182, v130, v130
v_add_f32 v175, v175, v131
v_fmac_f32 v183, v131, v131
buffer_load_dwordx4 v15, s[12:15], s60 offen offset:3072 lds
s_mov_b32 s60, s55
v_add_f32 v168, v168, v100
v_fmac_f32 v176, v100, v100
v_add_f32 v169, v169, v101
v_fmac_f32 v177, v101, v101
v_add_f32 v170, v170, v102
v_fmac_f32 v178, v102, v102
v_add_f32 v171, v171, v103
v_fmac_f32 v179, v103, v103
v_add_f32 v172, v172, v132
v_fmac_f32 v180, v132, v132
v_add_f32 v173, v173, v133
v_fmac_f32 v181, v133, v133
s_waitcnt vmcnt(16)
s_barrier
s_mov_b32 m0, s61
s_add_u32 s52, s52, 1
buffer_load_dwordx4 v16, s[8:11], s59 offen lds
s_add_u32 s51, s51, 32768
s_and_b32 s51, s51, 131071
s_sub_u32 s53, s52, 1
v_add_f32 v174, v174, v134
v_fmac_f32 v182, v134, v134
v_add_f32 v175, v175, v135
v_fmac_f32 v183, v135, v135
v_add_f32_dpp v168, v168, v168 row_ror:8 row_mask:0xf bank_mask:0x3
v_add_f32_dpp v169, v169, v169 row_ror:8 row_mask:0xf bank_mask:0x3
v_add_f32_dpp v170, v170, v170 row_ror:8 row_mask:0xf bank_mask:0x3
v_add_f32_dpp v171, v171, v171 row_ror:8 row_mask:0xf bank_mask:0x3
v_add_f32_dpp v176, v176, v176 row_ror:8 row_mask:0xf bank_mask:0x3
v_add_f32_dpp v177, v177, v177 row_ror:8 row_mask:0xf bank_mask:0x3
v_add_f32_dpp v178, v178, v178 row_ror:8 row_mask:0xf bank_mask:0x3
v_add_f32_dpp v179, v179, v179 row_ror:8 row_mask:0xf bank_mask:0x3
buffer_load_dwordx4 v17, s[8:11], s59 offen offset:1024 lds
s_and_b32 s7, s53, 3
s_cmp_eq_u32 s7, s42
s_cselect_b32 s7, 4, 0
s_add_u32 s53, s53, s7
v_add_f32_dpp v168, v172, v172 row_ror:8 row_mask:0xf bank_mask:0xc
v_add_f32_dpp v169, v173, v173 row_ror:8 row_mask:0xf bank_mask:0xc
v_add_f32_dpp v170, v174, v174 row_ror:8 row_mask:0xf bank_mask:0xc
v_add_f32_dpp v171, v175, v175 row_ror:8 row_mask:0xf bank_mask:0xc
v_add_f32_dpp v176, v180, v180 row_ror:8 row_mask:0xf bank_mask:0xc
v_add_f32_dpp v177, v181, v181 row_ror:8 row_mask:0xf bank_mask:0xc
v_add_f32_dpp v178, v182, v182 row_ror:8 row_mask:0xf bank_mask:0xc
v_add_f32_dpp v179, v183, v183 row_ror:8 row_mask:0xf bank_mask:0xc
v_add_f32_dpp v168, v168, v168 row_half_mirror row_mask:0xf bank_mask:0x5
v_add_f32_dpp v169, v169, v169 row_half_mirror row_mask:0xf bank_mask:0x5
v_add_f32_dpp v176, v176, v176 row_half_mirror row_mask:0xf bank_mask:0x5
v_add_f32_dpp v177, v177, v177 row_half_mirror row_mask:0xf bank_mask:0x5
buffer_load_dwordx4 v18, s[8:11], s59 offen offset:2048 lds
s_add_u32 s7, s42, 13
s_cmp_ge_u32 s52, s7
s_cselect_b32 s53, s52, s53
s_cmp_eq_u32 s52, 0
s_cselect_b32 s53, s42, s53
s_lshr_b32 s7, s6, 1
s_add_u32 s53, s53, s7
v_add_f32_dpp v168, v170, v170 row_half_mirror row_mask:0xf bank_mask:0xa
v_add_f32_dpp v169, v171, v171 row_half_mirror row_mask:0xf bank_mask:0xa
v_add_f32_dpp v176, v178, v178 row_half_mirror row_mask:0xf bank_mask:0xa
v_add_f32_dpp v177, v179, v179 row_half_mirror row_mask:0xf bank_mask:0xa
v_add_f32_dpp v168, v168, v168 quad_perm:[1,0,3,2] row_mask:0xf bank_mask:0xf
v_add_f32_dpp v169, v169, v169 quad_perm:[1,0,3,2] row_mask:0xf bank_mask:0xf
v_add_f32_dpp v176, v176, v176 quad_perm:[1,0,3,2] row_mask:0xf bank_mask:0xf
v_add_f32_dpp v177, v177, v177 quad_perm:[1,0,3,2] row_mask:0xf bank_mask:0xf
v_add_f32_dpp v168, v168, v168 quad_perm:[2,3,0,1] row_mask:0xf bank_mask:0xf
v_add_f32_dpp v169, v169, v169 quad_perm:[2,3,0,1] row_mask:0xf bank_mask:0xf
v_add_f32_dpp v176, v176, v176 quad_perm:[2,3,0,1] row_mask:0xf bank_mask:0xf
v_add_f32_dpp v177, v177, v177 quad_perm:[2,3,0,1] row_mask:0xf bank_mask:0xf
buffer_load_dwordx4 v19, s[8:11], s59 offen offset:3072 lds
s_and_b32 s53, s53, 15
s_add_u32 s61, s51, s63
v_and_b32 v2, 1, v0
v_cmp_eq_u32 vcc, 1, v2
v_lshrrev_b32 v3, 2, v0
v_lshl_add_u32 v2, v3, 1, v2
v_cndmask_b32 v136, v168, v169, vcc
v_cndmask_b32 v138, v176, v177, vcc
v_mov_b32 v137, s48
v_mov_b32 v139, s48
v_lshlrev_b32 v2, 4, v2
s_mul_i32 s54, s40, 14
s_add_u32 s54, s54, s41
s_lshl_b32 s54, s54, 2
s_mov_b32 m0, s62
s_lshl_b32 s59, s53, 7
buffer_load_dwordx4 v12, s[12:15], s60 offen lds
s_add_u32 s62, s51, s64
s_add_u32 s54, s54, s46
s_lshl_b32 s54, s54, 9
s_add_u32 s54, s54, 27262976
buffer_store_dwordx4 v[136:139], v2, s[16:19], s54 offen sc1
buffer_load_dwordx4 v13, s[12:15], s60 offen offset:1024 lds
s_mul_i32 s55, s53, 458752
buffer_load_dwordx4 v14, s[12:15], s60 offen offset:2048 lds
buffer_load_dwordx4 v15, s[12:15], s60 offen offset:3072 lds
s_mov_b32 s60, s55
s_waitcnt vmcnt(17)
s_barrier
s_mov_b32 m0, s61
s_add_u32 s52, s52, 1
buffer_load_dwordx4 v16, s[8:11], s59 offen lds
s_add_u32 s51, s51, 32768
s_and_b32 s51, s51, 131071
s_sub_u32 s53, s52, 1
buffer_load_dwordx4 v17, s[8:11], s59 offen offset:1024 lds
s_and_b32 s7, s53, 3
s_cmp_eq_u32 s7, s42
s_cselect_b32 s7, 4, 0
s_add_u32 s53, s53, s7
buffer_load_dwordx4 v18, s[8:11], s59 offen offset:2048 lds
s_add_u32 s7, s42, 13
s_cmp_ge_u32 s52, s7
s_cselect_b32 s53, s52, s53
s_cmp_eq_u32 s52, 0
s_cselect_b32 s53, s42, s53
s_lshr_b32 s7, s6, 1
s_add_u32 s53, s53, s7
buffer_load_dwordx4 v19, s[8:11], s59 offen offset:3072 lds
s_and_b32 s53, s53, 15
s_add_u32 s61, s51, s63
s_mov_b32 m0, s62
s_lshl_b32 s59, s53, 7
buffer_load_dwordx4 v12, s[12:15], s60 offen lds
s_add_u32 s62, s51, s64
buffer_load_dwordx4 v13, s[12:15], s60 offen offset:1024 lds
s_mul_i32 s55, s53, 458752
buffer_load_dwordx4 v14, s[12:15], s60 offen offset:2048 lds
buffer_load_dwordx4 v15, s[12:15], s60 offen offset:3072 lds
s_mov_b32 s60, s55
s_waitcnt vmcnt(17)
s_barrier
s_mov_b32 m0, s61
s_add_u32 s52, s52, 1
buffer_load_dwordx4 v16, s[8:11], s59 offen lds
s_add_u32 s51, s51, 32768
s_and_b32 s51, s51, 131071
s_sub_u32 s53, s52, 1
buffer_load_dwordx4 v17, s[8:11], s59 offen offset:1024 lds
s_and_b32 s7, s53, 3
s_cmp_eq_u32 s7, s42
s_cselect_b32 s7, 4, 0
s_add_u32 s53, s53, s7
buffer_load_dwordx4 v18, s[8:11], s59 offen offset:2048 lds
s_add_u32 s7, s42, 13
s_cmp_ge_u32 s52, s7
s_cselect_b32 s53, s52, s53
s_cmp_eq_u32 s52, 0
s_cselect_b32 s53, s42, s53
s_lshr_b32 s7, s6, 1
s_add_u32 s53, s53, s7
buffer_load_dwordx4 v19, s[8:11], s59 offen offset:3072 lds
s_and_b32 s53, s53, 15
s_add_u32 s61, s51, s63
s_mov_b32 m0, s62
s_lshl_b32 s59, s53, 7
buffer_load_dwordx4 v12, s[12:15], s60 offen lds
s_add_u32 s62, s51, s64
buffer_load_dwordx4 v13, s[12:15], s60 offen offset:1024 lds
s_mul_i32 s55, s53, 458752
buffer_load_dwordx4 v14, s[12:15], s60 offen offset:2048 lds
buffer_load_dwordx4 v15, s[12:15], s60 offen offset:3072 lds
s_mov_b32 s60, s55
s_waitcnt vmcnt(16)
s_barrier
s_mov_b32 m0, s61
s_add_u32 s52, s52, 1
buffer_load_dwordx4 v16, s[8:11], s59 offen lds
s_add_u32 s51, s51, 32768
s_and_b32 s51, s51, 131071
s_sub_u32 s53, s52, 1
buffer_load_dwordx4 v17, s[8:11], s59 offen offset:1024 lds
s_and_b32 s7, s53, 3
s_cmp_eq_u32 s7, s42
s_cselect_b32 s7, 4, 0
s_add_u32 s53, s53, s7
buffer_load_dwordx4 v18, s[8:11], s59 offen offset:2048 lds
s_add_u32 s7, s42, 13
s_cmp_ge_u32 s52, s7
s_cselect_b32 s53, s52, s53
s_cmp_eq_u32 s52, 0
s_cselect_b32 s53, s42, s53
s_lshr_b32 s7, s6, 1
s_add_u32 s53, s53, s7
buffer_load_dwordx4 v19, s[8:11], s59 offen offset:3072 lds
s_and_b32 s53, s53, 15
s_add_u32 s61, s51, s63
s_mov_b32 m0, s62
s_lshl_b32 s59, s53, 7
buffer_load_dwordx4 v12, s[12:15], s60 offen lds
s_add_u32 s62, s51, s64
buffer_load_dwordx4 v13, s[12:15], s60 offen offset:1024 lds
s_mul_i32 s55, s53, 458752
buffer_load_dwordx4 v14, s[12:15], s60 offen offset:2048 lds
buffer_load_dwordx4 v15, s[12:15], s60 offen offset:3072 lds
s_mov_b32 s60, s55
s_waitcnt vmcnt(16)
s_barrier
s_mov_b32 m0, s61
s_add_u32 s52, s52, 1
buffer_load_dwordx4 v16, s[8:11], s59 offen lds
s_add_u32 s51, s51, 32768
s_and_b32 s51, s51, 131071
s_sub_u32 s53, s52, 1
s_mul_i32 s54, s40, 28672
s_add_u32 s54, s54, 27262976
buffer_load_dwordx4 v[44:47], v35, s[16:19], s54 offen offset:0 sc1
buffer_load_dwordx4 v[48:51], v35, s[16:19], s54 offen offset:2048 sc1
s_add_u32 s54, s54, 4096
buffer_load_dwordx4 v[52:55], v35, s[16:19], s54 offen offset:0 sc1
buffer_load_dwordx4 v[56:59], v35, s[16:19], s54 offen offset:2048 sc1
s_add_u32 s54, s54, 4096
buffer_load_dwordx4 v[60:63], v35, s[16:19], s54 offen offset:0 sc1
buffer_load_dwordx4 v[64:67], v35, s[16:19], s54 offen offset:2048 sc1
s_add_u32 s54, s54, 4096
buffer_load_dwordx4 v[68:71], v35, s[16:19], s54 offen offset:0 sc1
buffer_load_dwordx4 v17, s[8:11], s59 offen offset:1024 lds
s_and_b32 s7, s53, 3
s_cmp_eq_u32 s7, s42
s_cselect_b32 s7, 4, 0
s_add_u32 s53, s53, s7
buffer_load_dwordx4 v18, s[8:11], s59 offen offset:2048 lds
s_add_u32 s7, s42, 13
s_cmp_ge_u32 s52, s7
s_cselect_b32 s53, s52, s53
s_cmp_eq_u32 s52, 0
s_cselect_b32 s53, s42, s53
s_lshr_b32 s7, s6, 1
s_add_u32 s53, s53, s7
buffer_load_dwordx4 v19, s[8:11], s59 offen offset:3072 lds
s_and_b32 s53, s53, 15
s_add_u32 s61, s51, s63
s_mov_b32 m0, s62
s_lshl_b32 s59, s53, 7
buffer_load_dwordx4 v12, s[12:15], s60 offen lds
s_add_u32 s62, s51, s64
buffer_load_dwordx4 v13, s[12:15], s60 offen offset:1024 lds
s_mul_i32 s55, s53, 458752
buffer_load_dwordx4 v14, s[12:15], s60 offen offset:2048 lds
buffer_load_dwordx4 v15, s[12:15], s60 offen offset:3072 lds
s_mov_b32 s60, s55
s_waitcnt vmcnt(23)
s_barrier
s_mov_b32 m0, s61
s_add_u32 s52, s52, 1
buffer_load_dwordx4 v16, s[8:11], s59 offen lds
s_add_u32 s51, s51, 32768
s_and_b32 s51, s51, 131071
s_sub_u32 s53, s52, 1
buffer_load_dwordx4 v17, s[8:11], s59 offen offset:1024 lds
s_and_b32 s7, s53, 3
s_cmp_eq_u32 s7, s42
s_cselect_b32 s7, 4, 0
s_add_u32 s53, s53, s7
buffer_load_dwordx4 v18, s[8:11], s59 offen offset:2048 lds
s_add_u32 s7, s42, 13
s_cmp_ge_u32 s52, s7
s_cselect_b32 s53, s52, s53
s_cmp_eq_u32 s52, 0
s_cselect_b32 s53, s42, s53
s_lshr_b32 s7, s6, 1
s_add_u32 s53, s53, s7
buffer_load_dwordx4 v19, s[8:11], s59 offen offset:3072 lds
s_and_b32 s53, s53, 15
s_add_u32 s61, s51, s63
s_mov_b32 m0, s62
s_lshl_b32 s59, s53, 7
buffer_load_dwordx4 v12, s[12:15], s60 offen lds
s_add_u32 s62, s51, s64
buffer_load_dwordx4 v13, s[12:15], s60 offen offset:1024 lds
s_mul_i32 s55, s53, 458752
buffer_load_dwordx4 v14, s[12:15], s60 offen offset:2048 lds
buffer_load_dwordx4 v15, s[12:15], s60 offen offset:3072 lds
s_mov_b32 s60, s55
s_waitcnt vmcnt(23)
s_barrier
s_mov_b32 m0, s61
s_nop 0
buffer_load_dwordx4 v16, s[8:11], s59 offen lds
s_waitcnt vmcnt(16)
v_min_u32 v2, v45, v47
v_max_u32 v3, v45, v47
v_min3_u32 v2, v2, v49, v51
v_max3_u32 v3, v3, v49, v51
v_min3_u32 v2, v2, v53, v55
v_max3_u32 v3, v3, v53, v55
v_min3_u32 v2, v2, v57, v59
v_max3_u32 v3, v3, v57, v59
v_min3_u32 v2, v2, v61, v63
v_max3_u32 v3, v3, v61, v63
v_min3_u32 v2, v2, v65, v67
buffer_load_dwordx4 v17, s[8:11], s59 offen offset:1024 lds
v_max3_u32 v3, v3, v65, v67
v_min3_u32 v2, v2, v69, v71
v_max3_u32 v3, v3, v69, v71
v_xor_b32 v2, s48, v2
v_xor_b32 v3, s48, v3
v_or_b32 v2, v2, v3
v_cmp_ne_u32 vcc, 0, v2
s_nop 1
s_cmp_eq_u64 vcc, 0
s_cbranch_scc0 L_st_retry
L_st_ok:
v_add_f32 v44, v44, v48
v_add_f32 v46, v46, v50
v_add_f32 v44, v44, v52
v_add_f32 v46, v46, v54
v_add_f32 v44, v44, v56
v_add_f32 v46, v46, v58
v_add_f32 v44, v44, v60
v_add_f32 v46, v46, v62
v_add_f32 v44, v44, v64
v_add_f32 v46, v46, v66
v_add_f32 v44, v44, v68
v_add_f32 v46, v46, v70
s_nop 0
v_add_f32_dpp v44, v44, v44 quad_perm:[1,0,3,2] row_mask:0xf bank_mask:0xf
v_add_f32_dpp v46, v46, v46 quad_perm:[1,0,3,2] row_mask:0xf bank_mask:0xf
buffer_load_dwordx4 v18, s[8:11], s59 offen offset:2048 lds
v_mul_f32 v2, 0x3a124925, v44
v_mul_f32 v3, 0x3a124925, v46
v_fma_f32 v3, -v2, v2, v3
v_max_f32 v3, 0, v3
v_add_f32 v3, 0x3727c5ac, v3
v_rsq_f32 v3, v3
s_nop 0
v_mul_f32 v4, -v2, v3
v_mov_b32_dpp v168, v3 row_newbcast:0 row_mask:0xf bank_mask:0xf
v_mov_b32_dpp v169, v3 row_newbcast:2 row_mask:0xf bank_mask:0xf
v_mov_b32_dpp v170, v3 row_newbcast:4 row_mask:0xf bank_mask:0xf
v_mov_b32_dpp v171, v3 row_newbcast:6 row_mask:0xf bank_mask:0xf
v_mov_b32_dpp v172, v3 row_newbcast:8 row_mask:0xf bank_mask:0xf
v_mov_b32_dpp v173, v3 row_newbcast:10 row_mask:0xf bank_mask:0xf
v_mov_b32_dpp v174, v3 row_newbcast:12 row_mask:0xf bank_mask:0xf
v_mov_b32_dpp v175, v3 row_newbcast:14 row_mask:0xf bank_mask:0xf
v_mov_b32_dpp v176, v4 row_newbcast:0 row_mask:0xf bank_mask:0xf
v_mov_b32_dpp v177, v4 row_newbcast:2 row_mask:0xf bank_mask:0xf
v_mov_b32_dpp v178, v4 row_newbcast:4 row_mask:0xf bank_mask:0xf
v_mov_b32_dpp v179, v4 row_newbcast:6 row_mask:0xf bank_mask:0xf
v_mov_b32_dpp v180, v4 row_newbcast:8 row_mask:0xf bank_mask:0xf
v_mov_b32_dpp v181, v4 row_newbcast:10 row_mask:0xf bank_mask:0xf
v_mov_b32_dpp v182, v4 row_newbcast:12 row_mask:0xf bank_mask:0xf
v_mov_b32_dpp v183, v4 row_newbcast:14 row_mask:0xf bank_mask:0xf
buffer_load_dwordx4 v19, s[8:11], s59 offen offset:3072 lds
v_lshlrev_b32 v2, 4, v0
s_lshl_b32 s58, s40, 1
s_lshr_b32 s54, s46, 1
s_add_u32 s58, s58, s54
s_mul_i32 s58, s58, 229376
s_lshl_b32 s54, s41, 14
s_add_u32 s58, s58, s54
s_and_b32 s54, s46, 1
s_lshl_b32 s54, s54, 10
s_add_u32 s58, s58, s54
s_add_u32 s58, s58, 1048576
v_fma_f32 v72, v72, v168, v176
v_fma_f32 v73, v73, v169, v177
v_fma_f32 v74, v74, v170, v178
v_fma_f32 v75, v75, v171, v179
v_fma_f32 v104, v104, v172, v180
v_fma_f32 v105, v105, v173, v181
v_fma_f32 v106, v106, v174, v182
v_fma_f32 v107, v107, v175, v183
v_cvt_pk_bf16_f32 v136, v72, v73
v_cvt_pk_bf16_f32 v137, v74, v75
v_cvt_pk_bf16_f32 v138, v104, v105
v_cvt_pk_bf16_f32 v139, v106, v107
buffer_store_dwordx4 v[136:139], v2, s[16:19], s58 offen sc1
s_add_u32 s58, s58, 2048
s_mov_b32 m0, s62
s_nop 0
buffer_load_dwordx4 v12, s[12:15], s60 offen lds
v_fma_f32 v76, v76, v168, v176
v_fma_f32 v77, v77, v169, v177
v_fma_f32 v78, v78, v170, v178
v_fma_f32 v79, v79, v171, v179
v_fma_f32 v108, v108, v172, v180
v_fma_f32 v109, v109, v173, v181
v_fma_f32 v110, v110, v174, v182
v_fma_f32 v111, v111, v175, v183
v_cvt_pk_bf16_f32 v140, v76, v77
v_cvt_pk_bf16_f32 v141, v78, v79
v_cvt_pk_bf16_f32 v142, v108, v109
v_cvt_pk_bf16_f32 v143, v110, v111
buffer_store_dwordx4 v[140:143], v2, s[16:19], s58 offen sc1
s_add_u32 s58, s58, 2048
v_fma_f32 v80, v80, v168, v176
v_fma_f32 v81, v81, v169, v177
v_fma_f32 v82, v82, v170, v178
v_fma_f32 v83, v83, v171, v179
v_fma_f32 v112, v112, v172, v180
v_fma_f32 v113, v113, v173, v181
v_fma_f32 v114, v114, v174, v182
v_fma_f32 v115, v115, v175, v183
v_cvt_pk_bf16_f32 v144, v80, v81
v_cvt_pk_bf16_f32 v145, v82, v83
v_cvt_pk_bf16_f32 v146, v112, v113
buffer_load_dwordx4 v13, s[12:15], s60 offen offset:1024 lds
v_cvt_pk_bf16_f32 v147, v114, v115
buffer_store_dwordx4 v[144:147], v2, s[16:19], s58 offen sc1
s_add_u32 s58, s58, 2048
v_fma_f32 v84, v84, v168, v176
v_fma_f32 v85, v85, v169, v177
v_fma_f32 v86, v86, v170, v178
v_fma_f32 v87, v87, v171, v179
v_fma_f32 v116, v116, v172, v180
v_fma_f32 v117, v117, v173, v181
v_fma_f32 v118, v118, v174, v182
v_fma_f32 v119, v119, v175, v183
v_cvt_pk_bf16_f32 v148, v84, v85
v_cvt_pk_bf16_f32 v149, v86, v87
v_cvt_pk_bf16_f32 v150, v116, v117
v_cvt_pk_bf16_f32 v151, v118, v119
buffer_store_dwordx4 v[148:151], v2, s[16:19], s58 offen sc1
s_add_u32 s58, s58, 2048
v_fma_f32 v88, v88, v168, v176
v_fma_f32 v89, v89, v169, v177
v_fma_f32 v90, v90, v170, v178
v_fma_f32 v91, v91, v171, v179
v_fma_f32 v120, v120, v172, v180
v_fma_f32 v121, v121, v173, v181
v_fma_f32 v122, v122, v174, v182
v_fma_f32 v123, v123, v175, v183
buffer_load_dwordx4 v14, s[12:15], s60 offen offset:2048 lds
v_cvt_pk_bf16_f32 v152, v88, v89
v_cvt_pk_bf16_f32 v153, v90, v91
v_cvt_pk_bf16_f32 v154, v120, v121
v_cvt_pk_bf16_f32 v155, v122, v123
buffer_store_dwordx4 v[152:155], v2, s[16:19], s58 offen sc1
s_add_u32 s58, s58, 2048
v_fma_f32 v92, v92, v168, v176
v_fma_f32 v93, v93, v169, v177
v_fma_f32 v94, v94, v170, v178
v_fma_f32 v95, v95, v171, v179
v_fma_f32 v124, v124, v172, v180
v_fma_f32 v125, v125, v173, v181
v_fma_f32 v126, v126, v174, v182
v_fma_f32 v127, v127, v175, v183
v_cvt_pk_bf16_f32 v156, v92, v93
v_cvt_pk_bf16_f32 v157, v94, v95
v_cvt_pk_bf16_f32 v158, v124, v125
v_cvt_pk_bf16_f32 v159, v126, v127
buffer_store_dwordx4 v[156:159], v2, s[16:19], s58 offen sc1
s_add_u32 s58, s58, 2048
v_fma_f32 v96, v96, v168, v176
v_fma_f32 v97, v97, v169, v177
v_fma_f32 v98, v98, v170, v178
v_fma_f32 v99, v99, v171, v179
v_fma_f32 v128, v128, v172, v180
buffer_load_dwordx4 v15, s[12:15], s60 offen offset:3072 lds
v_fma_f32 v129, v129, v173, v181
v_fma_f32 v130, v130, v174, v182
v_fma_f32 v131, v131, v175, v183
v_cvt_pk_bf16_f32 v160, v96, v97
v_cvt_pk_bf16_f32 v161, v98, v99
v_cvt_pk_bf16_f32 v162, v128, v129
v_cvt_pk_bf16_f32 v163, v130, v131
buffer_store_dwordx4 v[160:163], v2, s[16:19], s58 offen sc1
s_add_u32 s58, s58, 2048
v_fma_f32 v100, v100, v168, v176
v_fma_f32 v101, v101, v169, v177
v_fma_f32 v102, v102, v170, v178
v_fma_f32 v103, v103, v171, v179
v_fma_f32 v132, v132, v172, v180
v_fma_f32 v133, v133, v173, v181
v_fma_f32 v134, v134, v174, v182
v_fma_f32 v135, v135, v175, v183
v_cvt_pk_bf16_f32 v164, v100, v101
v_cvt_pk_bf16_f32 v165, v102, v103
v_cvt_pk_bf16_f32 v166, v132, v133
v_cvt_pk_bf16_f32 v167, v134, v135
buffer_store_dwordx4 v[164:167], v2, s[16:19], s58 offen sc1
s_add_u32 s58, s58, 2048
s_waitcnt vmcnt(24)
s_barrier
s_add_u32 s51, s51, 32768
s_and_b32 s51, s51, 131071
s_mov_b32 s52, 0
s_mov_b32 s57, s51
s_sub_u32 s53, s52, 1
s_and_b32 s7, s53, 3
s_cmp_eq_u32 s7, s42
s_cselect_b32 s7, 4, 0
s_add_u32 s53, s53, s7
s_add_u32 s7, s42, 29
s_cmp_ge_u32 s52, s7
s_cselect_b32 s53, s52, s53
s_cmp_eq_u32 s52, 0
s_cselect_b32 s53, s42, s53
s_add_u32 s53, s53, s6
s_and_b32 s53, s53, 31
s_lshl_b32 s59, s53, 7
s_mul_i32 s60, s53, 229376
s_add_u32 s60, s60, 1048576
s_add_u32 s61, s51, s63
s_add_u32 s62, s51, s64
s_mov_b32 m0, s61
s_add_u32 s52, s52, 1
buffer_load_dwordx4 v20, s[20:23], s59 offen lds
buffer_load_dwordx4 v21, s[20:23], s59 offen offset:1024 lds
buffer_load_dwordx4 v22, s[20:23], s59 offen offset:2048 lds
buffer_load_dwordx4 v23, s[20:23], s59 offen offset:3072 lds
s_add_u32 s51, s51, 32768
s_and_b32 s51, s51, 131071
s_lshl_b32 s54, s41, 4
s_add_u32 s54, s54, s40
s_lshl_b32 s54, s54, 2
s_add_u32 s54, s54, s46
s_lshl_b32 s54, s54, 7
s_add_u32 s54, s54, 28311552
v_mov_b32 v2, s48
s_waitcnt vmcnt(4)
s_mov_b64 exec, 1
buffer_store_dword v2, off, s[16:19], s54 sc1
s_mov_b64 exec, -1
s_waitcnt vmcnt(21)
s_barrier
s_sub_u32 s53, s52, 1
s_and_b32 s7, s53, 3
s_cmp_eq_u32 s7, s42
s_cselect_b32 s7, 4, 0
s_add_u32 s53, s53, s7
s_add_u32 s7, s42, 29
s_cmp_ge_u32 s52, s7
s_cselect_b32 s53, s52, s53
s_cmp_eq_u32 s52, 0
s_cselect_b32 s53, s42, s53
s_add_u32 s53, s53, s6
s_and_b32 s53, s53, 31
s_lshl_b32 s59, s53, 7
s_mul_i32 s60, s53, 229376
s_add_u32 s60, s60, 1048576
s_add_u32 s61, s51, s63
s_add_u32 s62, s51, s64
s_mov_b32 m0, s61
s_add_u32 s52, s52, 1
buffer_load_dwordx4 v20, s[20:23], s59 offen lds
buffer_load_dwordx4 v21, s[20:23], s59 offen offset:1024 lds
buffer_load_dwordx4 v22, s[20:23], s59 offen offset:2048 lds
buffer_load_dwordx4 v23, s[20:23], s59 offen offset:3072 lds
s_add_u32 s51, s51, 32768
s_and_b32 s51, s51, 131071
s_waitcnt vmcnt(11)
s_barrier
s_sub_u32 s53, s52, 1
s_and_b32 s7, s53, 3
s_cmp_eq_u32 s7, s42
s_cselect_b32 s7, 4, 0
s_add_u32 s53, s53, s7
s_add_u32 s7, s42, 29
s_cmp_ge_u32 s52, s7
s_cselect_b32 s53, s52, s53
s_cmp_eq_u32 s52, 0
s_cselect_b32 s53, s42, s53
s_add_u32 s53, s53, s6
s_and_b32 s53, s53, 31
s_lshl_b32 s59, s53, 7
s_mul_i32 s60, s53, 229376
s_add_u32 s60, s60, 1048576
s_add_u32 s61, s51, s63
s_add_u32 s62, s51, s64
s_mov_b32 m0, s61
s_add_u32 s52, s52, 1
buffer_load_dwordx4 v20, s[20:23], s59 offen lds
buffer_load_dwordx4 v21, s[20:23], s59 offen offset:1024 lds
buffer_load_dwordx4 v22, s[20:23], s59 offen offset:2048 lds
buffer_load_dwordx4 v23, s[20:23], s59 offen offset:3072 lds
s_add_u32 s51, s51, 32768
s_and_b32 s51, s51, 131071
s_barrier
s_setprio 0
s_lshl_b32 s58, s41, 13
s_add_u32 s58, s58, 28311552
v_lshlrev_b32 v2, 7, v0
s_mov_b32 s68, 200000
L_poll_7:
buffer_load_dword v3, v2, s[16:19], s58 offen sc1
s_sub_u32 s68, s68, 1
s_cbranch_scc1 L_polld_8
s_waitcnt vmcnt(0)
v_cmp_ne_u32 vcc, s48, v3
s_nop 1
s_cmp_eq_u64 vcc, 0
s_cbranch_scc1 L_polld_8
s_sleep 2
s_branch L_poll_7
L_polld_8:
s_waitcnt vmcnt(0)
s_mov_b32 s58, 0
s_sub_u32 s53, s58, 1
s_and_b32 s7, s53, 3
s_cmp_eq_u32 s7, s42
s_cselect_b32 s7, 4, 0
s_add_u32 s53, s53, s7
s_add_u32 s7, s42, 29
s_cmp_ge_u32 s58, s7
s_cselect_b32 s53, s58, s53
s_cmp_eq_u32 s58, 0
s_cselect_b32 s53, s42, s53
s_add_u32 s53, s53, s6
s_and_b32 s53, s53, 31
s_lshl_b32 s59, s53, 7
s_mul_i32 s60, s53, 229376
s_add_u32 s60, s60, 1048576
s_add_u32 s61, s57, s63
s_add_u32 s62, s57, s64
s_mov_b32 m0, s62
s_add_u32 s58, s58, 1
buffer_load_dwordx4 v24, s[16:19], s60 offen sc1 lds
buffer_load_dwordx4 v24, s[16:19], s60 offen offset:1024 sc1 lds
buffer_load_dwordx4 v25, s[16:19], s60 offen offset:2048 sc1 lds
buffer_load_dwordx4 v25, s[16:19], s60 offen offset:3072 sc1 lds
s_add_u32 s57, s57, 32768
s_and_b32 s57, s57, 131071
s_sub_u32 s53, s58, 1
s_and_b32 s7, s53, 3
s_cmp_eq_u32 s7, s42
s_cselect_b32 s7, 4, 0
s_add_u32 s53, s53, s7
s_add_u32 s7, s42, 29
s_cmp_ge_u32 s58, s7
s_cselect_b32 s53, s58, s53
s_cmp_eq_u32 s58, 0
s_cselect_b32 s53, s42, s53
s_add_u32 s53, s53, s6
s_and_b32 s53, s53, 31
s_lshl_b32 s59, s53, 7
s_mul_i32 s60, s53, 229376
s_add_u32 s60, s60, 1048576
s_add_u32 s61, s57, s63
s_add_u32 s62, s57, s64
s_mov_b32 m0, s62
s_add_u32 s58, s58, 1
buffer_load_dwordx4 v24, s[16:19], s60 offen sc1 lds
buffer_load_dwordx4 v24, s[16:19], s60 offen offset:1024 sc1 lds
buffer_load_dwordx4 v25, s[16:19], s60 offen offset:2048 sc1 lds
buffer_load_dwordx4 v25, s[16:19], s60 offen offset:3072 sc1 lds
s_add_u32 s57, s57, 32768
s_and_b32 s57, s57, 131071
s_sub_u32 s53, s52, 1
s_and_b32 s7, s53, 3
s_cmp_eq_u32 s7, s42
s_cselect_b32 s7, 4, 0
s_add_u32 s53, s53, s7
s_add_u32 s7, s42, 29
s_cmp_ge_u32 s52, s7
s_cselect_b32 s53, s52, s53
s_cmp_eq_u32 s52, 0
s_cselect_b32 s53, s42, s53
s_add_u32 s53, s53, s6
s_and_b32 s53, s53, 31
s_lshl_b32 s59, s53, 7
s_mul_i32 s60, s53, 229376
s_add_u32 s60, s60, 1048576
s_add_u32 s61, s51, s63
s_add_u32 s62, s51, s64
s_mov_b32 m0, s61
s_add_u32 s52, s52, 1
buffer_load_dwordx4 v20, s[20:23], s59 offen lds
buffer_load_dwordx4 v21, s[20:23], s59 offen offset:1024 lds
buffer_load_dwordx4 v22, s[20:23], s59 offen offset:2048 lds
buffer_load_dwordx4 v23, s[20:23], s59 offen offset:3072 lds
s_add_u32 s51, s51, 32768
s_and_b32 s51, s51, 131071
s_waitcnt vmcnt(8)
s_barrier
s_sub_u32 s53, s58, 1
s_and_b32 s7, s53, 3
s_cmp_eq_u32 s7, s42
s_cselect_b32 s7, 4, 0
s_add_u32 s53, s53, s7
s_add_u32 s7, s42, 29
s_cmp_ge_u32 s58, s7
s_cselect_b32 s53, s58, s53
s_cmp_eq_u32 s58, 0
s_cselect_b32 s53, s42, s53
s_add_u32 s53, s53, s6
s_and_b32 s53, s53, 31
s_lshl_b32 s59, s53, 7
s_mul_i32 s60, s53, 229376
s_add_u32 s60, s60, 1048576
s_add_u32 s61, s57, s63
s_add_u32 s62, s57, s64
s_mov_b32 m0, s62
s_add_u32 s58, s58, 1
buffer_load_dwordx4 v24, s[16:19], s60 offen sc1 lds
buffer_load_dwordx4 v24, s[16:19], s60 offen offset:1024 sc1 lds
buffer_load_dwordx4 v25, s[16:19], s60 offen offset:2048 sc1 lds
buffer_load_dwordx4 v25, s[16:19], s60 offen offset:3072 sc1 lds
s_add_u32 s57, s57, 32768
s_and_b32 s57, s57, 131071
s_sub_u32 s53, s58, 1
s_and_b32 s7, s53, 3
s_cmp_eq_u32 s7, s42
s_cselect_b32 s7, 4, 0
s_add_u32 s53, s53, s7
s_add_u32 s7, s42, 29
s_cmp_ge_u32 s58, s7
s_cselect_b32 s53, s58, s53
s_cmp_eq_u32 s58, 0
s_cselect_b32 s53, s42, s53
s_add_u32 s53, s53, s6
s_and_b32 s53, s53, 31
s_lshl_b32 s59, s53, 7
s_mul_i32 s60, s53, 229376
s_add_u32 s60, s60, 1048576
s_add_u32 s61, s57, s63
s_add_u32 s62, s57, s64
s_mov_b32 m0, s62
s_add_u32 s58, s58, 1
buffer_load_dwordx4 v24, s[16:19], s60 offen sc1 lds
buffer_load_dwordx4 v24, s[16:19], s60 offen offset:1024 sc1 lds
buffer_load_dwordx4 v25, s[16:19], s60 offen offset:2048 sc1 lds
buffer_load_dwordx4 v25, s[16:19], s60 offen offset:3072 sc1 lds
s_add_u32 s57, s57, 32768
s_and_b32 s57, s57, 131071
s_sub_u32 s53, s52, 1
s_and_b32 s7, s53, 3
s_cmp_eq_u32 s7, s42
s_cselect_b32 s7, 4, 0
s_add_u32 s53, s53, s7
s_add_u32 s7, s42, 29
s_cmp_ge_u32 s52, s7
s_cselect_b32 s53, s52, s53
s_cmp_eq_u32 s52, 0
s_cselect_b32 s53, s42, s53
s_add_u32 s53, s53, s6
s_and_b32 s53, s53, 31
s_lshl_b32 s59, s53, 7
s_mul_i32 s60, s53, 229376
s_add_u32 s60, s60, 1048576
s_add_u32 s61, s51, s63
s_add_u32 s62, s51, s64
s_waitcnt vmcnt(12)
s_barrier
s_mov_b32 m0, s61
s_add_u32 s52, s52, 1
buffer_load_dwordx4 v20, s[20:23], s59 offen lds
s_add_u32 s51, s51, 32768
s_and_b32 s51, s51, 131071
s_sub_u32 s53, s52, 1
buffer_load_dwordx4 v21, s[20:23], s59 offen offset:1024 lds
s_and_b32 s7, s53, 3
s_cmp_eq_u32 s7, s42
s_cselect_b32 s7, 4, 0
s_add_u32 s53, s53, s7
buffer_load_dwordx4 v22, s[20:23], s59 offen offset:2048 lds
s_add_u32 s7, s42, 29
s_cmp_ge_u32 s52, s7
s_cselect_b32 s53, s52, s53
s_cmp_eq_u32 s52, 0
s_cselect_b32 s53, s42, s53
s_add_u32 s53, s53, s6
s_waitcnt vmcnt(7)
s_barrier
buffer_load_dwordx4 v23, s[20:23], s59 offen offset:3072 lds
s_and_b32 s53, s53, 31
s_add_u32 s61, s51, s63
s_mov_b32 m0, s62
s_lshl_b32 s59, s53, 7
buffer_load_dwordx4 v24, s[16:19], s60 offen sc1 lds
s_add_u32 s62, s51, s64
buffer_load_dwordx4 v24, s[16:19], s60 offen offset:1024 sc1 lds
s_mul_i32 s55, s53, 229376
buffer_load_dwordx4 v25, s[16:19], s60 offen offset:2048 sc1 lds
s_add_u32 s55, s55, 1048576
buffer_load_dwordx4 v25, s[16:19], s60 offen offset:3072 sc1 lds
s_mov_b32 s60, s55
s_mov_b32 s56, 21
L_ll_15:
s_mov_b32 m0, s61
s_add_u32 s52, s52, 1
buffer_load_dwordx4 v20, s[20:23], s59 offen lds
s_add_u32 s51, s51, 32768
s_and_b32 s51, s51, 131071
s_sub_u32 s53, s52, 1
buffer_load_dwordx4 v21, s[20:23], s59 offen offset:1024 lds
s_and_b32 s7, s53, 3
s_cmp_eq_u32 s7, s42
s_cselect_b32 s7, 4, 0
s_add_u32 s53, s53, s7
buffer_load_dwordx4 v22, s[20:23], s59 offen offset:2048 lds
s_add_u32 s7, s42, 29
s_cmp_ge_u32 s52, s7
s_cselect_b32 s53, s52, s53
s_cmp_eq_u32 s52, 0
s_cselect_b32 s53, s42, s53
s_add_u32 s53, s53, s6
s_waitcnt vmcnt(11)
s_barrier
buffer_load_dwordx4 v23, s[20:23], s59 offen offset:3072 lds
s_and_b32 s53, s53, 31
s_add_u32 s61, s51, s63
s_mov_b32 m0, s62
s_lshl_b32 s59, s53, 7
buffer_load_dwordx4 v24, s[16:19], s60 offen sc1 lds
s_add_u32 s62, s51, s64
buffer_load_dwordx4 v24, s[16:19], s60 offen offset:1024 sc1 lds
s_mul_i32 s55, s53, 229376
buffer_load_dwordx4 v25, s[16:19], s60 offen offset:2048 sc1 lds
s_add_u32 s55, s55, 1048576
s_sub_u32 s56, s56, 1
s_cmp_lg_u32 s56, 0
buffer_load_dwordx4 v25, s[16:19], s60 offen offset:3072 sc1 lds
s_mov_b32 s60, s55
s_cbranch_scc1 L_ll_15
s_mov_b32 m0, s61
s_add_u32 s52, s52, 1
buffer_load_dwordx4 v20, s[20:23], s59 offen lds
s_add_u32 s51, s51, 32768
s_and_b32 s51, s51, 131071
s_sub_u32 s53, s52, 1
buffer_load_dwordx4 v21, s[20:23], s59 offen offset:1024 lds
s_and_b32 s7, s53, 3
s_cmp_eq_u32 s7, s42
s_cselect_b32 s7, 4, 0
s_add_u32 s53, s53, s7
buffer_load_dwordx4 v22, s[20:23], s59 offen offset:2048 lds
s_add_u32 s7, s42, 29
s_cmp_ge_u32 s52, s7
s_cselect_b32 s53, s52, s53
s_cmp_eq_u32 s52, 0
s_cselect_b32 s53, s42, s53
s_add_u32 s53, s53, s6
s_waitcnt vmcnt(11)
s_barrier
buffer_load_dwordx4 v23, s[20:23], s59 offen offset:3072 lds
s_and_b32 s53, s53, 31
s_add_u32 s61, s51, s63
s_mov_b32 m0, s62
s_lshl_b32 s59, s53, 7
buffer_load_dwordx4 v24, s[16:19], s60 offen sc1 lds
s_add_u32 s62, s51, s64
buffer_load_dwordx4 v24, s[16:19], s60 offen offset:1024 sc1 lds
s_mul_i32 s55, s53, 229376
buffer_load_dwordx4 v25, s[16:19], s60 offen offset:2048 sc1 lds
s_add_u32 s55, s55, 1048576
buffer_load_dwordx4 v25, s[16:19], s60 offen offset:3072 sc1 lds
s_mov_b32 s60, s55
v_and_b32 v2, 31, v0
v_lshlrev_b32 v5, 7, v2
s_mov_b32 s58, 28508160
buffer_load_dword v44, v5, s[16:19], s58 offen sc1
s_mov_b32 m0, s61
s_add_u32 s52, s52, 1
buffer_load_dwordx4 v20, s[20:23], s59 offen lds
s_add_u32 s51, s51, 32768
s_and_b32 s51, s51, 131071
s_sub_u32 s53, s52, 1
buffer_load_dwordx4 v21, s[20:23], s59 offen offset:1024 lds
s_and_b32 s7, s53, 3
s_cmp_eq_u32 s7, s42
s_cselect_b32 s7, 4, 0
s_add_u32 s53, s53, s7
buffer_load_dwordx4 v22, s[20:23], s59 offen offset:2048 lds
s_add_u32 s7, s42, 29
s_cmp_ge_u32 s52, s7
s_cselect_b32 s53, s52, s53
s_cmp_eq_u32 s52, 0
s_cselect_b32 s53, s42, s53
s_add_u32 s53, s53, s6
s_waitcnt vmcnt(12)
s_barrier
buffer_load_dwordx4 v23, s[20:23], s59 offen offset:3072 lds
s_and_b32 s53, s53, 31
s_add_u32 s61, s51, s63
s_mov_b32 m0, s62
s_lshl_b32 s59, s53, 7
buffer_load_dwordx4 v24, s[16:19], s60 offen sc1 lds
s_add_u32 s62, s51, s64
buffer_load_dwordx4 v24, s[16:19], s60 offen offset:1024 sc1 lds
s_mul_i32 s55, s53, 229376
buffer_load_dwordx4 v25, s[16:19], s60 offen offset:2048 sc1 lds
s_add_u32 s55, s55, 1048576
buffer_load_dwordx4 v25, s[16:19], s60 offen offset:3072 sc1 lds
s_mov_b32 s60, s55
s_mov_b32 m0, s61
s_add_u32 s52, s52, 1
buffer_load_dwordx4 v20, s[20:23], s59 offen lds
s_add_u32 s51, s51, 32768
s_and_b32 s51, s51, 131071
s_sub_u32 s53, s52, 1
buffer_load_dwordx4 v21, s[20:23], s59 offen offset:1024 lds
s_and_b32 s7, s53, 3
s_cmp_eq_u32 s7, s42
s_cselect_b32 s7, 4, 0
s_add_u32 s53, s53, s7
buffer_load_dwordx4 v22, s[20:23], s59 offen offset:2048 lds
s_add_u32 s7, s42, 29
s_cmp_ge_u32 s52, s7
s_cselect_b32 s53, s52, s53
s_cmp_eq_u32 s52, 0
s_cselect_b32 s53, s42, s53
s_add_u32 s53, s53, s6
s_waitcnt vmcnt(12)
s_barrier
buffer_load_dwordx4 v23, s[20:23], s59 offen offset:3072 lds
s_and_b32 s53, s53, 31
s_add_u32 s61, s51, s63
s_mov_b32 m0, s62
s_lshl_b32 s59, s53, 7
buffer_load_dwordx4 v24, s[16:19], s60 offen sc1 lds
s_add_u32 s62, s51, s64
buffer_load_dwordx4 v24, s[16:19], s60 offen offset:1024 sc1 lds
s_mul_i32 s55, s53, 229376
buffer_load_dwordx4 v25, s[16:19], s60 offen offset:2048 sc1 lds
s_add_u32 s55, s55, 1048576
buffer_load_dwordx4 v25, s[16:19], s60 offen offset:3072 sc1 lds
s_mov_b32 s60, s55
s_waitcnt vmcnt(16)
v_cmp_ne_u32 vcc, s48, v44
s_nop 1
s_cmp_eq_u64 vcc, 0
s_cbranch_scc1 L_vf_ok
s_mov_b32 s68, 200000
L_poll_9:
buffer_load_dword v44, v5, s[16:19], s58 offen sc1
s_sub_u32 s68, s68, 1
s_cbranch_scc1 L_polld_10
s_waitcnt vmcnt(0)
v_cmp_ne_u32 vcc, s48, v44
s_nop 1
s_cmp_eq_u64 vcc, 0
s_cbranch_scc1 L_polld_10
s_sleep 2
s_branch L_poll_9
L_polld_10:
s_waitcnt vmcnt(0)
L_vf_ok:
s_and_b32 s54, s46, 1
s_lshl_b32 s57, s40, 1
s_add_u32 s57, s57, s54
s_lshl_b32 s57, s57, 2
s_add_u32 s57, s57, 26214400
s_lshl_b32 s54, s54, 8
s_add_u32 m0, s54, 134656
v_lshlrev_b32 v2, 7, v0
buffer_load_dword v2, s[16:19], s57 offen sc1 lds
s_mov_b32 m0, s61
s_add_u32 s52, s52, 1
buffer_load_dwordx4 v20, s[20:23], s59 offen lds
s_add_u32 s51, s51, 32768
s_and_b32 s51, s51, 131071
s_sub_u32 s53, s52, 1
buffer_load_dwordx4 v21, s[20:23], s59 offen offset:1024 lds
s_and_b32 s7, s53, 3
s_cmp_eq_u32 s7, s42
s_cselect_b32 s7, 4, 0
s_add_u32 s53, s53, s7
buffer_load_dwordx4 v22, s[20:23], s59 offen offset:2048 lds
s_add_u32 s7, s42, 29
s_cmp_ge_u32 s52, s7
s_cselect_b32 s53, s52, s53
s_cmp_eq_u32 s52, 0
s_cselect_b32 s53, s42, s53
s_add_u32 s53, s53, s6
s_waitcnt vmcnt(12)
s_barrier
buffer_load_dwordx4 v23, s[20:23], s59 offen offset:3072 lds
s_and_b32 s53, s53, 31
s_add_u32 s61, s51, s63
s_mov_b32 m0, s62
s_lshl_b32 s59, s53, 7
buffer_load_dwordx4 v24, s[16:19], s60 offen sc1 lds
s_add_u32 s62, s51, s64
buffer_load_dwordx4 v24, s[16:19], s60 offen offset:1024 sc1 lds
s_mul_i32 s55, s53, 229376
buffer_load_dwordx4 v25, s[16:19], s60 offen offset:2048 sc1 lds
s_add_u32 s55, s55, 1048576
buffer_load_dwordx4 v25, s[16:19], s60 offen offset:3072 sc1 lds
s_mov_b32 s60, s55
s_mov_b32 m0, s61
s_add_u32 s52, s52, 1
buffer_load_dwordx4 v20, s[20:23], s59 offen lds
s_add_u32 s51, s51, 32768
s_and_b32 s51, s51, 131071
s_sub_u32 s53, s52, 1
buffer_load_dwordx4 v21, s[20:23], s59 offen offset:1024 lds
s_and_b32 s7, s53, 3
s_cmp_eq_u32 s7, s42
s_cselect_b32 s7, 4, 0
s_add_u32 s53, s53, s7
buffer_load_dwordx4 v22, s[20:23], s59 offen offset:2048 lds
s_add_u32 s7, s42, 29
s_cmp_ge_u32 s52, s7
s_cselect_b32 s53, s52, s53
s_cmp_eq_u32 s52, 0
s_cselect_b32 s53, s42, s53
s_add_u32 s53, s53, s6
s_waitcnt vmcnt(12)
s_barrier
buffer_load_dwordx4 v23, s[20:23], s59 offen offset:3072 lds
s_and_b32 s53, s53, 31
s_add_u32 s61, s51, s63
s_mov_b32 m0, s62
s_lshl_b32 s59, s53, 7
buffer_load_dwordx4 v24, s[16:19], s60 offen sc1 lds
s_add_u32 s62, s51, s64
buffer_load_dwordx4 v24, s[16:19], s60 offen offset:1024 sc1 lds
s_mul_i32 s55, s53, 229376
buffer_load_dwordx4 v25, s[16:19], s60 offen offset:2048 sc1 lds
s_add_u32 s55, s55, 1048576
buffer_load_dwordx4 v25, s[16:19], s60 offen offset:3072 sc1 lds
s_mov_b32 s60, s55
s_mov_b32 m0, s61
s_nop 0
buffer_load_dwordx4 v20, s[20:23], s59 offen lds
buffer_load_dwordx4 v21, s[20:23], s59 offen offset:1024 lds
buffer_load_dwordx4 v22, s[20:23], s59 offen offset:2048 lds
s_waitcnt vmcnt(11)
s_barrier
buffer_load_dwordx4 v23, s[20:23], s59 offen offset:3072 lds
s_mov_b32 m0, s62
s_nop 0
buffer_load_dwordx4 v24, s[16:19], s60 offen sc1 lds
buffer_load_dwordx4 v24, s[16:19], s60 offen offset:1024 sc1 lds
buffer_load_dwordx4 v25, s[16:19], s60 offen offset:2048 sc1 lds
buffer_load_dwordx4 v25, s[16:19], s60 offen offset:3072 sc1 lds
s_add_u32 s51, s51, 32768
s_and_b32 s51, s51, 131071
s_lshl_b32 s64, s46, 11
s_add_u32 s64, s64, 16384
s_waitcnt vmcnt(8)
s_barrier
s_lshl_b32 s53, s46, 10
s_add_u32 s61, s51, s53
s_add_u32 s62, s51, s64
s_mov_b32 s60, 17825792
s_add_u32 m0, s61, 0
s_nop 0
buffer_load_dwordx4 v29, s[28:31], 0 offen lds
s_add_u32 m0, s61, 8192
s_nop 0
buffer_load_dwordx4 v30, s[28:31], 0 offen lds
s_add_u32 m0, s62, 0
s_nop 0
buffer_load_dwordx4 v31, s[16:19], s60 offen sc1 lds
buffer_load_dwordx4 v32, s[16:19], s60 offen offset:1024 sc1 lds
s_add_u32 m0, s62, 8192
s_nop 0
buffer_load_dwordx4 v33, s[16:19], s60 offen sc1 lds
buffer_load_dwordx4 v34, s[16:19], s60 offen offset:1024 sc1 lds
s_add_u32 s51, s51, 32768
s_and_b32 s51, s51, 131071
s_waitcnt vmcnt(6)
s_barrier
s_lshl_b32 s53, s46, 10
s_add_u32 s61, s51, s53
s_add_u32 s62, s51, s64
s_mov_b32 s60, 17956864
s_add_u32 m0, s61, 0
s_nop 0
buffer_load_dwordx4 v29, s[32:35], 0 offen lds
s_add_u32 m0, s61, 8192
s_nop 0
buffer_load_dwordx4 v30, s[32:35], 0 offen lds
s_add_u32 m0, s62, 0
s_nop 0
buffer_load_dwordx4 v31, s[16:19], s60 offen sc1 lds
buffer_load_dwordx4 v32, s[16:19], s60 offen offset:1024 sc1 lds
s_add_u32 m0, s62, 8192
s_nop 0
buffer_load_dwordx4 v33, s[16:19], s60 offen sc1 lds
buffer_load_dwordx4 v34, s[16:19], s60 offen offset:1024 sc1 lds
s_add_u32 s51, s51, 32768
s_and_b32 s51, s51, 131071
L_l4_entry:
s_mov_b32 s57, 0
s_lshl_b32 s69, s46, 11
s_add_u32 s64, s69, 163840
s_add_u32 s69, s69, 65536
s_lshl_b32 s58, s40, 11
s_add_u32 s58, s58, 28442624
v_min_u32 v2, 13, v0
v_lshlrev_b32 v2, 7, v2
s_barrier
s_cmp_lt_u32 s47, 14
s_cselect_b32 s54, s46, 1
s_cmp_eq_u32 s54, 0
s_cbranch_scc0 L_nohf
s_lshl_b32 s54, s41, 7
s_add_u32 s54, s54, s58
v_mov_b32 v3, s48
s_mov_b64 exec, 1
buffer_store_dword v3, off, s[16:19], s54 sc1
s_mov_b64 exec, -1
L_nohf:
s_mov_b32 s56, 4
L_ll_16:
s_and_b32 s53, s57, 3
s_cmp_eq_u32 s53, s42
s_cselect_b32 s53, 4, 0
s_add_u32 s53, s53, s57
s_cmp_ge_u32 s53, 28
s_cselect_b32 s54, 28, 0
s_sub_u32 s53, s53, s54
s_add_u32 s53, s53, s100
s_cmp_ge_u32 s53, 28
s_cselect_b32 s54, 28, 0
s_sub_u32 s53, s53, s54
s_lshl_b32 s60, s53, 17
s_mov_b32 m0, s69
s_add_u32 s57, s57, 1
buffer_load_dwordx4 v27, s[24:27], s60 offen lds
s_add_u32 s69, s69, 8192
s_cmp_eq_u32 s69, s64
s_cselect_b32 s54, 98304, 0
s_sub_u32 s69, s69, s54
s_sub_u32 s56, s56, 1
s_cmp_lg_u32 s56, 0
buffer_load_dwordx4 v28, s[24:27], s60 offen offset:1024 lds
s_cbranch_scc1 L_ll_16
s_waitcnt vmcnt(14)
s_barrier
s_mov_b32 s56, 4
L_ll_17:
s_and_b32 s53, s57, 3
s_cmp_eq_u32 s53, s42
s_cselect_b32 s53, 4, 0
s_add_u32 s53, s53, s57
s_cmp_ge_u32 s53, 28
s_cselect_b32 s54, 28, 0
s_sub_u32 s53, s53, s54
s_add_u32 s53, s53, s100
s_cmp_ge_u32 s53, 28
s_cselect_b32 s54, 28, 0
s_sub_u32 s53, s53, s54
s_lshl_b32 s60, s53, 17
s_mov_b32 m0, s69
s_add_u32 s57, s57, 1
buffer_load_dwordx4 v27, s[24:27], s60 offen lds
s_add_u32 s69, s69, 8192
s_cmp_eq_u32 s69, s64
s_cselect_b32 s54, 98304, 0
s_sub_u32 s69, s69, s54
s_sub_u32 s56, s56, 1
s_cmp_lg_u32 s56, 0
buffer_load_dwordx4 v28, s[24:27], s60 offen offset:1024 lds
s_cbranch_scc1 L_ll_17
s_waitcnt vmcnt(16)
s_barrier
s_cmp_lt_u32 s47, 14
s_cbranch_scc1 L_pv_done
s_sub_u32 s53, s47, 14
s_mul_i32 s53, s53, 896
v_lshlrev_b32 v6, 4, v0
v_add_u32 v7, s53, v6
s_lshl_b32 s54, s47, 7
s_sub_u32 s54, s54, 896
v_add_u32 v6, s54, v6
v_cmp_gt_u32 vcc, 56, v0
s_lshl_b32 s53, s40, 19
s_lshl_b32 s54, s46, 17
s_add_u32 s53, s53, s54
s_add_u32 s53, s53, 17825792
v_cndmask_b32 v6, v6, v7, vcc
s_mov_b32 s54, 8
L_pv:
buffer_load_dword v3, v2, s[16:19], s58 offen sc1
buffer_load_dwordx4 v[36:39], v6, s[16:19], s53 offen sc1
buffer_load_dwordx4 v[36:39], v6, s[16:19], s53 offen offset:2048 sc1
s_add_u32 s53, s53, 4096
buffer_load_dwordx4 v[36:39], v6, s[16:19], s53 offen sc1
buffer_load_dwordx4 v[36:39], v6, s[16:19], s53 offen offset:2048 sc1
s_add_u32 s53, s53, 4096
buffer_load_dwordx4 v[36:39], v6, s[16:19], s53 offen sc1
buffer_load_dwordx4 v[36:39], v6, s[16:19], s53 offen offset:2048 sc1
s_add_u32 s53, s53, 4096
buffer_load_dwordx4 v[36:39], v6, s[16:19], s53 offen sc1
buffer_load_dwordx4 v[36:39], v6, s[16:19], s53 offen offset:2048 sc1
s_add_u32 s53, s53, 4096
s_waitcnt vmcnt(8)
v_cmp_eq_u32 vcc, s48, v3
s_nop 1
s_cmp_lg_u64 vcc, 0
s_cbranch_scc1 L_pv_done
s_sub_u32 s54, s54, 1
s_cmp_lg_u32 s54, 0
s_cbranch_scc1 L_pv
L_pv_done:
s_mov_b32 s68, 200000
L_poll_11:
buffer_load_dword v3, v2, s[16:19], s58 offen sc1
s_sub_u32 s68, s68, 1
s_cbranch_scc1 L_polld_12
s_waitcnt vmcnt(0)
v_cmp_ne_u32 vcc, s48, v3
s_nop 1
s_cmp_eq_u64 vcc, 0
s_cbranch_scc1 L_polld_12
s_sleep 2
s_branch L_poll_11
L_polld_12:
s_waitcnt vmcnt(0)
s_mov_b32 s52, 0
s_mov_b32 s51, 0
s_mov_b32 s61, s63
s_and_b32 s53, s52, 3
s_cmp_eq_u32 s53, s42
s_cselect_b32 s53, 4, 0
s_add_u32 s53, s53, s52
s_cmp_ge_u32 s53, 28
s_cselect_b32 s54, 28, 0
s_sub_u32 s53, s53, s54
s_add_u32 s53, s53, s100
s_cmp_ge_u32 s53, 28
s_cselect_b32 s54, 28, 0
s_sub_u32 s53, s53, s54
s_lshl_b32 s59, s53, 14
s_add_u32 s59, s59, 9437184
s_mov_b32 m0, s61
s_add_u32 s52, s52, 1
buffer_load_dwordx4 v26, s[16:19], s59 offen sc1 lds
s_add_u32 s51, s51, 16384
s_and_b32 s51, s51, 65535
s_add_u32 s61, s51, s63
s_and_b32 s53, s52, 3
s_cmp_eq_u32 s53, s42
s_cselect_b32 s53, 4, 0
buffer_load_dwordx4 v26, s[16:19], s59 offen offset:1024 sc1 lds
s_add_u32 s53, s53, s52
s_cmp_ge_u32 s53, 28
s_cselect_b32 s54, 28, 0
s_sub_u32 s53, s53, s54
s_add_u32 s53, s53, s100
s_cmp_ge_u32 s53, 28
s_cselect_b32 s54, 28, 0
buffer_load_dwordx4 v26, s[16:19], s59 offen offset:2048 sc1 lds
s_sub_u32 s53, s53, s54
s_lshl_b32 s55, s53, 14
s_add_u32 s55, s55, 9437184
buffer_load_dwordx4 v26, s[16:19], s59 offen offset:3072 sc1 lds
s_mov_b32 s59, s55
s_mov_b32 m0, s61
s_add_u32 s52, s52, 1
buffer_load_dwordx4 v26, s[16:19], s59 offen sc1 lds
s_add_u32 s51, s51, 16384
s_and_b32 s51, s51, 65535
s_add_u32 s61, s51, s63
s_and_b32 s53, s52, 3
s_cmp_eq_u32 s53, s42
s_cselect_b32 s53, 4, 0
buffer_load_dwordx4 v26, s[16:19], s59 offen offset:1024 sc1 lds
s_add_u32 s53, s53, s52
s_cmp_ge_u32 s53, 28
s_cselect_b32 s54, 28, 0
s_sub_u32 s53, s53, s54
s_add_u32 s53, s53, s100
s_cmp_ge_u32 s53, 28
s_cselect_b32 s54, 28, 0
buffer_load_dwordx4 v26, s[16:19], s59 offen offset:2048 sc1 lds
s_sub_u32 s53, s53, s54
s_lshl_b32 s55, s53, 14
s_add_u32 s55, s55, 9437184
buffer_load_dwordx4 v26, s[16:19], s59 offen offset:3072 sc1 lds
s_mov_b32 s59, s55
s_waitcnt vmcnt(4)
s_barrier
s_mov_b32 m0, s61
s_add_u32 s52, s52, 1
buffer_load_dwordx4 v26, s[16:19], s59 offen sc1 lds
s_add_u32 s51, s51, 16384
s_and_b32 s51, s51, 65535
s_add_u32 s61, s51, s63
s_and_b32 s53, s52, 3
s_cmp_eq_u32 s53, s42
s_cselect_b32 s53, 4, 0
buffer_load_dwordx4 v26, s[16:19], s59 offen offset:1024 sc1 lds
s_add_u32 s53, s53, s52
s_cmp_ge_u32 s53, 28
s_cselect_b32 s54, 28, 0
s_sub_u32 s53, s53, s54
s_add_u32 s53, s53, s100
s_cmp_ge_u32 s53, 28
s_cselect_b32 s54, 28, 0
buffer_load_dwordx4 v26, s[16:19], s59 offen offset:2048 sc1 lds
s_sub_u32 s53, s53, s54
s_lshl_b32 s55, s53, 14
s_add_u32 s55, s55, 9437184
buffer_load_dwordx4 v26, s[16:19], s59 offen offset:3072 sc1 lds
s_mov_b32 s59, s55
s_waitcnt vmcnt(4)
s_barrier
s_mov_b32 m0, s61
s_and_b32 s53, s57, 3
buffer_load_dwordx4 v26, s[16:19], s59 offen sc1 lds
s_cmp_eq_u32 s53, s42
s_cselect_b32 s53, 4, 0
s_add_u32 s53, s53, s57
s_cmp_ge_u32 s53, 28
s_cselect_b32 s54, 28, 0
buffer_load_dwordx4 v26, s[16:19], s59 offen offset:1024 sc1 lds
s_sub_u32 s53, s53, s54
s_add_u32 s53, s53, s100
s_cmp_ge_u32 s53, 28
s_cselect_b32 s54, 28, 0
buffer_load_dwordx4 v26, s[16:19], s59 offen offset:2048 sc1 lds
s_sub_u32 s53, s53, s54
s_lshl_b32 s60, s53, 17
buffer_load_dwordx4 v26, s[16:19], s59 offen offset:3072 sc1 lds
s_mov_b32 m0, s69
s_add_u32 s52, s52, 1
s_add_u32 s51, s51, 16384
s_and_b32 s51, s51, 65535
s_add_u32 s61, s51, s63
s_add_u32 s57, s57, 1
buffer_load_dwordx4 v27, s[24:27], s60 offen lds
s_and_b32 s53, s52, 3
s_cmp_eq_u32 s53, s42
s_cselect_b32 s53, 4, 0
s_add_u32 s53, s53, s52
s_cmp_ge_u32 s53, 28
s_cselect_b32 s54, 28, 0
s_sub_u32 s53, s53, s54
s_add_u32 s53, s53, s100
s_cmp_ge_u32 s53, 28
s_cselect_b32 s54, 28, 0
s_sub_u32 s53, s53, s54
s_lshl_b32 s55, s53, 14
s_add_u32 s55, s55, 9437184
s_add_u32 s69, s69, 8192
s_cmp_eq_u32 s69, s64
s_cselect_b32 s54, 98304, 0
s_sub_u32 s69, s69, s54
buffer_load_dwordx4 v28, s[24:27], s60 offen offset:1024 lds
s_mov_b32 s59, s55
s_waitcnt vmcnt(6)
s_barrier
s_mov_b32 m0, s61
s_and_b32 s53, s57, 3
buffer_load_dwordx4 v26, s[16:19], s59 offen sc1 lds
s_cmp_eq_u32 s53, s42
s_cselect_b32 s53, 4, 0
s_add_u32 s53, s53, s57
s_cmp_ge_u32 s53, 28
s_cselect_b32 s54, 28, 0
buffer_load_dwordx4 v26, s[16:19], s59 offen offset:1024 sc1 lds
s_sub_u32 s53, s53, s54
s_add_u32 s53, s53, s100
s_cmp_ge_u32 s53, 28
s_cselect_b32 s54, 28, 0
buffer_load_dwordx4 v26, s[16:19], s59 offen offset:2048 sc1 lds
s_sub_u32 s53, s53, s54
s_lshl_b32 s60, s53, 17
buffer_load_dwordx4 v26, s[16:19], s59 offen offset:3072 sc1 lds
s_mov_b32 m0, s69
s_add_u32 s52, s52, 1
s_add_u32 s51, s51, 16384
s_and_b32 s51, s51, 65535
s_add_u32 s61, s51, s63
s_add_u32 s57, s57, 1
buffer_load_dwordx4 v27, s[24:27], s60 offen lds
s_and_b32 s53, s52, 3
s_cmp_eq_u32 s53, s42
s_cselect_b32 s53, 4, 0
s_add_u32 s53, s53, s52
s_cmp_ge_u32 s53, 28
s_cselect_b32 s54, 28, 0
s_sub_u32 s53, s53, s54
s_add_u32 s53, s53, s100
s_cmp_ge_u32 s53, 28
s_cselect_b32 s54, 28, 0
s_sub_u32 s53, s53, s54
s_lshl_b32 s55, s53, 14
s_add_u32 s55, s55, 9437184
s_add_u32 s69, s69, 8192
s_cmp_eq_u32 s69, s64
s_cselect_b32 s54, 98304, 0
s_sub_u32 s69, s69, s54
buffer_load_dwordx4 v28, s[24:27], s60 offen offset:1024 lds
s_mov_b32 s59, s55
s_mov_b32 s56, 18
L_ll_18:
s_mov_b32 m0, s61
s_and_b32 s53, s57, 3
buffer_load_dwordx4 v26, s[16:19], s59 offen sc1 lds
s_cmp_eq_u32 s53, s42
s_cselect_b32 s53, 4, 0
s_add_u32 s53, s53, s57
s_cmp_ge_u32 s53, 28
s_cselect_b32 s54, 28, 0
buffer_load_dwordx4 v26, s[16:19], s59 offen offset:1024 sc1 lds
s_sub_u32 s53, s53, s54
s_add_u32 s53, s53, s100
s_cmp_ge_u32 s53, 28
s_cselect_b32 s54, 28, 0
buffer_load_dwordx4 v26, s[16:19], s59 offen offset:2048 sc1 lds
s_sub_u32 s53, s53, s54
s_lshl_b32 s60, s53, 17
s_waitcnt vmcnt(11)
s_barrier
buffer_load_dwordx4 v26, s[16:19], s59 offen offset:3072 sc1 lds
s_mov_b32 m0, s69
s_add_u32 s52, s52, 1
s_add_u32 s51, s51, 16384
s_and_b32 s51, s51, 65535
s_add_u32 s61, s51, s63
s_add_u32 s57, s57, 1
buffer_load_dwordx4 v27, s[24:27], s60 offen lds
s_and_b32 s53, s52, 3
s_cmp_eq_u32 s53, s42
s_cselect_b32 s53, 4, 0
s_add_u32 s53, s53, s52
s_cmp_ge_u32 s53, 28
s_cselect_b32 s54, 28, 0
s_sub_u32 s53, s53, s54
s_add_u32 s53, s53, s100
s_cmp_ge_u32 s53, 28
s_cselect_b32 s54, 28, 0
s_sub_u32 s53, s53, s54
s_lshl_b32 s55, s53, 14
s_add_u32 s55, s55, 9437184
s_add_u32 s69, s69, 8192
s_cmp_eq_u32 s69, s64
s_cselect_b32 s54, 98304, 0
s_sub_u32 s69, s69, s54
s_sub_u32 s56, s56, 1
s_cmp_lg_u32 s56, 0
buffer_load_dwordx4 v28, s[24:27], s60 offen offset:1024 lds
s_mov_b32 s59, s55
s_cbranch_scc1 L_ll_18
s_mov_b32 m0, s61
s_add_u32 s52, s52, 1
buffer_load_dwordx4 v26, s[16:19], s59 offen sc1 lds
s_add_u32 s51, s51, 16384
s_and_b32 s51, s51, 65535
s_add_u32 s61, s51, s63
s_and_b32 s53, s52, 3
s_cmp_eq_u32 s53, s42
s_cselect_b32 s53, 4, 0
buffer_load_dwordx4 v26, s[16:19], s59 offen offset:1024 sc1 lds
s_add_u32 s53, s53, s52
s_cmp_ge_u32 s53, 28
s_cselect_b32 s54, 28, 0
s_sub_u32 s53, s53, s54
s_add_u32 s53, s53, s100
s_cmp_ge_u32 s53, 28
s_cselect_b32 s54, 28, 0
buffer_load_dwordx4 v26, s[16:19], s59 offen offset:2048 sc1 lds
s_sub_u32 s53, s53, s54
s_lshl_b32 s55, s53, 14
s_add_u32 s55, s55, 9437184
s_waitcnt vmcnt(11)
s_barrier
buffer_load_dwordx4 v26, s[16:19], s59 offen offset:3072 sc1 lds
s_mov_b32 s59, s55
s_mov_b32 m0, s61
s_add_u32 s52, s52, 1
buffer_load_dwordx4 v26, s[16:19], s59 offen sc1 lds
s_add_u32 s51, s51, 16384
s_and_b32 s51, s51, 65535
s_add_u32 s61, s51, s63
s_and_b32 s53, s52, 3
s_cmp_eq_u32 s53, s42
s_cselect_b32 s53, 4, 0
buffer_load_dwordx4 v26, s[16:19], s59 offen offset:1024 sc1 lds
s_add_u32 s53, s53, s52
s_cmp_ge_u32 s53, 28
s_cselect_b32 s54, 28, 0
s_sub_u32 s53, s53, s54
s_add_u32 s53, s53, s100
s_cmp_ge_u32 s53, 28
s_cselect_b32 s54, 28, 0
buffer_load_dwordx4 v26, s[16:19], s59 offen offset:2048 sc1 lds
s_sub_u32 s53, s53, s54
s_lshl_b32 s55, s53, 14
s_add_u32 s55, s55, 9437184
s_waitcnt vmcnt(9)
s_barrier
buffer_load_dwordx4 v26, s[16:19], s59 offen offset:3072 sc1 lds
s_mov_b32 s59, s55
s_mov_b32 m0, s61
s_add_u32 s52, s52, 1
buffer_load_dwordx4 v26, s[16:19], s59 offen sc1 lds
s_add_u32 s51, s51, 16384
s_and_b32 s51, s51, 65535
s_add_u32 s61, s51, s63
s_and_b32 s53, s52, 3
s_cmp_eq_u32 s53, s42
s_cselect_b32 s53, 4, 0
buffer_load_dwordx4 v26, s[16:19], s59 offen offset:1024 sc1 lds
s_add_u32 s53, s53, s52
s_cmp_ge_u32 s53, 28
s_cselect_b32 s54, 28, 0
s_sub_u32 s53, s53, s54
s_add_u32 s53, s53, s100
s_cmp_ge_u32 s53, 28
s_cselect_b32 s54, 28, 0
buffer_load_dwordx4 v26, s[16:19], s59 offen offset:2048 sc1 lds
s_sub_u32 s53, s53, s54
s_lshl_b32 s55, s53, 14
s_add_u32 s55, s55, 9437184
s_waitcnt vmcnt(7)
s_barrier
buffer_load_dwordx4 v26, s[16:19], s59 offen offset:3072 sc1 lds
s_mov_b32 s59, s55
s_mov_b32 m0, s61
s_add_u32 s52, s52, 1
buffer_load_dwordx4 v26, s[16:19], s59 offen sc1 lds
s_add_u32 s51, s51, 16384
s_and_b32 s51, s51, 65535
s_add_u32 s61, s51, s63
s_and_b32 s53, s52, 3
s_cmp_eq_u32 s53, s42
s_cselect_b32 s53, 4, 0
buffer_load_dwordx4 v26, s[16:19], s59 offen offset:1024 sc1 lds
s_add_u32 s53, s53, s52
s_cmp_ge_u32 s53, 28
s_cselect_b32 s54, 28, 0
s_sub_u32 s53, s53, s54
s_add_u32 s53, s53, s100
s_cmp_ge_u32 s53, 28
s_cselect_b32 s54, 28, 0
buffer_load_dwordx4 v26, s[16:19], s59 offen offset:2048 sc1 lds
s_sub_u32 s53, s53, s54
s_lshl_b32 s55, s53, 14
s_add_u32 s55, s55, 9437184
s_waitcnt vmcnt(7)
s_barrier
buffer_load_dwordx4 v26, s[16:19], s59 offen offset:3072 sc1 lds
s_mov_b32 s59, s55
s_mov_b32 m0, s61
s_nop 0
buffer_load_dwordx4 v26, s[16:19], s59 offen sc1 lds
buffer_load_dwordx4 v26, s[16:19], s59 offen offset:1024 sc1 lds
buffer_load_dwordx4 v26, s[16:19], s59 offen offset:2048 sc1 lds
s_waitcnt vmcnt(7)
s_barrier
buffer_load_dwordx4 v26, s[16:19], s59 offen offset:3072 sc1 lds
s_waitcnt lgkmcnt(0)
s_waitcnt vmcnt(4)
s_barrier
s_waitcnt vmcnt(0)
s_barrier
s_endpgm
L_st_retry:
s_mov_b32 s68, 200000
L_st_r2:
s_mul_i32 s54, s40, 28672
s_add_u32 s54, s54, 27262976
buffer_load_dwordx4 v[44:47], v35, s[16:19], s54 offen offset:0 sc1
buffer_load_dwordx4 v[48:51], v35, s[16:19], s54 offen offset:2048 sc1
s_add_u32 s54, s54, 4096
buffer_load_dwordx4 v[52:55], v35, s[16:19], s54 offen offset:0 sc1
buffer_load_dwordx4 v[56:59], v35, s[16:19], s54 offen offset:2048 sc1
s_add_u32 s54, s54, 4096
buffer_load_dwordx4 v[60:63], v35, s[16:19], s54 offen offset:0 sc1
buffer_load_dwordx4 v[64:67], v35, s[16:19], s54 offen offset:2048 sc1
s_add_u32 s54, s54, 4096
buffer_load_dwordx4 v[68:71], v35, s[16:19], s54 offen offset:0 sc1
s_waitcnt vmcnt(0)
v_min_u32 v2, v45, v47
v_max_u32 v3, v45, v47
v_min3_u32 v2, v2, v49, v51
v_max3_u32 v3, v3, v49, v51
v_min3_u32 v2, v2, v53, v55
v_max3_u32 v3, v3, v53, v55
v_min3_u32 v2, v2, v57, v59
v_max3_u32 v3, v3, v57, v59
v_min3_u32 v2, v2, v61, v63
v_max3_u32 v3, v3, v61, v63
v_min3_u32 v2, v2, v65, v67
v_max3_u32 v3, v3, v65, v67
v_min3_u32 v2, v2, v69, v71
v_max3_u32 v3, v3, v69, v71
v_xor_b32 v2, s48, v2
v_xor_b32 v3, s48, v3
v_or_b32 v2, v2, v3
v_cmp_ne_u32 vcc, 0, v2
s_nop 1
s_cmp_eq_u64 vcc, 0
s_cbranch_scc1 L_st_ok
s_sub_u32 s68, s68, 1
s_cbranch_scc0 L_st_r2
s_branch L_st_ok
L_fft0:
    s_add_u32 s47, s57, 14
    s_lshl_b32 s49, s53, 2
    s_add_u32 s49, s49, s55
    s_waitcnt lgkmcnt(0)
L_fft:

    s_load_dwordx2 s[28:29], s[0:1], 24
    s_load_dwordx2 s[32:33], s[0:1], 32
    s_load_dwordx2 s[36:37], s[0:1], 80
    s_mov_b32 s30, 2097152
    s_mov_b32 s34, 2097152
    s_mov_b32 s38, 2048
    v_lshlrev_b32 v6, 4, v0
    s_lshl_b32 s62, s43, 19
    s_lshl_b32 s54, s49, 12
    s_add_u32 s62, s62, s54
s_add_u32 s60, s62, 0
buffer_load_dwordx4 v[8:11], v6, s[8:11], s60 offen offset:0
s_add_u32 s60, s62, 0
buffer_load_dwordx4 v[12:15], v6, s[8:11], s60 offen offset:1024
s_add_u32 s60, s62, 131072
buffer_load_dwordx4 v[16:19], v6, s[8:11], s60 offen offset:0
s_add_u32 s60, s62, 131072
buffer_load_dwordx4 v[20:23], v6, s[8:11], s60 offen offset:1024
s_add_u32 s60, s62, 262144
buffer_load_dwordx4 v[24:27], v6, s[8:11], s60 offen offset:0
s_add_u32 s60, s62, 262144
buffer_load_dwordx4 v[28:31], v6, s[8:11], s60 offen offset:1024
s_add_u32 s60, s62, 393216
buffer_load_dwordx4 v[32:35], v6, s[8:11], s60 offen offset:0
s_add_u32 s60, s62, 393216
buffer_load_dwordx4 v[36:39], v6, s[8:11], s60 offen offset:1024

    v_and_b32 v3, 31, v0
    v_lshrrev_b32 v4, 5, v0
    v_lshrrev_b32 v5, 3, v3
    v_and_b32 v2, 3, v3
    v_lshl_add_u32 v5, v5, 2, v2
    v_bfe_u32 v2, v3, 2, 1
    v_lshl_add_u32 v5, v5, 1, v2
    v_lshlrev_b32 v2, 16, v5
    v_lshl_add_u32 v2, v4, 4, v2
    v_lshlrev_b32 v7, 16, v3
    v_lshl_add_u32 v7, v4, 3, v7
    s_waitcnt lgkmcnt(0)
buffer_load_dwordx4 v[80:83], v2, s[28:31], 0 offen offset:0
buffer_load_dwordx4 v[88:91], v2, s[32:35], 0 offen offset:0
buffer_load_dwordx2 v[96:97], v7, s[28:31], 0 offen offset:0
buffer_load_dwordx2 v[104:105], v7, s[32:35], 0 offen offset:0
buffer_load_dwordx2 v[98:99], v7, s[28:31], 0 offen offset:16
buffer_load_dwordx2 v[106:107], v7, s[32:35], 0 offen offset:16
buffer_load_dwordx4 v[84:87], v2, s[28:31], 0 offen offset:32
buffer_load_dwordx4 v[92:95], v2, s[32:35], 0 offen offset:32
buffer_load_dwordx2 v[100:101], v7, s[28:31], 0 offen offset:32
buffer_load_dwordx2 v[108:109], v7, s[32:35], 0 offen offset:32
buffer_load_dwordx2 v[102:103], v7, s[28:31], 0 offen offset:48
buffer_load_dwordx2 v[110:111], v7, s[32:35], 0 offen offset:48
buffer_load_dwordx4 v[72:75], v6, s[36:39], 0 offen offset:0
buffer_load_dwordx4 v[76:79], v6, s[36:39], 0 offen offset:1024

    s_lshl_b32 s59, s49, 3
    s_add_u32 s59, s59, s43
    s_lshl_b32 s61, s59, 10
    s_mul_i32 s59, s59, 14336
    v_mul_u32_u24 v7, 3584, v4
    v_add_u32 v7, v7, v6
    v_cvt_f32_u32 v5, v5
    v_mul_f32 v5, 0x3a800000, v5
    v_cvt_f32_u32 v2, v4
    v_mul_f32 v2, 4.0, v2
    v_mul_f32 v2, v2, v5
v_fmamk_f32 v120, v5, 0x00000000, v2
v_fmamk_f32 v121, v5, 0x3f800000, v2
s_mov_b32 s3, 262144
v_fmamk_f32 v122, v5, 0x40000000, v2
s_mov_b32 s4, 524288
v_fmamk_f32 v123, v5, 0x40400000, v2
s_mov_b32 s5, 786432
v_fmamk_f32 v124, v5, 0x41000000, v2
s_mov_b32 s6, 2097152
v_fmamk_f32 v125, v5, 0x41100000, v2
s_mov_b32 s7, 2359296
v_fmamk_f32 v126, v5, 0x41200000, v2
s_mov_b32 s44, 2621440
v_fmamk_f32 v127, v5, 0x41300000, v2
s_mov_b32 s45, 2883584
v_fmamk_f32 v128, v5, 0x41800000, v2
s_mov_b32 s46, 4194304
v_fmamk_f32 v129, v5, 0x41880000, v2
s_mov_b32 s50, 4456448
v_fmamk_f32 v130, v5, 0x41900000, v2
s_mov_b32 s51, 4718592
v_fmamk_f32 v131, v5, 0x41980000, v2
s_mov_b32 s52, 4980736
v_fmamk_f32 v132, v5, 0x41c00000, v2
s_mov_b32 s63, 6291456
v_fmamk_f32 v133, v5, 0x41c80000, v2
s_mov_b32 s64, 6553600
v_fmamk_f32 v134, v5, 0x41d00000, v2
s_mov_b32 s65, 6815744
v_fmamk_f32 v135, v5, 0x41d80000, v2
s_mov_b32 s66, 7077888
v_sin_f32 v136, v120
v_cos_f32 v120, v120
v_sin_f32 v137, v121
v_cos_f32 v121, v121
v_sin_f32 v138, v122
v_cos_f32 v122, v122
v_sin_f32 v139, v123
v_cos_f32 v123, v123
v_sin_f32 v140, v124
v_cos_f32 v124, v124
v_sin_f32 v141, v125
v_cos_f32 v125, v125
v_sin_f32 v142, v126
v_cos_f32 v126, v126
v_sin_f32 v143, v127
v_cos_f32 v127, v127
v_sin_f32 v144, v128
v_cos_f32 v128, v128
v_sin_f32 v145, v129
v_cos_f32 v129, v129
v_sin_f32 v146, v130
v_cos_f32 v130, v130
v_sin_f32 v147, v131
v_cos_f32 v131, v131
v_sin_f32 v148, v132
v_cos_f32 v132, v132
v_sin_f32 v149, v133
v_cos_f32 v133, v133
v_sin_f32 v150, v134
v_cos_f32 v134, v134
v_sin_f32 v151, v135
v_cos_f32 v135, v135

    s_lshl_b32 s53, s43, 14
    v_lshl_add_u32 v248, v0, 4, s53
    v_bfe_u32 v232, v0, 2, 2
    v_and_b32 v233, 3, v0
    v_bfe_u32 v234, v0, 4, 1
    v_lshl_add_u32 v2, v4, 3, v232
    v_lshlrev_b32 v249, 6, v2
    v_lshl_add_u32 v249, v234, 5, v249
    v_lshl_add_u32 v249, v233, 3, v249
    v_add_u32 v249, s53, v249
    v_lshlrev_b32 v234, 2, v234
    v_lshrrev_b32 v252, 1, v233
    v_or_b32 v234, v234, v252
    v_and_b32 v252, 1, v232
    v_lshlrev_b32 v252, 1, v252
    v_xor_b32 v234, v234, v252
    v_lshrrev_b32 v252, 1, v232
    v_lshlrev_b32 v252, 3, v252
    v_xor_b32 v234, v234, v252
    v_lshlrev_b32 v234, 4, v234
    v_lshl_add_u32 v234, v2, 12, v234
    v_and_b32 v233, 1, v233
    v_lshl_add_u32 v251, v233, 3, v234
    v_lshlrev_b32 v232, 2, v3
    v_lshl_add_u32 v232, v4, 1, v232
    v_bfe_u32 v233, v3, 1, 2
    v_xor_b32 v232, v232, v233
    v_lshl_add_u32 v250, v232, 4, s53
    v_lshlrev_b32 v1, 2, v3
    v_lshl_add_u32 v1, v4, 20, v1
    s_lshl_b32 s58, s49, 1
s_waitcnt vmcnt(0)
v_xor_b32 v112, 0x80008000, v104
v_xor_b32 v113, 0x80008000, v105
v_xor_b32 v114, 0x80008000, v106
v_xor_b32 v115, 0x80008000, v107
v_xor_b32 v116, 0x80008000, v108
v_xor_b32 v117, 0x80008000, v109
v_xor_b32 v118, 0x80008000, v110
v_xor_b32 v119, 0x80008000, v111
s_load_dwordx2 s[28:29], s[0:1], 8
s_load_dwordx2 s[32:33], s[0:1], 16
s_mov_b32 s30, 8388608
s_mov_b32 s34, 8388608
s_waitcnt lgkmcnt(0)
ds_write_b128 v248, v[8:11] offset:0
ds_write_b128 v248, v[12:15] offset:1024
ds_write_b128 v248, v[16:19] offset:4096
ds_write_b128 v248, v[20:23] offset:5120
ds_write_b128 v248, v[24:27] offset:8192
ds_write_b128 v248, v[28:31] offset:9216
ds_write_b128 v248, v[32:35] offset:12288
ds_write_b128 v248, v[36:39] offset:13312
v_and_b32 v3, 31, v0
v_cvt_f32_u32 v3, v3
v_lshrrev_b32 v4, 5, v0
s_add_u32 s60, s62, 2048
buffer_load_dwordx4 v[40:43], v6, s[8:11], s60 offen offset:0
s_lshr_b32 s53, s43, 2
s_lshl_b32 s53, s53, 3
s_lshl_b32 s54, s43, 1
s_add_u32 s53, s53, s54
v_lshl_add_u32 v4, v4, 3, s53
v_lshl_add_u32 v4, v4, 6, s58
v_cvt_f32_u32 v4, v4
v_mul_f32 v3, 0x3a000000, v3
v_mul_f32 v4, v4, v3
v_fmamk_f32 v5, v3, 0x42800000, v4
v_fract_f32 v4, v4
v_fract_f32 v5, v5
v_cos_f32 v2, v4
v_cos_f32 v3, v5
v_sin_f32 v4, v4
v_sin_f32 v5, v5
s_lshr_b32 s53, s43, 2
s_lshl_b32 s53, s53, 10
s_and_b32 s54, s43, 3
s_lshl_b32 s54, s54, 2
s_add_u32 s53, s53, s54
s_add_u32 s53, s53, 131072
s_add_u32 s60, s62, 2048
buffer_load_dwordx4 v[44:47], v6, s[8:11], s60 offen offset:1024
v_cvt_pk_bf16_f32 v2, v2, v3
v_cvt_pk_bf16_f32 v4, v4, v5
v_add_u32 v3, s53, v6
ds_write_b32 v3, v2
ds_write_b32 v3, v4 offset:2048
v_mov_b32 v232, 0
v_mov_b32 v233, 0
v_mov_b32 v234, 0
v_mov_b32 v235, 0
v_dot2_f32_bf16 v232, v8, v72, v232
v_dot2_f32_bf16 v233, v16, v72, v233
v_dot2_f32_bf16 v234, v24, v72, v234
v_dot2_f32_bf16 v235, v32, v72, v235
v_dot2_f32_bf16 v232, v9, v73, v232
v_dot2_f32_bf16 v233, v17, v73, v233
v_dot2_f32_bf16 v234, v25, v73, v234
v_dot2_f32_bf16 v235, v33, v73, v235
v_dot2_f32_bf16 v232, v10, v74, v232
v_dot2_f32_bf16 v233, v18, v74, v233
v_dot2_f32_bf16 v234, v26, v74, v234
v_dot2_f32_bf16 v235, v34, v74, v235
s_add_u32 s60, s62, 133120
buffer_load_dwordx4 v[48:51], v6, s[8:11], s60 offen offset:0
v_dot2_f32_bf16 v232, v11, v75, v232
v_dot2_f32_bf16 v233, v19, v75, v233
v_dot2_f32_bf16 v234, v27, v75, v234
v_dot2_f32_bf16 v235, v35, v75, v235
v_dot2_f32_bf16 v232, v12, v76, v232
v_dot2_f32_bf16 v233, v20, v76, v233
v_dot2_f32_bf16 v234, v28, v76, v234
v_dot2_f32_bf16 v235, v36, v76, v235
v_dot2_f32_bf16 v232, v13, v77, v232
v_dot2_f32_bf16 v233, v21, v77, v233
v_dot2_f32_bf16 v234, v29, v77, v234
v_dot2_f32_bf16 v235, v37, v77, v235
v_dot2_f32_bf16 v232, v14, v78, v232
v_dot2_f32_bf16 v233, v22, v78, v233
v_dot2_f32_bf16 v234, v30, v78, v234
v_dot2_f32_bf16 v235, v38, v78, v235
v_dot2_f32_bf16 v232, v15, v79, v232
v_dot2_f32_bf16 v233, v23, v79, v233
v_dot2_f32_bf16 v234, v31, v79, v234
v_dot2_f32_bf16 v235, v39, v79, v235
v_add_f32_dpp v232, v232, v232 quad_perm:[1,0,3,2] row_mask:0xf bank_mask:0xf
s_add_u32 s60, s62, 133120
buffer_load_dwordx4 v[52:55], v6, s[8:11], s60 offen offset:1024
v_add_f32_dpp v233, v233, v233 quad_perm:[1,0,3,2] row_mask:0xf bank_mask:0xf
v_add_f32_dpp v234, v234, v234 quad_perm:[1,0,3,2] row_mask:0xf bank_mask:0xf
v_add_f32_dpp v235, v235, v235 quad_perm:[1,0,3,2] row_mask:0xf bank_mask:0xf
v_add_f32_dpp v232, v232, v232 quad_perm:[2,3,0,1] row_mask:0xf bank_mask:0xf
v_add_f32_dpp v233, v233, v233 quad_perm:[2,3,0,1] row_mask:0xf bank_mask:0xf
v_add_f32_dpp v234, v234, v234 quad_perm:[2,3,0,1] row_mask:0xf bank_mask:0xf
v_add_f32_dpp v235, v235, v235 quad_perm:[2,3,0,1] row_mask:0xf bank_mask:0xf
v_add_f32_dpp v232, v232, v232 row_half_mirror row_mask:0xf bank_mask:0xf
v_add_f32_dpp v233, v233, v233 row_half_mirror row_mask:0xf bank_mask:0xf
v_add_f32_dpp v234, v234, v234 row_half_mirror row_mask:0xf bank_mask:0xf
v_add_f32_dpp v235, v235, v235 row_half_mirror row_mask:0xf bank_mask:0xf
v_add_f32_dpp v232, v232, v232 row_mirror row_mask:0xf bank_mask:0xf
v_add_f32_dpp v233, v233, v233 row_mirror row_mask:0xf bank_mask:0xf
v_add_f32_dpp v234, v234, v234 row_mirror row_mask:0xf bank_mask:0xf
v_add_f32_dpp v235, v235, v235 row_mirror row_mask:0xf bank_mask:0xf
v_add_f32_dpp v232, v232, v232 row_bcast:15 row_mask:0xa bank_mask:0xf
v_add_f32_dpp v233, v233, v233 row_bcast:15 row_mask:0xa bank_mask:0xf
v_add_f32_dpp v234, v234, v234 row_bcast:15 row_mask:0xa bank_mask:0xf
v_add_f32_dpp v235, v235, v235 row_bcast:15 row_mask:0xa bank_mask:0xf
v_add_f32_dpp v232, v232, v232 row_bcast:31 row_mask:0xc bank_mask:0xf
v_add_f32_dpp v233, v233, v233 row_bcast:31 row_mask:0xc bank_mask:0xf
v_add_f32_dpp v234, v234, v234 row_bcast:31 row_mask:0xc bank_mask:0xf
s_add_u32 s60, s62, 264192
buffer_load_dwordx4 v[56:59], v6, s[8:11], s60 offen offset:0
v_add_f32_dpp v235, v235, v235 row_bcast:31 row_mask:0xc bank_mask:0xf
s_waitcnt lgkmcnt(0)
ds_read_b64_tr_b16 v[176:177], v249 offset:0
ds_read_b64_tr_b16 v[178:179], v249 offset:256
ds_read_b64_tr_b16 v[180:181], v249 offset:1024
ds_read_b64_tr_b16 v[182:183], v249 offset:1280
v_mul_f32 v232, 0xbfb8aa3b, v232
v_mul_f32 v233, 0xbfb8aa3b, v233
v_mul_f32 v234, 0xbfb8aa3b, v234
v_mul_f32 v235, 0xbfb8aa3b, v235
v_exp_f32 v232, v232
v_exp_f32 v233, v233
v_exp_f32 v234, v234
v_exp_f32 v235, v235
v_add_f32 v232, 1.0, v232
v_add_f32 v233, 1.0, v233
v_add_f32 v234, 1.0, v234
v_add_f32 v235, 1.0, v235
v_rcp_f32 v232, v232
v_rcp_f32 v233, v233
v_rcp_f32 v234, v234
s_add_u32 s60, s62, 264192
buffer_load_dwordx4 v[60:63], v6, s[8:11], s60 offen offset:1024
v_rcp_f32 v235, v235
s_lshl_b32 s53, s43, 10
s_lshl_b32 s54, s58, 2
s_add_u32 s53, s53, s54
s_add_u32 s53, s53, 26214400
s_mov_b32 exec_lo, 0
s_mov_b32 exec_hi, 0x80000000
buffer_store_dword v232, off, s[16:19], s53 offset:0 sc1
buffer_store_dword v233, off, s[16:19], s53 offset:256 sc1
buffer_store_dword v234, off, s[16:19], s53 offset:512 sc1
buffer_store_dword v235, off, s[16:19], s53 offset:768 sc1
s_mov_b64 exec, -1
s_waitcnt lgkmcnt(0)
v_mfma_f32_32x32x16_bf16 v[184:199], v[176:179], v[80:83], 0
v_mfma_f32_32x32x16_bf16 v[200:215], v[176:179], v[88:91], 0
v_mfma_f32_32x32x16_bf16 v[184:199], v[180:183], v[84:87], v[184:199]
v_mfma_f32_32x32x16_bf16 v[200:215], v[180:183], v[92:95], v[200:215]
ds_read_b64_tr_b16 v[176:177], v249 offset:4096
ds_read_b64_tr_b16 v[178:179], v249 offset:4352
ds_read_b64_tr_b16 v[180:181], v249 offset:5120
ds_read_b64_tr_b16 v[182:183], v249 offset:5376
s_nop 6
v_pk_mul_f32 v[232:233], v[184:185], v[120:121]
v_pk_mul_f32 v[234:235], v[200:201], v[120:121]
v_pk_fma_f32 v[232:233], v[200:201], v[136:137], v[232:233]
v_pk_fma_f32 v[234:235], v[184:185], v[136:137], v[234:235] neg_lo:[1,0,0] neg_hi:[1,0,0]
v_cvt_pk_bf16_f32 v216, v232, v233
v_cvt_pk_bf16_f32 v224, v234, v235
s_add_u32 s60, s62, 395264
buffer_load_dwordx4 v[64:67], v6, s[8:11], s60 offen offset:0
v_pk_mul_f32 v[236:237], v[186:187], v[122:123]
v_pk_mul_f32 v[238:239], v[202:203], v[122:123]
v_pk_fma_f32 v[236:237], v[202:203], v[138:139], v[236:237]
v_pk_fma_f32 v[238:239], v[186:187], v[138:139], v[238:239] neg_lo:[1,0,0] neg_hi:[1,0,0]
v_cvt_pk_bf16_f32 v217, v236, v237
v_cvt_pk_bf16_f32 v225, v238, v239
v_pk_mul_f32 v[232:233], v[188:189], v[124:125]
v_pk_mul_f32 v[234:235], v[204:205], v[124:125]
v_pk_fma_f32 v[232:233], v[204:205], v[140:141], v[232:233]
v_pk_fma_f32 v[234:235], v[188:189], v[140:141], v[234:235] neg_lo:[1,0,0] neg_hi:[1,0,0]
v_cvt_pk_bf16_f32 v218, v232, v233
v_cvt_pk_bf16_f32 v226, v234, v235
v_pk_mul_f32 v[236:237], v[190:191], v[126:127]
v_pk_mul_f32 v[238:239], v[206:207], v[126:127]
v_pk_fma_f32 v[236:237], v[206:207], v[142:143], v[236:237]
v_pk_fma_f32 v[238:239], v[190:191], v[142:143], v[238:239] neg_lo:[1,0,0] neg_hi:[1,0,0]
v_cvt_pk_bf16_f32 v219, v236, v237
v_cvt_pk_bf16_f32 v227, v238, v239
v_pk_mul_f32 v[232:233], v[192:193], v[128:129]
v_pk_mul_f32 v[234:235], v[208:209], v[128:129]
v_pk_fma_f32 v[232:233], v[208:209], v[144:145], v[232:233]
v_pk_fma_f32 v[234:235], v[192:193], v[144:145], v[234:235] neg_lo:[1,0,0] neg_hi:[1,0,0]
s_add_u32 s60, s62, 395264
buffer_load_dwordx4 v[68:71], v6, s[8:11], s60 offen offset:1024
v_cvt_pk_bf16_f32 v220, v232, v233
v_cvt_pk_bf16_f32 v228, v234, v235
v_pk_mul_f32 v[236:237], v[194:195], v[130:131]
v_pk_mul_f32 v[238:239], v[210:211], v[130:131]
v_pk_fma_f32 v[236:237], v[210:211], v[146:147], v[236:237]
v_pk_fma_f32 v[238:239], v[194:195], v[146:147], v[238:239] neg_lo:[1,0,0] neg_hi:[1,0,0]
v_cvt_pk_bf16_f32 v221, v236, v237
v_cvt_pk_bf16_f32 v229, v238, v239
v_pk_mul_f32 v[232:233], v[196:197], v[132:133]
v_pk_mul_f32 v[234:235], v[212:213], v[132:133]
v_pk_fma_f32 v[232:233], v[212:213], v[148:149], v[232:233]
v_pk_fma_f32 v[234:235], v[196:197], v[148:149], v[234:235] neg_lo:[1,0,0] neg_hi:[1,0,0]
v_cvt_pk_bf16_f32 v222, v232, v233
v_cvt_pk_bf16_f32 v230, v234, v235
v_pk_mul_f32 v[236:237], v[198:199], v[134:135]
v_pk_mul_f32 v[238:239], v[214:215], v[134:135]
v_pk_fma_f32 v[236:237], v[214:215], v[150:151], v[236:237]
v_pk_fma_f32 v[238:239], v[198:199], v[150:151], v[238:239] neg_lo:[1,0,0] neg_hi:[1,0,0]
v_cvt_pk_bf16_f32 v223, v236, v237
v_cvt_pk_bf16_f32 v231, v238, v239
s_waitcnt lgkmcnt(0)
s_add_u32 s60, s59, 0
buffer_load_dwordx4 v[244:247], v6, s[12:15], s60 offen
v_mfma_f32_32x32x16_bf16 v[184:199], v[176:179], v[80:83], 0
v_mfma_f32_32x32x16_bf16 v[200:215], v[176:179], v[88:91], 0
v_mfma_f32_32x32x16_bf16 v[184:199], v[180:183], v[84:87], v[184:199]
v_mfma_f32_32x32x16_bf16 v[200:215], v[180:183], v[92:95], v[200:215]
ds_read_b64_tr_b16 v[176:177], v249 offset:8192
ds_read_b64_tr_b16 v[178:179], v249 offset:8448
ds_read_b64_tr_b16 v[180:181], v249 offset:9216
ds_read_b64_tr_b16 v[182:183], v249 offset:9472
v_mfma_f32_32x32x16_bf16 v[8:23], v[216:219], v[96:99], 0
s_nop 5
v_pk_mul_f32 v[232:233], v[184:185], v[120:121]
v_pk_mul_f32 v[234:235], v[200:201], v[120:121]
v_pk_fma_f32 v[232:233], v[200:201], v[136:137], v[232:233]
v_pk_fma_f32 v[234:235], v[184:185], v[136:137], v[234:235] neg_lo:[1,0,0] neg_hi:[1,0,0]
v_cvt_pk_bf16_f32 v152, v232, v233
v_cvt_pk_bf16_f32 v160, v234, v235
v_mfma_f32_32x32x16_bf16 v[24:39], v[216:219], v[104:107], 0
v_pk_mul_f32 v[236:237], v[186:187], v[122:123]
v_pk_mul_f32 v[238:239], v[202:203], v[122:123]
v_pk_fma_f32 v[236:237], v[202:203], v[138:139], v[236:237]
v_pk_fma_f32 v[238:239], v[186:187], v[138:139], v[238:239] neg_lo:[1,0,0] neg_hi:[1,0,0]
v_cvt_pk_bf16_f32 v153, v236, v237
s_add_u32 s60, s59, 1024
buffer_load_dwordx4 v[244:247], v6, s[12:15], s60 offen
v_cvt_pk_bf16_f32 v161, v238, v239
v_mfma_f32_32x32x16_bf16 v[8:23], v[220:223], v[100:103], v[8:23]
v_pk_mul_f32 v[232:233], v[188:189], v[124:125]
v_pk_mul_f32 v[234:235], v[204:205], v[124:125]
v_pk_fma_f32 v[232:233], v[204:205], v[140:141], v[232:233]
v_pk_fma_f32 v[234:235], v[188:189], v[140:141], v[234:235] neg_lo:[1,0,0] neg_hi:[1,0,0]
v_cvt_pk_bf16_f32 v154, v232, v233
v_cvt_pk_bf16_f32 v162, v234, v235
v_mfma_f32_32x32x16_bf16 v[24:39], v[220:223], v[108:111], v[24:39]
v_pk_mul_f32 v[236:237], v[190:191], v[126:127]
v_pk_mul_f32 v[238:239], v[206:207], v[126:127]
v_pk_fma_f32 v[236:237], v[206:207], v[142:143], v[236:237]
v_pk_fma_f32 v[238:239], v[190:191], v[142:143], v[238:239] neg_lo:[1,0,0] neg_hi:[1,0,0]
v_cvt_pk_bf16_f32 v155, v236, v237
v_cvt_pk_bf16_f32 v163, v238, v239
v_mfma_f32_32x32x16_bf16 v[8:23], v[224:227], v[112:115], v[8:23]
v_pk_mul_f32 v[232:233], v[192:193], v[128:129]
v_pk_mul_f32 v[234:235], v[208:209], v[128:129]
v_pk_fma_f32 v[232:233], v[208:209], v[144:145], v[232:233]
v_pk_fma_f32 v[234:235], v[192:193], v[144:145], v[234:235] neg_lo:[1,0,0] neg_hi:[1,0,0]
v_cvt_pk_bf16_f32 v156, v232, v233
v_cvt_pk_bf16_f32 v164, v234, v235
s_add_u32 s60, s59, 2048
buffer_load_dwordx4 v[244:247], v6, s[12:15], s60 offen
v_mfma_f32_32x32x16_bf16 v[24:39], v[224:227], v[96:99], v[24:39]
v_pk_mul_f32 v[236:237], v[194:195], v[130:131]
v_pk_mul_f32 v[238:239], v[210:211], v[130:131]
v_pk_fma_f32 v[236:237], v[210:211], v[146:147], v[236:237]
v_pk_fma_f32 v[238:239], v[194:195], v[146:147], v[238:239] neg_lo:[1,0,0] neg_hi:[1,0,0]
v_cvt_pk_bf16_f32 v157, v236, v237
v_cvt_pk_bf16_f32 v165, v238, v239
v_mfma_f32_32x32x16_bf16 v[8:23], v[228:231], v[116:119], v[8:23]
v_pk_mul_f32 v[232:233], v[196:197], v[132:133]
v_pk_mul_f32 v[234:235], v[212:213], v[132:133]
v_pk_fma_f32 v[232:233], v[212:213], v[148:149], v[232:233]
v_pk_fma_f32 v[234:235], v[196:197], v[148:149], v[234:235] neg_lo:[1,0,0] neg_hi:[1,0,0]
v_cvt_pk_bf16_f32 v158, v232, v233
v_cvt_pk_bf16_f32 v166, v234, v235
v_mfma_f32_32x32x16_bf16 v[24:39], v[228:231], v[100:103], v[24:39]
v_pk_mul_f32 v[236:237], v[198:199], v[134:135]
v_pk_mul_f32 v[238:239], v[214:215], v[134:135]
v_pk_fma_f32 v[236:237], v[214:215], v[150:151], v[236:237]
v_pk_fma_f32 v[238:239], v[198:199], v[150:151], v[238:239] neg_lo:[1,0,0] neg_hi:[1,0,0]
v_cvt_pk_bf16_f32 v159, v236, v237
v_cvt_pk_bf16_f32 v167, v238, v239
s_add_u32 s60, s59, 3072
buffer_load_dwordx4 v[244:247], v7, s[12:15], s60 offen
s_waitcnt lgkmcnt(0)
v_mfma_f32_32x32x16_bf16 v[184:199], v[176:179], v[80:83], 0
v_mfma_f32_32x32x16_bf16 v[200:215], v[176:179], v[88:91], 0
v_mfma_f32_32x32x16_bf16 v[184:199], v[180:183], v[84:87], v[184:199]
v_mfma_f32_32x32x16_bf16 v[200:215], v[180:183], v[92:95], v[200:215]
ds_read_b64_tr_b16 v[176:177], v249 offset:12288
ds_read_b64_tr_b16 v[178:179], v249 offset:12544
ds_read_b64_tr_b16 v[180:181], v249 offset:13312
ds_read_b64_tr_b16 v[182:183], v249 offset:13568
s_nop 3
v_xor_b32 v2, 0, v250
v_xor_b32 v3, 16, v250
v_cvt_pk_bf16_f32 v216, v8, v9
v_cvt_pk_bf16_f32 v217, v10, v11
v_cvt_pk_bf16_f32 v218, v12, v13
v_cvt_pk_bf16_f32 v219, v14, v15
v_cvt_pk_bf16_f32 v220, v16, v17
v_cvt_pk_bf16_f32 v221, v18, v19
v_cvt_pk_bf16_f32 v222, v20, v21
v_cvt_pk_bf16_f32 v223, v22, v23
ds_write_b128 v2, v[216:219] offset:0
ds_write_b128 v3, v[220:223] offset:0
s_add_u32 s60, s59, 7680
buffer_load_dwordx4 v[244:247], v6, s[12:15], s60 offen
v_cvt_pk_bf16_f32 v224, v24, v25
v_cvt_pk_bf16_f32 v225, v26, v27
v_cvt_pk_bf16_f32 v226, v28, v29
v_cvt_pk_bf16_f32 v227, v30, v31
v_cvt_pk_bf16_f32 v228, v32, v33
v_cvt_pk_bf16_f32 v229, v34, v35
v_cvt_pk_bf16_f32 v230, v36, v37
v_cvt_pk_bf16_f32 v231, v38, v39
ds_write_b128 v2, v[224:227] offset:2048
ds_write_b128 v3, v[228:231] offset:2048
v_mfma_f32_32x32x16_bf16 v[8:23], v[152:155], v[96:99], 0
v_pk_mul_f32 v[232:233], v[184:185], v[120:121]
v_pk_mul_f32 v[234:235], v[200:201], v[120:121]
v_pk_fma_f32 v[232:233], v[200:201], v[136:137], v[232:233]
v_pk_fma_f32 v[234:235], v[184:185], v[136:137], v[234:235] neg_lo:[1,0,0] neg_hi:[1,0,0]
v_cvt_pk_bf16_f32 v216, v232, v233
v_cvt_pk_bf16_f32 v224, v234, v235
v_mfma_f32_32x32x16_bf16 v[24:39], v[152:155], v[104:107], 0
v_pk_mul_f32 v[236:237], v[186:187], v[122:123]
v_pk_mul_f32 v[238:239], v[202:203], v[122:123]
v_pk_fma_f32 v[236:237], v[202:203], v[138:139], v[236:237]
s_add_u32 s60, s59, 8704
buffer_load_dwordx4 v[244:247], v6, s[12:15], s60 offen
v_pk_fma_f32 v[238:239], v[186:187], v[138:139], v[238:239] neg_lo:[1,0,0] neg_hi:[1,0,0]
v_cvt_pk_bf16_f32 v217, v236, v237
v_cvt_pk_bf16_f32 v225, v238, v239
v_mfma_f32_32x32x16_bf16 v[8:23], v[156:159], v[100:103], v[8:23]
v_pk_mul_f32 v[232:233], v[188:189], v[124:125]
v_pk_mul_f32 v[234:235], v[204:205], v[124:125]
v_pk_fma_f32 v[232:233], v[204:205], v[140:141], v[232:233]
v_pk_fma_f32 v[234:235], v[188:189], v[140:141], v[234:235] neg_lo:[1,0,0] neg_hi:[1,0,0]
v_cvt_pk_bf16_f32 v218, v232, v233
v_cvt_pk_bf16_f32 v226, v234, v235
v_mfma_f32_32x32x16_bf16 v[24:39], v[156:159], v[108:111], v[24:39]
v_pk_mul_f32 v[236:237], v[190:191], v[126:127]
v_pk_mul_f32 v[238:239], v[206:207], v[126:127]
v_pk_fma_f32 v[236:237], v[206:207], v[142:143], v[236:237]
v_pk_fma_f32 v[238:239], v[190:191], v[142:143], v[238:239] neg_lo:[1,0,0] neg_hi:[1,0,0]
v_cvt_pk_bf16_f32 v219, v236, v237
v_cvt_pk_bf16_f32 v227, v238, v239
v_mfma_f32_32x32x16_bf16 v[8:23], v[160:163], v[112:115], v[8:23]
v_pk_mul_f32 v[232:233], v[192:193], v[128:129]
v_pk_mul_f32 v[234:235], v[208:209], v[128:129]
v_pk_fma_f32 v[232:233], v[208:209], v[144:145], v[232:233]
s_add_u32 s60, s59, 9728
buffer_load_dwordx4 v[244:247], v6, s[12:15], s60 offen
v_pk_fma_f32 v[234:235], v[192:193], v[144:145], v[234:235] neg_lo:[1,0,0] neg_hi:[1,0,0]
v_cvt_pk_bf16_f32 v220, v232, v233
v_cvt_pk_bf16_f32 v228, v234, v235
v_mfma_f32_32x32x16_bf16 v[24:39], v[160:163], v[96:99], v[24:39]
v_pk_mul_f32 v[236:237], v[194:195], v[130:131]
v_pk_mul_f32 v[238:239], v[210:211], v[130:131]
v_pk_fma_f32 v[236:237], v[210:211], v[146:147], v[236:237]
v_pk_fma_f32 v[238:239], v[194:195], v[146:147], v[238:239] neg_lo:[1,0,0] neg_hi:[1,0,0]
v_cvt_pk_bf16_f32 v221, v236, v237
v_cvt_pk_bf16_f32 v229, v238, v239
v_mfma_f32_32x32x16_bf16 v[8:23], v[164:167], v[116:119], v[8:23]
v_pk_mul_f32 v[232:233], v[196:197], v[132:133]
v_pk_mul_f32 v[234:235], v[212:213], v[132:133]
v_pk_fma_f32 v[232:233], v[212:213], v[148:149], v[232:233]
v_pk_fma_f32 v[234:235], v[196:197], v[148:149], v[234:235] neg_lo:[1,0,0] neg_hi:[1,0,0]
v_cvt_pk_bf16_f32 v222, v232, v233
v_cvt_pk_bf16_f32 v230, v234, v235
v_mfma_f32_32x32x16_bf16 v[24:39], v[164:167], v[100:103], v[24:39]
v_pk_mul_f32 v[236:237], v[198:199], v[134:135]
v_pk_mul_f32 v[238:239], v[214:215], v[134:135]
v_pk_fma_f32 v[236:237], v[214:215], v[150:151], v[236:237]
v_pk_fma_f32 v[238:239], v[198:199], v[150:151], v[238:239] neg_lo:[1,0,0] neg_hi:[1,0,0]
s_add_u32 s60, s59, 3670016
buffer_load_dwordx4 v[244:247], v6, s[12:15], s60 offen
v_cvt_pk_bf16_f32 v223, v236, v237
v_cvt_pk_bf16_f32 v231, v238, v239
s_waitcnt lgkmcnt(0)
v_mfma_f32_32x32x16_bf16 v[184:199], v[176:179], v[80:83], 0
v_mfma_f32_32x32x16_bf16 v[200:215], v[176:179], v[88:91], 0
v_mfma_f32_32x32x16_bf16 v[184:199], v[180:183], v[84:87], v[184:199]
v_mfma_f32_32x32x16_bf16 v[200:215], v[180:183], v[92:95], v[200:215]
s_nop 3
v_xor_b32 v2, 32, v250
v_xor_b32 v3, 48, v250
v_cvt_pk_bf16_f32 v152, v8, v9
v_cvt_pk_bf16_f32 v153, v10, v11
v_cvt_pk_bf16_f32 v154, v12, v13
v_cvt_pk_bf16_f32 v155, v14, v15
v_cvt_pk_bf16_f32 v156, v16, v17
v_cvt_pk_bf16_f32 v157, v18, v19
v_cvt_pk_bf16_f32 v158, v20, v21
v_cvt_pk_bf16_f32 v159, v22, v23
ds_write_b128 v2, v[152:155] offset:4096
ds_write_b128 v3, v[156:159] offset:4096
v_cvt_pk_bf16_f32 v160, v24, v25
s_add_u32 s60, s59, 3671040
buffer_load_dwordx4 v[244:247], v6, s[12:15], s60 offen
v_cvt_pk_bf16_f32 v161, v26, v27
v_cvt_pk_bf16_f32 v162, v28, v29
v_cvt_pk_bf16_f32 v163, v30, v31
v_cvt_pk_bf16_f32 v164, v32, v33
v_cvt_pk_bf16_f32 v165, v34, v35
v_cvt_pk_bf16_f32 v166, v36, v37
v_cvt_pk_bf16_f32 v167, v38, v39
ds_write_b128 v2, v[160:163] offset:6144
ds_write_b128 v3, v[164:167] offset:6144
v_mfma_f32_32x32x16_bf16 v[8:23], v[216:219], v[96:99], 0
v_pk_mul_f32 v[232:233], v[184:185], v[120:121]
v_pk_mul_f32 v[234:235], v[200:201], v[120:121]
v_pk_fma_f32 v[232:233], v[200:201], v[136:137], v[232:233]
v_pk_fma_f32 v[234:235], v[184:185], v[136:137], v[234:235] neg_lo:[1,0,0] neg_hi:[1,0,0]
v_cvt_pk_bf16_f32 v152, v232, v233
v_cvt_pk_bf16_f32 v160, v234, v235
v_mfma_f32_32x32x16_bf16 v[24:39], v[216:219], v[104:107], 0
v_pk_mul_f32 v[236:237], v[186:187], v[122:123]
v_pk_mul_f32 v[238:239], v[202:203], v[122:123]
v_pk_fma_f32 v[236:237], v[202:203], v[138:139], v[236:237]
v_pk_fma_f32 v[238:239], v[186:187], v[138:139], v[238:239] neg_lo:[1,0,0] neg_hi:[1,0,0]
s_add_u32 s60, s59, 3672064
buffer_load_dwordx4 v[244:247], v6, s[12:15], s60 offen
v_cvt_pk_bf16_f32 v153, v236, v237
v_cvt_pk_bf16_f32 v161, v238, v239
v_mfma_f32_32x32x16_bf16 v[8:23], v[220:223], v[100:103], v[8:23]
v_pk_mul_f32 v[232:233], v[188:189], v[124:125]
v_pk_mul_f32 v[234:235], v[204:205], v[124:125]
v_pk_fma_f32 v[232:233], v[204:205], v[140:141], v[232:233]
v_pk_fma_f32 v[234:235], v[188:189], v[140:141], v[234:235] neg_lo:[1,0,0] neg_hi:[1,0,0]
v_cvt_pk_bf16_f32 v154, v232, v233
v_cvt_pk_bf16_f32 v162, v234, v235
v_mfma_f32_32x32x16_bf16 v[24:39], v[220:223], v[108:111], v[24:39]
v_pk_mul_f32 v[236:237], v[190:191], v[126:127]
v_pk_mul_f32 v[238:239], v[206:207], v[126:127]
v_pk_fma_f32 v[236:237], v[206:207], v[142:143], v[236:237]
v_pk_fma_f32 v[238:239], v[190:191], v[142:143], v[238:239] neg_lo:[1,0,0] neg_hi:[1,0,0]
v_cvt_pk_bf16_f32 v155, v236, v237
v_cvt_pk_bf16_f32 v163, v238, v239
v_mfma_f32_32x32x16_bf16 v[8:23], v[224:227], v[112:115], v[8:23]
v_pk_mul_f32 v[232:233], v[192:193], v[128:129]
v_pk_mul_f32 v[234:235], v[208:209], v[128:129]
v_pk_fma_f32 v[232:233], v[208:209], v[144:145], v[232:233]
v_pk_fma_f32 v[234:235], v[192:193], v[144:145], v[234:235] neg_lo:[1,0,0] neg_hi:[1,0,0]
v_cvt_pk_bf16_f32 v156, v232, v233
s_add_u32 s60, s59, 3673088
buffer_load_dwordx4 v[244:247], v7, s[12:15], s60 offen
v_cvt_pk_bf16_f32 v164, v234, v235
v_mfma_f32_32x32x16_bf16 v[24:39], v[224:227], v[96:99], v[24:39]
v_pk_mul_f32 v[236:237], v[194:195], v[130:131]
v_pk_mul_f32 v[238:239], v[210:211], v[130:131]
v_pk_fma_f32 v[236:237], v[210:211], v[146:147], v[236:237]
v_pk_fma_f32 v[238:239], v[194:195], v[146:147], v[238:239] neg_lo:[1,0,0] neg_hi:[1,0,0]
v_cvt_pk_bf16_f32 v157, v236, v237
v_cvt_pk_bf16_f32 v165, v238, v239
v_mfma_f32_32x32x16_bf16 v[8:23], v[228:231], v[116:119], v[8:23]
v_pk_mul_f32 v[232:233], v[196:197], v[132:133]
v_pk_mul_f32 v[234:235], v[212:213], v[132:133]
v_pk_fma_f32 v[232:233], v[212:213], v[148:149], v[232:233]
v_pk_fma_f32 v[234:235], v[196:197], v[148:149], v[234:235] neg_lo:[1,0,0] neg_hi:[1,0,0]
v_cvt_pk_bf16_f32 v158, v232, v233
v_cvt_pk_bf16_f32 v166, v234, v235
v_mfma_f32_32x32x16_bf16 v[24:39], v[228:231], v[100:103], v[24:39]
v_pk_mul_f32 v[236:237], v[198:199], v[134:135]
v_pk_mul_f32 v[238:239], v[214:215], v[134:135]
v_pk_fma_f32 v[236:237], v[214:215], v[150:151], v[236:237]
v_pk_fma_f32 v[238:239], v[198:199], v[150:151], v[238:239] neg_lo:[1,0,0] neg_hi:[1,0,0]
v_cvt_pk_bf16_f32 v159, v236, v237
s_add_u32 s60, s59, 3677696
buffer_load_dwordx4 v[244:247], v6, s[12:15], s60 offen
v_cvt_pk_bf16_f32 v167, v238, v239
v_xor_b32 v2, 128, v250
v_xor_b32 v3, 144, v250
v_cvt_pk_bf16_f32 v216, v8, v9
v_cvt_pk_bf16_f32 v217, v10, v11
v_cvt_pk_bf16_f32 v218, v12, v13
v_cvt_pk_bf16_f32 v219, v14, v15
v_cvt_pk_bf16_f32 v220, v16, v17
v_cvt_pk_bf16_f32 v221, v18, v19
v_cvt_pk_bf16_f32 v222, v20, v21
v_cvt_pk_bf16_f32 v223, v22, v23
ds_write_b128 v2, v[216:219] offset:8192
ds_write_b128 v3, v[220:223] offset:8192
v_cvt_pk_bf16_f32 v224, v24, v25
v_cvt_pk_bf16_f32 v225, v26, v27
v_cvt_pk_bf16_f32 v226, v28, v29
v_cvt_pk_bf16_f32 v227, v30, v31
v_cvt_pk_bf16_f32 v228, v32, v33
v_cvt_pk_bf16_f32 v229, v34, v35
v_cvt_pk_bf16_f32 v230, v36, v37
v_cvt_pk_bf16_f32 v231, v38, v39
s_add_u32 s60, s59, 3678720
buffer_load_dwordx4 v[244:247], v6, s[12:15], s60 offen
ds_write_b128 v2, v[224:227] offset:10240
ds_write_b128 v3, v[228:231] offset:10240
v_mfma_f32_32x32x16_bf16 v[8:23], v[152:155], v[96:99], 0
v_mfma_f32_32x32x16_bf16 v[24:39], v[152:155], v[104:107], 0
v_mfma_f32_32x32x16_bf16 v[8:23], v[156:159], v[100:103], v[8:23]
v_mfma_f32_32x32x16_bf16 v[24:39], v[156:159], v[108:111], v[24:39]
v_mfma_f32_32x32x16_bf16 v[8:23], v[160:163], v[112:115], v[8:23]
v_mfma_f32_32x32x16_bf16 v[24:39], v[160:163], v[96:99], v[24:39]
v_mfma_f32_32x32x16_bf16 v[8:23], v[164:167], v[116:119], v[8:23]
v_mfma_f32_32x32x16_bf16 v[24:39], v[164:167], v[100:103], v[24:39]
v_xor_b32 v2, 160, v250
v_xor_b32 v3, 176, v250
s_nop 8
v_cvt_pk_bf16_f32 v152, v8, v9
v_cvt_pk_bf16_f32 v153, v10, v11
v_cvt_pk_bf16_f32 v154, v12, v13
v_cvt_pk_bf16_f32 v155, v14, v15
v_cvt_pk_bf16_f32 v156, v16, v17
v_cvt_pk_bf16_f32 v157, v18, v19
v_cvt_pk_bf16_f32 v158, v20, v21
v_cvt_pk_bf16_f32 v159, v22, v23
ds_write_b128 v2, v[152:155] offset:12288
ds_write_b128 v3, v[156:159] offset:12288
s_add_u32 s60, s59, 3679744
buffer_load_dwordx4 v[244:247], v6, s[12:15], s60 offen
v_cvt_pk_bf16_f32 v160, v24, v25
v_cvt_pk_bf16_f32 v161, v26, v27
v_cvt_pk_bf16_f32 v162, v28, v29
v_cvt_pk_bf16_f32 v163, v30, v31
v_cvt_pk_bf16_f32 v164, v32, v33
v_cvt_pk_bf16_f32 v165, v34, v35
v_cvt_pk_bf16_f32 v166, v36, v37
v_cvt_pk_bf16_f32 v167, v38, v39
ds_write_b128 v2, v[160:163] offset:14336
ds_write_b128 v3, v[164:167] offset:14336
s_waitcnt lgkmcnt(0)
s_barrier
v_add_u32 v2, 131072, v6
ds_read_b128 v[152:155], v2 offset:0
ds_read_b128 v[156:159], v2 offset:1024
ds_read_b128 v[160:163], v2 offset:2048
ds_read_b128 v[164:167], v2 offset:3072
s_lshl_b32 s53, s43, 1
s_add_u32 s53, s53, 0
s_lshl_b32 s54, s53, 3
s_and_b32 s55, s53, 3
s_xor_b32 s54, s54, s55
s_lshl_b32 s54, s54, 4
v_xor_b32 v252, s54, v251
v_xor_b32 v253, 32, v252
v_add_u32 v254, 0x10000, v252
v_add_u32 v255, 0x10000, v253
ds_read_b64_tr_b16 v[8:9], v252 offset:0
ds_read_b64_tr_b16 v[10:11], v252 offset:16384
s_add_u32 s60, s61, 1835008
buffer_load_dwordx4 v[244:247], v6, s[20:23], s60 offen
ds_read_b64_tr_b16 v[12:13], v254 offset:0
ds_read_b64_tr_b16 v[14:15], v254 offset:16384
ds_read_b64_tr_b16 v[16:17], v252 offset:2048
ds_read_b64_tr_b16 v[18:19], v252 offset:18432
ds_read_b64_tr_b16 v[20:21], v254 offset:2048
ds_read_b64_tr_b16 v[22:23], v254 offset:18432
ds_read_b64_tr_b16 v[24:25], v253 offset:0
ds_read_b64_tr_b16 v[26:27], v253 offset:16384
ds_read_b64_tr_b16 v[28:29], v255 offset:0
ds_read_b64_tr_b16 v[30:31], v255 offset:16384
ds_read_b64_tr_b16 v[32:33], v253 offset:2048
ds_read_b64_tr_b16 v[34:35], v253 offset:18432
ds_read_b64_tr_b16 v[36:37], v255 offset:2048
ds_read_b64_tr_b16 v[38:39], v255 offset:18432
v_and_b32 v3, 31, v0
v_lshrrev_b32 v4, 5, v0
v_lshlrev_b32 v3, 2, v3
v_lshl_add_u32 v3, v4, 14, v3
s_lshl_b32 s53, s43, 8
v_add_u32 v2, s53, v3
v_add_u32 v3, 0x10000, v2
v_lshrrev_b32 v4, 3, v0
v_and_b32 v5, 7, v0
v_lshlrev_b32 v5, 4, v5
v_lshl_add_u32 v1, v4, 18, v5
v_lshl_add_u32 v5, v4, 12, v5
v_bfe_u32 v4, v0, 4, 1
v_lshl_add_u32 v5, v4, 7, v5
v_add_u32 v4, s53, v5
v_add_u32 v5, 0x10000, v4
s_waitcnt lgkmcnt(0)
v_xor_b32 v168, 0x80008000, v152
v_xor_b32 v169, 0x80008000, v153
v_xor_b32 v170, 0x80008000, v154
s_add_u32 s60, s61, 2097152
buffer_load_dwordx4 v[244:247], v6, s[20:23], s60 offen
v_xor_b32 v171, 0x80008000, v155
v_xor_b32 v172, 0x80008000, v156
v_xor_b32 v173, 0x80008000, v157
v_xor_b32 v174, 0x80008000, v158
v_xor_b32 v175, 0x80008000, v159
v_mfma_f32_32x32x16_bf16 v[176:191], v[152:155], v[8:11], 0
v_mfma_f32_32x32x16_bf16 v[208:223], v[152:155], v[24:27], 0
v_mfma_f32_32x32x16_bf16 v[176:191], v[156:159], v[12:15], v[176:191]
v_mfma_f32_32x32x16_bf16 v[208:223], v[156:159], v[28:31], v[208:223]
v_mfma_f32_32x32x16_bf16 v[176:191], v[160:163], v[16:19], v[176:191]
v_mfma_f32_32x32x16_bf16 v[208:223], v[160:163], v[32:35], v[208:223]
v_mfma_f32_32x32x16_bf16 v[176:191], v[164:167], v[20:23], v[176:191]
v_mfma_f32_32x32x16_bf16 v[208:223], v[164:167], v[36:39], v[208:223]
s_nop 7
s_nop 3
v_mfma_f32_32x32x16_bf16 v[192:207], v[168:171], v[16:19], 0
v_cvt_pk_bf16_f32 v240, v176, v208
ds_write_b32 v2, v240 offset:0
v_cvt_pk_bf16_f32 v241, v177, v209
ds_write_b32 v2, v241 offset:4096
v_mfma_f32_32x32x16_bf16 v[224:239], v[168:171], v[32:35], 0
v_cvt_pk_bf16_f32 v242, v178, v210
ds_write_b32 v2, v242 offset:8320
v_cvt_pk_bf16_f32 v243, v179, v211
ds_write_b32 v2, v243 offset:12416
v_mfma_f32_32x32x16_bf16 v[192:207], v[172:175], v[20:23], v[192:207]
v_cvt_pk_bf16_f32 v240, v180, v212
ds_write_b32 v2, v240 offset:32768
v_cvt_pk_bf16_f32 v241, v181, v213
ds_write_b32 v2, v241 offset:36864
v_mfma_f32_32x32x16_bf16 v[224:239], v[172:175], v[36:39], v[224:239]
v_cvt_pk_bf16_f32 v242, v182, v214
ds_write_b32 v2, v242 offset:41088
s_add_u32 s60, s61, 2359296
buffer_load_dwordx4 v[244:247], v6, s[20:23], s60 offen
v_cvt_pk_bf16_f32 v243, v183, v215
ds_write_b32 v2, v243 offset:45184
v_mfma_f32_32x32x16_bf16 v[192:207], v[160:163], v[8:11], v[192:207]
v_cvt_pk_bf16_f32 v240, v184, v216
ds_write_b32 v3, v240 offset:0
v_cvt_pk_bf16_f32 v241, v185, v217
ds_write_b32 v3, v241 offset:4096
v_mfma_f32_32x32x16_bf16 v[224:239], v[160:163], v[24:27], v[224:239]
v_cvt_pk_bf16_f32 v242, v186, v218
ds_write_b32 v3, v242 offset:8320
v_cvt_pk_bf16_f32 v243, v187, v219
ds_write_b32 v3, v243 offset:12416
v_mfma_f32_32x32x16_bf16 v[192:207], v[164:167], v[12:15], v[192:207]
v_cvt_pk_bf16_f32 v240, v188, v220
ds_write_b32 v3, v240 offset:32768
v_cvt_pk_bf16_f32 v241, v189, v221
ds_write_b32 v3, v241 offset:36864
v_mfma_f32_32x32x16_bf16 v[224:239], v[164:167], v[28:31], v[224:239]
v_cvt_pk_bf16_f32 v242, v190, v222
ds_write_b32 v3, v242 offset:41088
v_cvt_pk_bf16_f32 v243, v191, v223
ds_write_b32 v3, v243 offset:45184
s_lshl_b32 s53, s43, 1
s_add_u32 s53, s53, 1
s_lshl_b32 s54, s53, 3
s_and_b32 s55, s53, 3
s_xor_b32 s54, s54, s55
s_lshl_b32 s54, s54, 4
v_xor_b32 v252, s54, v251
v_xor_b32 v253, 32, v252
v_add_u32 v254, 0x10000, v252
v_add_u32 v255, 0x10000, v253
ds_read_b64_tr_b16 v[8:9], v252 offset:0
s_add_u32 s60, s61, 2621440
buffer_load_dwordx4 v[244:247], v6, s[20:23], s60 offen
ds_read_b64_tr_b16 v[10:11], v252 offset:16384
ds_read_b64_tr_b16 v[12:13], v254 offset:0
ds_read_b64_tr_b16 v[14:15], v254 offset:16384
ds_read_b64_tr_b16 v[16:17], v252 offset:2048
ds_read_b64_tr_b16 v[18:19], v252 offset:18432
ds_read_b64_tr_b16 v[20:21], v254 offset:2048
ds_read_b64_tr_b16 v[22:23], v254 offset:18432
ds_read_b64_tr_b16 v[24:25], v253 offset:0
ds_read_b64_tr_b16 v[26:27], v253 offset:16384
ds_read_b64_tr_b16 v[28:29], v255 offset:0
ds_read_b64_tr_b16 v[30:31], v255 offset:16384
ds_read_b64_tr_b16 v[32:33], v253 offset:2048
ds_read_b64_tr_b16 v[34:35], v253 offset:18432
ds_read_b64_tr_b16 v[36:37], v255 offset:2048
ds_read_b64_tr_b16 v[38:39], v255 offset:18432
s_lshl_b32 s53, s43, 8
s_lshl_b32 s54, s58, 11
s_add_u32 s53, s53, s54
s_add_u32 s53, s53, 17825792
s_waitcnt lgkmcnt(0)
ds_read_b128 v[176:179], v4 offset:0
ds_read_b128 v[180:183], v4 offset:32768
ds_read_b128 v[184:187], v5 offset:0
ds_read_b128 v[188:191], v5 offset:32768
s_waitcnt lgkmcnt(3)
buffer_store_dwordx4 v[176:179], v1, s[16:19], s53 offen sc1
s_add_u32 s53, s53, 2097152
s_waitcnt lgkmcnt(2)
buffer_store_dwordx4 v[180:183], v1, s[16:19], s53 offen sc1
s_add_u32 s53, s53, 2097152
s_waitcnt lgkmcnt(1)
buffer_store_dwordx4 v[184:187], v1, s[16:19], s53 offen sc1
s_add_u32 s53, s53, 2097152
s_waitcnt lgkmcnt(0)
s_add_u32 s60, s61, 2883584
buffer_load_dwordx4 v[244:247], v6, s[20:23], s60 offen
buffer_store_dwordx4 v[188:191], v1, s[16:19], s53 offen sc1
s_add_u32 s53, s53, 2097152
s_nop 0
v_mfma_f32_32x32x16_bf16 v[176:191], v[152:155], v[8:11], 0
v_cvt_pk_bf16_f32 v240, v192, v224
ds_write_b32 v2, v240 offset:2048
v_cvt_pk_bf16_f32 v241, v193, v225
ds_write_b32 v2, v241 offset:6144
v_mfma_f32_32x32x16_bf16 v[208:223], v[152:155], v[24:27], 0
v_cvt_pk_bf16_f32 v242, v194, v226
ds_write_b32 v2, v242 offset:10368
v_cvt_pk_bf16_f32 v243, v195, v227
ds_write_b32 v2, v243 offset:14464
v_mfma_f32_32x32x16_bf16 v[176:191], v[156:159], v[12:15], v[176:191]
v_cvt_pk_bf16_f32 v240, v196, v228
ds_write_b32 v2, v240 offset:34816
v_cvt_pk_bf16_f32 v241, v197, v229
ds_write_b32 v2, v241 offset:38912
v_mfma_f32_32x32x16_bf16 v[208:223], v[156:159], v[28:31], v[208:223]
v_cvt_pk_bf16_f32 v242, v198, v230
ds_write_b32 v2, v242 offset:43136
v_cvt_pk_bf16_f32 v243, v199, v231
ds_write_b32 v2, v243 offset:47232
v_mfma_f32_32x32x16_bf16 v[176:191], v[160:163], v[16:19], v[176:191]
v_cvt_pk_bf16_f32 v240, v200, v232
ds_write_b32 v3, v240 offset:2048
v_cvt_pk_bf16_f32 v241, v201, v233
ds_write_b32 v3, v241 offset:6144
v_mfma_f32_32x32x16_bf16 v[208:223], v[160:163], v[32:35], v[208:223]
v_cvt_pk_bf16_f32 v242, v202, v234
ds_write_b32 v3, v242 offset:10368
v_cvt_pk_bf16_f32 v243, v203, v235
ds_write_b32 v3, v243 offset:14464
s_add_u32 s60, s61, 3145728
buffer_load_dwordx4 v[244:247], v6, s[20:23], s60 offen
v_mfma_f32_32x32x16_bf16 v[176:191], v[164:167], v[20:23], v[176:191]
v_cvt_pk_bf16_f32 v240, v204, v236
ds_write_b32 v3, v240 offset:34816
v_cvt_pk_bf16_f32 v241, v205, v237
ds_write_b32 v3, v241 offset:38912
v_mfma_f32_32x32x16_bf16 v[208:223], v[164:167], v[36:39], v[208:223]
v_cvt_pk_bf16_f32 v242, v206, v238
ds_write_b32 v3, v242 offset:43136
v_cvt_pk_bf16_f32 v243, v207, v239
ds_write_b32 v3, v243 offset:47232
s_lshl_b32 s53, s43, 8
s_lshl_b32 s54, s58, 11
s_add_u32 s53, s53, s54
s_add_u32 s53, s53, 17956864
s_waitcnt lgkmcnt(0)
ds_read_b128 v[192:195], v4 offset:2048
ds_read_b128 v[196:199], v4 offset:34816
ds_read_b128 v[200:203], v5 offset:2048
ds_read_b128 v[204:207], v5 offset:34816
s_waitcnt lgkmcnt(3)
buffer_store_dwordx4 v[192:195], v1, s[16:19], s53 offen sc1
s_add_u32 s53, s53, 2097152
s_waitcnt lgkmcnt(2)
buffer_store_dwordx4 v[196:199], v1, s[16:19], s53 offen sc1
s_add_u32 s53, s53, 2097152
s_waitcnt lgkmcnt(1)
buffer_store_dwordx4 v[200:203], v1, s[16:19], s53 offen sc1
s_add_u32 s53, s53, 2097152
s_waitcnt lgkmcnt(0)
buffer_store_dwordx4 v[204:207], v1, s[16:19], s53 offen sc1
s_add_u32 s53, s53, 2097152
s_nop 0
v_xor_b32 v4, 128, v4
v_xor_b32 v5, 128, v5
s_add_u32 s60, s61, 3407872
buffer_load_dwordx4 v[244:247], v6, s[20:23], s60 offen
v_mfma_f32_32x32x16_bf16 v[192:207], v[168:171], v[16:19], 0
v_cvt_pk_bf16_f32 v240, v176, v208
ds_write_b32 v2, v240 offset:128
v_cvt_pk_bf16_f32 v241, v177, v209
ds_write_b32 v2, v241 offset:4224
v_mfma_f32_32x32x16_bf16 v[224:239], v[168:171], v[32:35], 0
v_cvt_pk_bf16_f32 v242, v178, v210
ds_write_b32 v2, v242 offset:8192
v_cvt_pk_bf16_f32 v243, v179, v211
ds_write_b32 v2, v243 offset:12288
v_mfma_f32_32x32x16_bf16 v[192:207], v[172:175], v[20:23], v[192:207]
v_cvt_pk_bf16_f32 v240, v180, v212
ds_write_b32 v2, v240 offset:32896
v_cvt_pk_bf16_f32 v241, v181, v213
ds_write_b32 v2, v241 offset:36992
v_mfma_f32_32x32x16_bf16 v[224:239], v[172:175], v[36:39], v[224:239]
v_cvt_pk_bf16_f32 v242, v182, v214
ds_write_b32 v2, v242 offset:40960
v_cvt_pk_bf16_f32 v243, v183, v215
ds_write_b32 v2, v243 offset:45056
v_mfma_f32_32x32x16_bf16 v[192:207], v[160:163], v[8:11], v[192:207]
v_cvt_pk_bf16_f32 v240, v184, v216
ds_write_b32 v3, v240 offset:128
v_cvt_pk_bf16_f32 v241, v185, v217
ds_write_b32 v3, v241 offset:4224
v_mfma_f32_32x32x16_bf16 v[224:239], v[160:163], v[24:27], v[224:239]
v_cvt_pk_bf16_f32 v242, v186, v218
ds_write_b32 v3, v242 offset:8192
v_cvt_pk_bf16_f32 v243, v187, v219
ds_write_b32 v3, v243 offset:12288
v_mfma_f32_32x32x16_bf16 v[192:207], v[164:167], v[12:15], v[192:207]
v_cvt_pk_bf16_f32 v240, v188, v220
ds_write_b32 v3, v240 offset:32896
s_add_u32 s60, s61, 3670016
buffer_load_dwordx4 v[244:247], v6, s[20:23], s60 offen
v_cvt_pk_bf16_f32 v241, v189, v221
ds_write_b32 v3, v241 offset:36992
v_mfma_f32_32x32x16_bf16 v[224:239], v[164:167], v[28:31], v[224:239]
v_cvt_pk_bf16_f32 v242, v190, v222
ds_write_b32 v3, v242 offset:40960
v_cvt_pk_bf16_f32 v243, v191, v223
ds_write_b32 v3, v243 offset:45056
s_lshl_b32 s53, s43, 8
s_lshl_b32 s54, s58, 11
s_add_u32 s53, s53, s54
s_add_u32 s53, s53, 17825920
s_waitcnt lgkmcnt(0)
ds_read_b128 v[176:179], v4 offset:0
ds_read_b128 v[180:183], v4 offset:32768
ds_read_b128 v[184:187], v5 offset:0
ds_read_b128 v[188:191], v5 offset:32768
s_waitcnt lgkmcnt(3)
buffer_store_dwordx4 v[176:179], v1, s[16:19], s53 offen sc1
s_add_u32 s53, s53, 2097152
s_waitcnt lgkmcnt(2)
buffer_store_dwordx4 v[180:183], v1, s[16:19], s53 offen sc1
s_add_u32 s53, s53, 2097152
s_waitcnt lgkmcnt(1)
buffer_store_dwordx4 v[184:187], v1, s[16:19], s53 offen sc1
s_add_u32 s53, s53, 2097152
s_waitcnt lgkmcnt(0)
buffer_store_dwordx4 v[188:191], v1, s[16:19], s53 offen sc1
s_add_u32 s53, s53, 2097152
s_nop 0
v_cvt_pk_bf16_f32 v240, v192, v224
ds_write_b32 v2, v240 offset:2176
v_cvt_pk_bf16_f32 v241, v193, v225
ds_write_b32 v2, v241 offset:6272
s_add_u32 s60, s61, 3932160
buffer_load_dwordx4 v[244:247], v6, s[20:23], s60 offen
v_cvt_pk_bf16_f32 v242, v194, v226
ds_write_b32 v2, v242 offset:10240
v_cvt_pk_bf16_f32 v243, v195, v227
ds_write_b32 v2, v243 offset:14336
v_cvt_pk_bf16_f32 v240, v196, v228
ds_write_b32 v2, v240 offset:34944
v_cvt_pk_bf16_f32 v241, v197, v229
ds_write_b32 v2, v241 offset:39040
v_cvt_pk_bf16_f32 v242, v198, v230
ds_write_b32 v2, v242 offset:43008
v_cvt_pk_bf16_f32 v243, v199, v231
ds_write_b32 v2, v243 offset:47104
v_cvt_pk_bf16_f32 v240, v200, v232
ds_write_b32 v3, v240 offset:2176
v_cvt_pk_bf16_f32 v241, v201, v233
ds_write_b32 v3, v241 offset:6272
v_cvt_pk_bf16_f32 v242, v202, v234
ds_write_b32 v3, v242 offset:10240
v_cvt_pk_bf16_f32 v243, v203, v235
ds_write_b32 v3, v243 offset:14336
v_cvt_pk_bf16_f32 v240, v204, v236
ds_write_b32 v3, v240 offset:34944
v_cvt_pk_bf16_f32 v241, v205, v237
ds_write_b32 v3, v241 offset:39040
v_cvt_pk_bf16_f32 v242, v206, v238
ds_write_b32 v3, v242 offset:43008
v_cvt_pk_bf16_f32 v243, v207, v239
ds_write_b32 v3, v243 offset:47104
s_lshl_b32 s53, s43, 8
s_lshl_b32 s54, s58, 11
s_add_u32 s53, s53, s54
s_add_u32 s53, s53, 17956992
s_waitcnt lgkmcnt(0)
ds_read_b128 v[192:195], v4 offset:2048
s_add_u32 s60, s61, 4194304
buffer_load_dwordx4 v[244:247], v6, s[20:23], s60 offen
ds_read_b128 v[196:199], v4 offset:34816
ds_read_b128 v[200:203], v5 offset:2048
ds_read_b128 v[204:207], v5 offset:34816
s_waitcnt lgkmcnt(3)
buffer_store_dwordx4 v[192:195], v1, s[16:19], s53 offen sc1
s_add_u32 s53, s53, 2097152
s_waitcnt lgkmcnt(2)
buffer_store_dwordx4 v[196:199], v1, s[16:19], s53 offen sc1
s_add_u32 s53, s53, 2097152
s_waitcnt lgkmcnt(1)
buffer_store_dwordx4 v[200:203], v1, s[16:19], s53 offen sc1
s_add_u32 s53, s53, 2097152
s_waitcnt lgkmcnt(0)
buffer_store_dwordx4 v[204:207], v1, s[16:19], s53 offen sc1
s_add_u32 s53, s53, 2097152
s_nop 0
s_add_u32 s58, s58, 1
s_waitcnt vmcnt(26)
s_barrier

ds_write_b128 v248, v[40:43] offset:0
ds_write_b128 v248, v[44:47] offset:1024
ds_write_b128 v248, v[48:51] offset:4096
ds_write_b128 v248, v[52:55] offset:5120
ds_write_b128 v248, v[56:59] offset:8192
ds_write_b128 v248, v[60:63] offset:9216
ds_write_b128 v248, v[64:67] offset:12288
ds_write_b128 v248, v[68:71] offset:13312
v_and_b32 v3, 31, v0
v_cvt_f32_u32 v3, v3
v_lshrrev_b32 v4, 5, v0
s_lshr_b32 s53, s43, 2
s_lshl_b32 s53, s53, 3
s_lshl_b32 s54, s43, 1
s_add_u32 s60, s61, 4456448
buffer_load_dwordx4 v[244:247], v6, s[20:23], s60 offen
s_add_u32 s53, s53, s54
v_lshl_add_u32 v4, v4, 3, s53
v_lshl_add_u32 v4, v4, 6, s58
v_cvt_f32_u32 v4, v4
v_mul_f32 v3, 0x3a000000, v3
v_mul_f32 v4, v4, v3
v_fmamk_f32 v5, v3, 0x42800000, v4
v_fract_f32 v4, v4
v_fract_f32 v5, v5
v_cos_f32 v2, v4
v_cos_f32 v3, v5
v_sin_f32 v4, v4
v_sin_f32 v5, v5
s_lshr_b32 s53, s43, 2
s_lshl_b32 s53, s53, 10
s_and_b32 s54, s43, 3
s_lshl_b32 s54, s54, 2
s_add_u32 s53, s53, s54
s_add_u32 s53, s53, 131072
v_cvt_pk_bf16_f32 v2, v2, v3
v_cvt_pk_bf16_f32 v4, v4, v5
v_add_u32 v3, s53, v6
ds_write_b32 v3, v2
ds_write_b32 v3, v4 offset:2048
v_mov_b32 v232, 0
v_mov_b32 v233, 0
v_mov_b32 v234, 0
v_mov_b32 v235, 0
s_add_u32 s60, s61, 4718592
buffer_load_dwordx4 v[244:247], v6, s[20:23], s60 offen
v_dot2_f32_bf16 v232, v40, v72, v232
v_dot2_f32_bf16 v233, v48, v72, v233
v_dot2_f32_bf16 v234, v56, v72, v234
v_dot2_f32_bf16 v235, v64, v72, v235
v_dot2_f32_bf16 v232, v41, v73, v232
v_dot2_f32_bf16 v233, v49, v73, v233
v_dot2_f32_bf16 v234, v57, v73, v234
v_dot2_f32_bf16 v235, v65, v73, v235
v_dot2_f32_bf16 v232, v42, v74, v232
v_dot2_f32_bf16 v233, v50, v74, v233
v_dot2_f32_bf16 v234, v58, v74, v234
v_dot2_f32_bf16 v235, v66, v74, v235
v_dot2_f32_bf16 v232, v43, v75, v232
v_dot2_f32_bf16 v233, v51, v75, v233
v_dot2_f32_bf16 v234, v59, v75, v234
v_dot2_f32_bf16 v235, v67, v75, v235
v_dot2_f32_bf16 v232, v44, v76, v232
v_dot2_f32_bf16 v233, v52, v76, v233
v_dot2_f32_bf16 v234, v60, v76, v234
v_dot2_f32_bf16 v235, v68, v76, v235
v_dot2_f32_bf16 v232, v45, v77, v232
v_dot2_f32_bf16 v233, v53, v77, v233
v_dot2_f32_bf16 v234, v61, v77, v234
v_dot2_f32_bf16 v235, v69, v77, v235
v_dot2_f32_bf16 v232, v46, v78, v232
v_dot2_f32_bf16 v233, v54, v78, v233
v_dot2_f32_bf16 v234, v62, v78, v234
v_dot2_f32_bf16 v235, v70, v78, v235
s_add_u32 s60, s61, 4980736
buffer_load_dwordx4 v[244:247], v6, s[20:23], s60 offen
v_dot2_f32_bf16 v232, v47, v79, v232
v_dot2_f32_bf16 v233, v55, v79, v233
v_dot2_f32_bf16 v234, v63, v79, v234
v_dot2_f32_bf16 v235, v71, v79, v235
v_add_f32_dpp v232, v232, v232 quad_perm:[1,0,3,2] row_mask:0xf bank_mask:0xf
v_add_f32_dpp v233, v233, v233 quad_perm:[1,0,3,2] row_mask:0xf bank_mask:0xf
v_add_f32_dpp v234, v234, v234 quad_perm:[1,0,3,2] row_mask:0xf bank_mask:0xf
v_add_f32_dpp v235, v235, v235 quad_perm:[1,0,3,2] row_mask:0xf bank_mask:0xf
v_add_f32_dpp v232, v232, v232 quad_perm:[2,3,0,1] row_mask:0xf bank_mask:0xf
v_add_f32_dpp v233, v233, v233 quad_perm:[2,3,0,1] row_mask:0xf bank_mask:0xf
v_add_f32_dpp v234, v234, v234 quad_perm:[2,3,0,1] row_mask:0xf bank_mask:0xf
v_add_f32_dpp v235, v235, v235 quad_perm:[2,3,0,1] row_mask:0xf bank_mask:0xf
v_add_f32_dpp v232, v232, v232 row_half_mirror row_mask:0xf bank_mask:0xf
v_add_f32_dpp v233, v233, v233 row_half_mirror row_mask:0xf bank_mask:0xf
v_add_f32_dpp v234, v234, v234 row_half_mirror row_mask:0xf bank_mask:0xf
v_add_f32_dpp v235, v235, v235 row_half_mirror row_mask:0xf bank_mask:0xf
v_add_f32_dpp v232, v232, v232 row_mirror row_mask:0xf bank_mask:0xf
v_add_f32_dpp v233, v233, v233 row_mirror row_mask:0xf bank_mask:0xf
v_add_f32_dpp v234, v234, v234 row_mirror row_mask:0xf bank_mask:0xf
v_add_f32_dpp v235, v235, v235 row_mirror row_mask:0xf bank_mask:0xf
v_add_f32_dpp v232, v232, v232 row_bcast:15 row_mask:0xa bank_mask:0xf
v_add_f32_dpp v233, v233, v233 row_bcast:15 row_mask:0xa bank_mask:0xf
v_add_f32_dpp v234, v234, v234 row_bcast:15 row_mask:0xa bank_mask:0xf
v_add_f32_dpp v235, v235, v235 row_bcast:15 row_mask:0xa bank_mask:0xf
v_add_f32_dpp v232, v232, v232 row_bcast:31 row_mask:0xc bank_mask:0xf
v_add_f32_dpp v233, v233, v233 row_bcast:31 row_mask:0xc bank_mask:0xf
v_add_f32_dpp v234, v234, v234 row_bcast:31 row_mask:0xc bank_mask:0xf
s_add_u32 s60, s61, 5242880
buffer_load_dwordx4 v[244:247], v6, s[20:23], s60 offen
v_add_f32_dpp v235, v235, v235 row_bcast:31 row_mask:0xc bank_mask:0xf
s_waitcnt lgkmcnt(0)
ds_read_b64_tr_b16 v[176:177], v249 offset:0
ds_read_b64_tr_b16 v[178:179], v249 offset:256
ds_read_b64_tr_b16 v[180:181], v249 offset:1024
ds_read_b64_tr_b16 v[182:183], v249 offset:1280
v_mul_f32 v232, 0xbfb8aa3b, v232
v_mul_f32 v233, 0xbfb8aa3b, v233
v_mul_f32 v234, 0xbfb8aa3b, v234
v_mul_f32 v235, 0xbfb8aa3b, v235
v_exp_f32 v232, v232
v_exp_f32 v233, v233
v_exp_f32 v234, v234
v_exp_f32 v235, v235
v_add_f32 v232, 1.0, v232
v_add_f32 v233, 1.0, v233
v_add_f32 v234, 1.0, v234
v_add_f32 v235, 1.0, v235
v_rcp_f32 v232, v232
v_rcp_f32 v233, v233
v_rcp_f32 v234, v234
v_rcp_f32 v235, v235
s_lshl_b32 s53, s43, 10
s_lshl_b32 s54, s58, 2
s_add_u32 s53, s53, s54
s_add_u32 s53, s53, 26214400
s_mov_b32 exec_lo, 0
s_mov_b32 exec_hi, 0x80000000
buffer_store_dword v232, off, s[16:19], s53 offset:0 sc1
buffer_store_dword v233, off, s[16:19], s53 offset:256 sc1
buffer_store_dword v234, off, s[16:19], s53 offset:512 sc1
buffer_store_dword v235, off, s[16:19], s53 offset:768 sc1
s_mov_b64 exec, -1
s_waitcnt lgkmcnt(0)
s_add_u32 s60, s61, 5505024
buffer_load_dwordx4 v[244:247], v6, s[20:23], s60 offen
v_mfma_f32_32x32x16_bf16 v[184:199], v[176:179], v[80:83], 0
v_mfma_f32_32x32x16_bf16 v[200:215], v[176:179], v[88:91], 0
v_mfma_f32_32x32x16_bf16 v[184:199], v[180:183], v[84:87], v[184:199]
v_mfma_f32_32x32x16_bf16 v[200:215], v[180:183], v[92:95], v[200:215]
ds_read_b64_tr_b16 v[176:177], v249 offset:4096
ds_read_b64_tr_b16 v[178:179], v249 offset:4352
ds_read_b64_tr_b16 v[180:181], v249 offset:5120
ds_read_b64_tr_b16 v[182:183], v249 offset:5376
s_nop 6
v_pk_mul_f32 v[232:233], v[184:185], v[120:121]
v_pk_mul_f32 v[234:235], v[200:201], v[120:121]
v_pk_fma_f32 v[232:233], v[200:201], v[136:137], v[232:233]
v_pk_fma_f32 v[234:235], v[184:185], v[136:137], v[234:235] neg_lo:[1,0,0] neg_hi:[1,0,0]
v_cvt_pk_bf16_f32 v216, v232, v233
v_cvt_pk_bf16_f32 v224, v234, v235
v_pk_mul_f32 v[236:237], v[186:187], v[122:123]
v_pk_mul_f32 v[238:239], v[202:203], v[122:123]
v_pk_fma_f32 v[236:237], v[202:203], v[138:139], v[236:237]
v_pk_fma_f32 v[238:239], v[186:187], v[138:139], v[238:239] neg_lo:[1,0,0] neg_hi:[1,0,0]
v_cvt_pk_bf16_f32 v217, v236, v237
v_cvt_pk_bf16_f32 v225, v238, v239
v_pk_mul_f32 v[232:233], v[188:189], v[124:125]
v_pk_mul_f32 v[234:235], v[204:205], v[124:125]
v_pk_fma_f32 v[232:233], v[204:205], v[140:141], v[232:233]
v_pk_fma_f32 v[234:235], v[188:189], v[140:141], v[234:235] neg_lo:[1,0,0] neg_hi:[1,0,0]
v_cvt_pk_bf16_f32 v218, v232, v233
v_cvt_pk_bf16_f32 v226, v234, v235
v_pk_mul_f32 v[236:237], v[190:191], v[126:127]
v_pk_mul_f32 v[238:239], v[206:207], v[126:127]
s_add_u32 s60, s61, 5767168
buffer_load_dwordx4 v[244:247], v6, s[20:23], s60 offen
v_pk_fma_f32 v[236:237], v[206:207], v[142:143], v[236:237]
v_pk_fma_f32 v[238:239], v[190:191], v[142:143], v[238:239] neg_lo:[1,0,0] neg_hi:[1,0,0]
v_cvt_pk_bf16_f32 v219, v236, v237
v_cvt_pk_bf16_f32 v227, v238, v239
v_pk_mul_f32 v[232:233], v[192:193], v[128:129]
v_pk_mul_f32 v[234:235], v[208:209], v[128:129]
v_pk_fma_f32 v[232:233], v[208:209], v[144:145], v[232:233]
v_pk_fma_f32 v[234:235], v[192:193], v[144:145], v[234:235] neg_lo:[1,0,0] neg_hi:[1,0,0]
v_cvt_pk_bf16_f32 v220, v232, v233
v_cvt_pk_bf16_f32 v228, v234, v235
v_pk_mul_f32 v[236:237], v[194:195], v[130:131]
v_pk_mul_f32 v[238:239], v[210:211], v[130:131]
v_pk_fma_f32 v[236:237], v[210:211], v[146:147], v[236:237]
v_pk_fma_f32 v[238:239], v[194:195], v[146:147], v[238:239] neg_lo:[1,0,0] neg_hi:[1,0,0]
v_cvt_pk_bf16_f32 v221, v236, v237
v_cvt_pk_bf16_f32 v229, v238, v239
v_pk_mul_f32 v[232:233], v[196:197], v[132:133]
v_pk_mul_f32 v[234:235], v[212:213], v[132:133]
v_pk_fma_f32 v[232:233], v[212:213], v[148:149], v[232:233]
v_pk_fma_f32 v[234:235], v[196:197], v[148:149], v[234:235] neg_lo:[1,0,0] neg_hi:[1,0,0]
v_cvt_pk_bf16_f32 v222, v232, v233
v_cvt_pk_bf16_f32 v230, v234, v235
v_pk_mul_f32 v[236:237], v[198:199], v[134:135]
v_pk_mul_f32 v[238:239], v[214:215], v[134:135]
v_pk_fma_f32 v[236:237], v[214:215], v[150:151], v[236:237]
v_pk_fma_f32 v[238:239], v[198:199], v[150:151], v[238:239] neg_lo:[1,0,0] neg_hi:[1,0,0]
v_cvt_pk_bf16_f32 v223, v236, v237
s_add_u32 s60, s61, 6029312
buffer_load_dwordx4 v[244:247], v6, s[20:23], s60 offen
v_cvt_pk_bf16_f32 v231, v238, v239
s_waitcnt lgkmcnt(0)
v_mfma_f32_32x32x16_bf16 v[184:199], v[176:179], v[80:83], 0
v_mfma_f32_32x32x16_bf16 v[200:215], v[176:179], v[88:91], 0
v_mfma_f32_32x32x16_bf16 v[184:199], v[180:183], v[84:87], v[184:199]
v_mfma_f32_32x32x16_bf16 v[200:215], v[180:183], v[92:95], v[200:215]
ds_read_b64_tr_b16 v[176:177], v249 offset:8192
ds_read_b64_tr_b16 v[178:179], v249 offset:8448
ds_read_b64_tr_b16 v[180:181], v249 offset:9216
ds_read_b64_tr_b16 v[182:183], v249 offset:9472
v_mfma_f32_32x32x16_bf16 v[8:23], v[216:219], v[96:99], 0
s_nop 5
v_pk_mul_f32 v[232:233], v[184:185], v[120:121]
v_pk_mul_f32 v[234:235], v[200:201], v[120:121]
v_pk_fma_f32 v[232:233], v[200:201], v[136:137], v[232:233]
v_pk_fma_f32 v[234:235], v[184:185], v[136:137], v[234:235] neg_lo:[1,0,0] neg_hi:[1,0,0]
v_cvt_pk_bf16_f32 v152, v232, v233
v_cvt_pk_bf16_f32 v160, v234, v235
v_mfma_f32_32x32x16_bf16 v[24:39], v[216:219], v[104:107], 0
v_pk_mul_f32 v[236:237], v[186:187], v[122:123]
v_pk_mul_f32 v[238:239], v[202:203], v[122:123]
v_pk_fma_f32 v[236:237], v[202:203], v[138:139], v[236:237]
v_pk_fma_f32 v[238:239], v[186:187], v[138:139], v[238:239] neg_lo:[1,0,0] neg_hi:[1,0,0]
v_cvt_pk_bf16_f32 v153, v236, v237
v_cvt_pk_bf16_f32 v161, v238, v239
v_mfma_f32_32x32x16_bf16 v[8:23], v[220:223], v[100:103], v[8:23]
v_pk_mul_f32 v[232:233], v[188:189], v[124:125]
v_pk_mul_f32 v[234:235], v[204:205], v[124:125]
v_pk_fma_f32 v[232:233], v[204:205], v[140:141], v[232:233]
s_add_u32 s60, s61, 6291456
buffer_load_dwordx4 v[244:247], v6, s[20:23], s60 offen
v_pk_fma_f32 v[234:235], v[188:189], v[140:141], v[234:235] neg_lo:[1,0,0] neg_hi:[1,0,0]
v_cvt_pk_bf16_f32 v154, v232, v233
v_cvt_pk_bf16_f32 v162, v234, v235
v_mfma_f32_32x32x16_bf16 v[24:39], v[220:223], v[108:111], v[24:39]
v_pk_mul_f32 v[236:237], v[190:191], v[126:127]
v_pk_mul_f32 v[238:239], v[206:207], v[126:127]
v_pk_fma_f32 v[236:237], v[206:207], v[142:143], v[236:237]
v_pk_fma_f32 v[238:239], v[190:191], v[142:143], v[238:239] neg_lo:[1,0,0] neg_hi:[1,0,0]
v_cvt_pk_bf16_f32 v155, v236, v237
v_cvt_pk_bf16_f32 v163, v238, v239
v_mfma_f32_32x32x16_bf16 v[8:23], v[224:227], v[112:115], v[8:23]
v_pk_mul_f32 v[232:233], v[192:193], v[128:129]
v_pk_mul_f32 v[234:235], v[208:209], v[128:129]
v_pk_fma_f32 v[232:233], v[208:209], v[144:145], v[232:233]
v_pk_fma_f32 v[234:235], v[192:193], v[144:145], v[234:235] neg_lo:[1,0,0] neg_hi:[1,0,0]
v_cvt_pk_bf16_f32 v156, v232, v233
v_cvt_pk_bf16_f32 v164, v234, v235
v_mfma_f32_32x32x16_bf16 v[24:39], v[224:227], v[96:99], v[24:39]
v_pk_mul_f32 v[236:237], v[194:195], v[130:131]
v_pk_mul_f32 v[238:239], v[210:211], v[130:131]
v_pk_fma_f32 v[236:237], v[210:211], v[146:147], v[236:237]
v_pk_fma_f32 v[238:239], v[194:195], v[146:147], v[238:239] neg_lo:[1,0,0] neg_hi:[1,0,0]
v_cvt_pk_bf16_f32 v157, v236, v237
v_cvt_pk_bf16_f32 v165, v238, v239
v_mfma_f32_32x32x16_bf16 v[8:23], v[228:231], v[116:119], v[8:23]
v_pk_mul_f32 v[232:233], v[196:197], v[132:133]
v_pk_mul_f32 v[234:235], v[212:213], v[132:133]
s_add_u32 s60, s61, 6553600
buffer_load_dwordx4 v[244:247], v6, s[20:23], s60 offen
v_pk_fma_f32 v[232:233], v[212:213], v[148:149], v[232:233]
v_pk_fma_f32 v[234:235], v[196:197], v[148:149], v[234:235] neg_lo:[1,0,0] neg_hi:[1,0,0]
v_cvt_pk_bf16_f32 v158, v232, v233
v_cvt_pk_bf16_f32 v166, v234, v235
v_mfma_f32_32x32x16_bf16 v[24:39], v[228:231], v[100:103], v[24:39]
v_pk_mul_f32 v[236:237], v[198:199], v[134:135]
v_pk_mul_f32 v[238:239], v[214:215], v[134:135]
v_pk_fma_f32 v[236:237], v[214:215], v[150:151], v[236:237]
v_pk_fma_f32 v[238:239], v[198:199], v[150:151], v[238:239] neg_lo:[1,0,0] neg_hi:[1,0,0]
v_cvt_pk_bf16_f32 v159, v236, v237
v_cvt_pk_bf16_f32 v167, v238, v239
s_waitcnt lgkmcnt(0)
v_mfma_f32_32x32x16_bf16 v[184:199], v[176:179], v[80:83], 0
v_mfma_f32_32x32x16_bf16 v[200:215], v[176:179], v[88:91], 0
v_mfma_f32_32x32x16_bf16 v[184:199], v[180:183], v[84:87], v[184:199]
v_mfma_f32_32x32x16_bf16 v[200:215], v[180:183], v[92:95], v[200:215]
ds_read_b64_tr_b16 v[176:177], v249 offset:12288
ds_read_b64_tr_b16 v[178:179], v249 offset:12544
ds_read_b64_tr_b16 v[180:181], v249 offset:13312
ds_read_b64_tr_b16 v[182:183], v249 offset:13568
s_nop 3
v_xor_b32 v2, 0, v250
v_xor_b32 v3, 16, v250
v_cvt_pk_bf16_f32 v216, v8, v9
v_cvt_pk_bf16_f32 v217, v10, v11
v_cvt_pk_bf16_f32 v218, v12, v13
v_cvt_pk_bf16_f32 v219, v14, v15
v_cvt_pk_bf16_f32 v220, v16, v17
s_add_u32 s60, s61, 6815744
buffer_load_dwordx4 v[244:247], v6, s[20:23], s60 offen
v_cvt_pk_bf16_f32 v221, v18, v19
v_cvt_pk_bf16_f32 v222, v20, v21
v_cvt_pk_bf16_f32 v223, v22, v23
ds_write_b128 v2, v[216:219] offset:0
ds_write_b128 v3, v[220:223] offset:0
v_cvt_pk_bf16_f32 v224, v24, v25
v_cvt_pk_bf16_f32 v225, v26, v27
v_cvt_pk_bf16_f32 v226, v28, v29
v_cvt_pk_bf16_f32 v227, v30, v31
v_cvt_pk_bf16_f32 v228, v32, v33
v_cvt_pk_bf16_f32 v229, v34, v35
v_cvt_pk_bf16_f32 v230, v36, v37
v_cvt_pk_bf16_f32 v231, v38, v39
ds_write_b128 v2, v[224:227] offset:2048
ds_write_b128 v3, v[228:231] offset:2048
v_mfma_f32_32x32x16_bf16 v[8:23], v[152:155], v[96:99], 0
v_pk_mul_f32 v[232:233], v[184:185], v[120:121]
v_pk_mul_f32 v[234:235], v[200:201], v[120:121]
v_pk_fma_f32 v[232:233], v[200:201], v[136:137], v[232:233]
v_pk_fma_f32 v[234:235], v[184:185], v[136:137], v[234:235] neg_lo:[1,0,0] neg_hi:[1,0,0]
v_cvt_pk_bf16_f32 v216, v232, v233
v_cvt_pk_bf16_f32 v224, v234, v235
v_mfma_f32_32x32x16_bf16 v[24:39], v[152:155], v[104:107], 0
v_pk_mul_f32 v[236:237], v[186:187], v[122:123]
v_pk_mul_f32 v[238:239], v[202:203], v[122:123]
v_pk_fma_f32 v[236:237], v[202:203], v[138:139], v[236:237]
v_pk_fma_f32 v[238:239], v[186:187], v[138:139], v[238:239] neg_lo:[1,0,0] neg_hi:[1,0,0]
v_cvt_pk_bf16_f32 v217, v236, v237
s_add_u32 s60, s61, 7077888
buffer_load_dwordx4 v[244:247], v6, s[20:23], s60 offen
v_cvt_pk_bf16_f32 v225, v238, v239
v_mfma_f32_32x32x16_bf16 v[8:23], v[156:159], v[100:103], v[8:23]
v_pk_mul_f32 v[232:233], v[188:189], v[124:125]
v_pk_mul_f32 v[234:235], v[204:205], v[124:125]
v_pk_fma_f32 v[232:233], v[204:205], v[140:141], v[232:233]
v_pk_fma_f32 v[234:235], v[188:189], v[140:141], v[234:235] neg_lo:[1,0,0] neg_hi:[1,0,0]
v_cvt_pk_bf16_f32 v218, v232, v233
v_cvt_pk_bf16_f32 v226, v234, v235
v_mfma_f32_32x32x16_bf16 v[24:39], v[156:159], v[108:111], v[24:39]
v_pk_mul_f32 v[236:237], v[190:191], v[126:127]
v_pk_mul_f32 v[238:239], v[206:207], v[126:127]
v_pk_fma_f32 v[236:237], v[206:207], v[142:143], v[236:237]
v_pk_fma_f32 v[238:239], v[190:191], v[142:143], v[238:239] neg_lo:[1,0,0] neg_hi:[1,0,0]
v_cvt_pk_bf16_f32 v219, v236, v237
v_cvt_pk_bf16_f32 v227, v238, v239
v_mfma_f32_32x32x16_bf16 v[8:23], v[160:163], v[112:115], v[8:23]
v_pk_mul_f32 v[232:233], v[192:193], v[128:129]
v_pk_mul_f32 v[234:235], v[208:209], v[128:129]
v_pk_fma_f32 v[232:233], v[208:209], v[144:145], v[232:233]
v_pk_fma_f32 v[234:235], v[192:193], v[144:145], v[234:235] neg_lo:[1,0,0] neg_hi:[1,0,0]
v_cvt_pk_bf16_f32 v220, v232, v233
v_cvt_pk_bf16_f32 v228, v234, v235
v_mfma_f32_32x32x16_bf16 v[24:39], v[160:163], v[96:99], v[24:39]
v_pk_mul_f32 v[236:237], v[194:195], v[130:131]
v_pk_mul_f32 v[238:239], v[210:211], v[130:131]
v_pk_fma_f32 v[236:237], v[210:211], v[146:147], v[236:237]
v_pk_fma_f32 v[238:239], v[194:195], v[146:147], v[238:239] neg_lo:[1,0,0] neg_hi:[1,0,0]
s_add_u32 s60, s61, 7340032
buffer_load_dwordx4 v[244:247], v6, s[20:23], s60 offen
v_cvt_pk_bf16_f32 v221, v236, v237
v_cvt_pk_bf16_f32 v229, v238, v239
v_mfma_f32_32x32x16_bf16 v[8:23], v[164:167], v[116:119], v[8:23]
v_pk_mul_f32 v[232:233], v[196:197], v[132:133]
v_pk_mul_f32 v[234:235], v[212:213], v[132:133]
v_pk_fma_f32 v[232:233], v[212:213], v[148:149], v[232:233]
v_pk_fma_f32 v[234:235], v[196:197], v[148:149], v[234:235] neg_lo:[1,0,0] neg_hi:[1,0,0]
v_cvt_pk_bf16_f32 v222, v232, v233
v_cvt_pk_bf16_f32 v230, v234, v235
v_mfma_f32_32x32x16_bf16 v[24:39], v[164:167], v[100:103], v[24:39]
v_pk_mul_f32 v[236:237], v[198:199], v[134:135]
v_pk_mul_f32 v[238:239], v[214:215], v[134:135]
v_pk_fma_f32 v[236:237], v[214:215], v[150:151], v[236:237]
v_pk_fma_f32 v[238:239], v[198:199], v[150:151], v[238:239] neg_lo:[1,0,0] neg_hi:[1,0,0]
v_cvt_pk_bf16_f32 v223, v236, v237
v_cvt_pk_bf16_f32 v231, v238, v239
s_waitcnt lgkmcnt(0)
v_mfma_f32_32x32x16_bf16 v[184:199], v[176:179], v[80:83], 0
v_mfma_f32_32x32x16_bf16 v[200:215], v[176:179], v[88:91], 0
v_mfma_f32_32x32x16_bf16 v[184:199], v[180:183], v[84:87], v[184:199]
v_mfma_f32_32x32x16_bf16 v[200:215], v[180:183], v[92:95], v[200:215]
s_nop 3
v_xor_b32 v2, 32, v250
v_xor_b32 v3, 48, v250
v_cvt_pk_bf16_f32 v152, v8, v9
v_cvt_pk_bf16_f32 v153, v10, v11
v_cvt_pk_bf16_f32 v154, v12, v13
v_cvt_pk_bf16_f32 v155, v14, v15
s_add_u32 s60, s61, 7602176
buffer_load_dwordx4 v[244:247], v6, s[20:23], s60 offen
v_cvt_pk_bf16_f32 v156, v16, v17
v_cvt_pk_bf16_f32 v157, v18, v19
v_cvt_pk_bf16_f32 v158, v20, v21
v_cvt_pk_bf16_f32 v159, v22, v23
ds_write_b128 v2, v[152:155] offset:4096
ds_write_b128 v3, v[156:159] offset:4096
v_cvt_pk_bf16_f32 v160, v24, v25
v_cvt_pk_bf16_f32 v161, v26, v27
v_cvt_pk_bf16_f32 v162, v28, v29
v_cvt_pk_bf16_f32 v163, v30, v31
v_cvt_pk_bf16_f32 v164, v32, v33
v_cvt_pk_bf16_f32 v165, v34, v35
v_cvt_pk_bf16_f32 v166, v36, v37
v_cvt_pk_bf16_f32 v167, v38, v39
ds_write_b128 v2, v[160:163] offset:6144
ds_write_b128 v3, v[164:167] offset:6144
v_mfma_f32_32x32x16_bf16 v[8:23], v[216:219], v[96:99], 0
v_pk_mul_f32 v[232:233], v[184:185], v[120:121]
v_pk_mul_f32 v[234:235], v[200:201], v[120:121]
v_pk_fma_f32 v[232:233], v[200:201], v[136:137], v[232:233]
v_pk_fma_f32 v[234:235], v[184:185], v[136:137], v[234:235] neg_lo:[1,0,0] neg_hi:[1,0,0]
v_cvt_pk_bf16_f32 v152, v232, v233
v_cvt_pk_bf16_f32 v160, v234, v235
v_mfma_f32_32x32x16_bf16 v[24:39], v[216:219], v[104:107], 0
v_pk_mul_f32 v[236:237], v[186:187], v[122:123]
v_pk_mul_f32 v[238:239], v[202:203], v[122:123]
v_pk_fma_f32 v[236:237], v[202:203], v[138:139], v[236:237]
v_pk_fma_f32 v[238:239], v[186:187], v[138:139], v[238:239] neg_lo:[1,0,0] neg_hi:[1,0,0]
s_add_u32 s60, s61, 7864320
buffer_load_dwordx4 v[244:247], v6, s[20:23], s60 offen
v_cvt_pk_bf16_f32 v153, v236, v237
v_cvt_pk_bf16_f32 v161, v238, v239
v_mfma_f32_32x32x16_bf16 v[8:23], v[220:223], v[100:103], v[8:23]
v_pk_mul_f32 v[232:233], v[188:189], v[124:125]
v_pk_mul_f32 v[234:235], v[204:205], v[124:125]
v_pk_fma_f32 v[232:233], v[204:205], v[140:141], v[232:233]
v_pk_fma_f32 v[234:235], v[188:189], v[140:141], v[234:235] neg_lo:[1,0,0] neg_hi:[1,0,0]
v_cvt_pk_bf16_f32 v154, v232, v233
v_cvt_pk_bf16_f32 v162, v234, v235
v_mfma_f32_32x32x16_bf16 v[24:39], v[220:223], v[108:111], v[24:39]
v_pk_mul_f32 v[236:237], v[190:191], v[126:127]
v_pk_mul_f32 v[238:239], v[206:207], v[126:127]
v_pk_fma_f32 v[236:237], v[206:207], v[142:143], v[236:237]
v_pk_fma_f32 v[238:239], v[190:191], v[142:143], v[238:239] neg_lo:[1,0,0] neg_hi:[1,0,0]
v_cvt_pk_bf16_f32 v155, v236, v237
v_cvt_pk_bf16_f32 v163, v238, v239
v_mfma_f32_32x32x16_bf16 v[8:23], v[224:227], v[112:115], v[8:23]
v_pk_mul_f32 v[232:233], v[192:193], v[128:129]
v_pk_mul_f32 v[234:235], v[208:209], v[128:129]
v_pk_fma_f32 v[232:233], v[208:209], v[144:145], v[232:233]
v_pk_fma_f32 v[234:235], v[192:193], v[144:145], v[234:235] neg_lo:[1,0,0] neg_hi:[1,0,0]
v_cvt_pk_bf16_f32 v156, v232, v233
v_cvt_pk_bf16_f32 v164, v234, v235
v_mfma_f32_32x32x16_bf16 v[24:39], v[224:227], v[96:99], v[24:39]
v_pk_mul_f32 v[236:237], v[194:195], v[130:131]
v_pk_mul_f32 v[238:239], v[210:211], v[130:131]
v_pk_fma_f32 v[236:237], v[210:211], v[146:147], v[236:237]
s_add_u32 s60, s61, 8126464
buffer_load_dwordx4 v[244:247], v6, s[20:23], s60 offen
v_pk_fma_f32 v[238:239], v[194:195], v[146:147], v[238:239] neg_lo:[1,0,0] neg_hi:[1,0,0]
v_cvt_pk_bf16_f32 v157, v236, v237
v_cvt_pk_bf16_f32 v165, v238, v239
v_mfma_f32_32x32x16_bf16 v[8:23], v[228:231], v[116:119], v[8:23]
v_pk_mul_f32 v[232:233], v[196:197], v[132:133]
v_pk_mul_f32 v[234:235], v[212:213], v[132:133]
v_pk_fma_f32 v[232:233], v[212:213], v[148:149], v[232:233]
v_pk_fma_f32 v[234:235], v[196:197], v[148:149], v[234:235] neg_lo:[1,0,0] neg_hi:[1,0,0]
v_cvt_pk_bf16_f32 v158, v232, v233
v_cvt_pk_bf16_f32 v166, v234, v235
v_mfma_f32_32x32x16_bf16 v[24:39], v[228:231], v[100:103], v[24:39]
v_pk_mul_f32 v[236:237], v[198:199], v[134:135]
v_pk_mul_f32 v[238:239], v[214:215], v[134:135]
v_pk_fma_f32 v[236:237], v[214:215], v[150:151], v[236:237]
v_pk_fma_f32 v[238:239], v[198:199], v[150:151], v[238:239] neg_lo:[1,0,0] neg_hi:[1,0,0]
v_cvt_pk_bf16_f32 v159, v236, v237
v_cvt_pk_bf16_f32 v167, v238, v239
v_xor_b32 v2, 128, v250
v_xor_b32 v3, 144, v250
v_cvt_pk_bf16_f32 v216, v8, v9
v_cvt_pk_bf16_f32 v217, v10, v11
v_cvt_pk_bf16_f32 v218, v12, v13
v_cvt_pk_bf16_f32 v219, v14, v15
v_cvt_pk_bf16_f32 v220, v16, v17
v_cvt_pk_bf16_f32 v221, v18, v19
v_cvt_pk_bf16_f32 v222, v20, v21
v_cvt_pk_bf16_f32 v223, v22, v23
ds_write_b128 v2, v[216:219] offset:8192
v_lshlrev_b32 v245, 17, v0
buffer_load_dword v244, v245, s[28:31], 0 offen
ds_write_b128 v3, v[220:223] offset:8192
v_cvt_pk_bf16_f32 v224, v24, v25
v_cvt_pk_bf16_f32 v225, v26, v27
v_cvt_pk_bf16_f32 v226, v28, v29
v_cvt_pk_bf16_f32 v227, v30, v31
v_cvt_pk_bf16_f32 v228, v32, v33
v_cvt_pk_bf16_f32 v229, v34, v35
v_cvt_pk_bf16_f32 v230, v36, v37
v_cvt_pk_bf16_f32 v231, v38, v39
ds_write_b128 v2, v[224:227] offset:10240
ds_write_b128 v3, v[228:231] offset:10240
v_mfma_f32_32x32x16_bf16 v[8:23], v[152:155], v[96:99], 0
v_mfma_f32_32x32x16_bf16 v[24:39], v[152:155], v[104:107], 0
v_mfma_f32_32x32x16_bf16 v[8:23], v[156:159], v[100:103], v[8:23]
v_mfma_f32_32x32x16_bf16 v[24:39], v[156:159], v[108:111], v[24:39]
v_mfma_f32_32x32x16_bf16 v[8:23], v[160:163], v[112:115], v[8:23]
v_mfma_f32_32x32x16_bf16 v[24:39], v[160:163], v[96:99], v[24:39]
v_mfma_f32_32x32x16_bf16 v[8:23], v[164:167], v[116:119], v[8:23]
v_mfma_f32_32x32x16_bf16 v[24:39], v[164:167], v[100:103], v[24:39]
v_xor_b32 v2, 160, v250
v_xor_b32 v3, 176, v250
s_nop 8
v_cvt_pk_bf16_f32 v152, v8, v9
v_cvt_pk_bf16_f32 v153, v10, v11
v_cvt_pk_bf16_f32 v154, v12, v13
v_cvt_pk_bf16_f32 v155, v14, v15
v_cvt_pk_bf16_f32 v156, v16, v17
v_cvt_pk_bf16_f32 v157, v18, v19
v_cvt_pk_bf16_f32 v158, v20, v21
v_lshlrev_b32 v245, 17, v0
buffer_load_dword v244, v245, s[32:35], 0 offen
v_cvt_pk_bf16_f32 v159, v22, v23
ds_write_b128 v2, v[152:155] offset:12288
ds_write_b128 v3, v[156:159] offset:12288
v_cvt_pk_bf16_f32 v160, v24, v25
v_cvt_pk_bf16_f32 v161, v26, v27
v_cvt_pk_bf16_f32 v162, v28, v29
v_cvt_pk_bf16_f32 v163, v30, v31
v_cvt_pk_bf16_f32 v164, v32, v33
v_cvt_pk_bf16_f32 v165, v34, v35
v_cvt_pk_bf16_f32 v166, v36, v37
v_cvt_pk_bf16_f32 v167, v38, v39
ds_write_b128 v2, v[160:163] offset:14336
ds_write_b128 v3, v[164:167] offset:14336
s_waitcnt lgkmcnt(0)
s_barrier
v_add_u32 v2, 131072, v6
ds_read_b128 v[152:155], v2 offset:0
ds_read_b128 v[156:159], v2 offset:1024
ds_read_b128 v[160:163], v2 offset:2048
ds_read_b128 v[164:167], v2 offset:3072
s_lshl_b32 s53, s43, 1
s_add_u32 s53, s53, 0
s_lshl_b32 s54, s53, 3
s_and_b32 s55, s53, 3
s_xor_b32 s54, s54, s55
s_lshl_b32 s54, s54, 4
v_xor_b32 v252, s54, v251
v_xor_b32 v253, 32, v252
v_add_u32 v254, 0x10000, v252
v_add_u32 v255, 0x10000, v253
ds_read_b64_tr_b16 v[8:9], v252 offset:0
ds_read_b64_tr_b16 v[10:11], v252 offset:16384
ds_read_b64_tr_b16 v[12:13], v254 offset:0
ds_read_b64_tr_b16 v[14:15], v254 offset:16384
ds_read_b64_tr_b16 v[16:17], v252 offset:2048
ds_read_b64_tr_b16 v[18:19], v252 offset:18432
ds_read_b64_tr_b16 v[20:21], v254 offset:2048
ds_read_b64_tr_b16 v[22:23], v254 offset:18432
ds_read_b64_tr_b16 v[24:25], v253 offset:0
ds_read_b64_tr_b16 v[26:27], v253 offset:16384
ds_read_b64_tr_b16 v[28:29], v255 offset:0
ds_read_b64_tr_b16 v[30:31], v255 offset:16384
ds_read_b64_tr_b16 v[32:33], v253 offset:2048
ds_read_b64_tr_b16 v[34:35], v253 offset:18432
ds_read_b64_tr_b16 v[36:37], v255 offset:2048
ds_read_b64_tr_b16 v[38:39], v255 offset:18432
v_and_b32 v3, 31, v0
v_lshrrev_b32 v4, 5, v0
v_lshlrev_b32 v3, 2, v3
v_lshl_add_u32 v3, v4, 14, v3
s_lshl_b32 s53, s43, 8
v_add_u32 v2, s53, v3
v_add_u32 v3, 0x10000, v2
v_lshrrev_b32 v4, 3, v0
v_and_b32 v5, 7, v0
v_lshlrev_b32 v5, 4, v5
v_lshl_add_u32 v1, v4, 18, v5
v_lshl_add_u32 v5, v4, 12, v5
v_bfe_u32 v4, v0, 4, 1
v_lshl_add_u32 v5, v4, 7, v5
v_add_u32 v4, s53, v5
v_add_u32 v5, 0x10000, v4
s_waitcnt lgkmcnt(0)
v_xor_b32 v168, 0x80008000, v152
v_xor_b32 v169, 0x80008000, v153
v_xor_b32 v170, 0x80008000, v154
v_xor_b32 v171, 0x80008000, v155
v_xor_b32 v172, 0x80008000, v156
v_xor_b32 v173, 0x80008000, v157
v_xor_b32 v174, 0x80008000, v158
v_xor_b32 v175, 0x80008000, v159
v_mfma_f32_32x32x16_bf16 v[176:191], v[152:155], v[8:11], 0
v_mfma_f32_32x32x16_bf16 v[208:223], v[152:155], v[24:27], 0
v_mfma_f32_32x32x16_bf16 v[176:191], v[156:159], v[12:15], v[176:191]
v_mfma_f32_32x32x16_bf16 v[208:223], v[156:159], v[28:31], v[208:223]
v_mfma_f32_32x32x16_bf16 v[176:191], v[160:163], v[16:19], v[176:191]
v_mfma_f32_32x32x16_bf16 v[208:223], v[160:163], v[32:35], v[208:223]
v_mfma_f32_32x32x16_bf16 v[176:191], v[164:167], v[20:23], v[176:191]
v_mfma_f32_32x32x16_bf16 v[208:223], v[164:167], v[36:39], v[208:223]
s_nop 7
s_nop 3
v_mfma_f32_32x32x16_bf16 v[192:207], v[168:171], v[16:19], 0
v_cvt_pk_bf16_f32 v240, v176, v208
ds_write_b32 v2, v240 offset:0
v_cvt_pk_bf16_f32 v241, v177, v209
ds_write_b32 v2, v241 offset:4096
v_mfma_f32_32x32x16_bf16 v[224:239], v[168:171], v[32:35], 0
v_cvt_pk_bf16_f32 v242, v178, v210
ds_write_b32 v2, v242 offset:8320
v_cvt_pk_bf16_f32 v243, v179, v211
ds_write_b32 v2, v243 offset:12416
v_mfma_f32_32x32x16_bf16 v[192:207], v[172:175], v[20:23], v[192:207]
v_cvt_pk_bf16_f32 v240, v180, v212
ds_write_b32 v2, v240 offset:32768
v_cvt_pk_bf16_f32 v241, v181, v213
ds_write_b32 v2, v241 offset:36864
v_mfma_f32_32x32x16_bf16 v[224:239], v[172:175], v[36:39], v[224:239]
v_cvt_pk_bf16_f32 v242, v182, v214
ds_write_b32 v2, v242 offset:41088
v_cvt_pk_bf16_f32 v243, v183, v215
ds_write_b32 v2, v243 offset:45184
v_mfma_f32_32x32x16_bf16 v[192:207], v[160:163], v[8:11], v[192:207]
v_cvt_pk_bf16_f32 v240, v184, v216
ds_write_b32 v3, v240 offset:0
v_cvt_pk_bf16_f32 v241, v185, v217
ds_write_b32 v3, v241 offset:4096
v_mfma_f32_32x32x16_bf16 v[224:239], v[160:163], v[24:27], v[224:239]
v_cvt_pk_bf16_f32 v242, v186, v218
ds_write_b32 v3, v242 offset:8320
v_cvt_pk_bf16_f32 v243, v187, v219
ds_write_b32 v3, v243 offset:12416
v_mfma_f32_32x32x16_bf16 v[192:207], v[164:167], v[12:15], v[192:207]
v_cvt_pk_bf16_f32 v240, v188, v220
ds_write_b32 v3, v240 offset:32768
v_cvt_pk_bf16_f32 v241, v189, v221
ds_write_b32 v3, v241 offset:36864
v_mfma_f32_32x32x16_bf16 v[224:239], v[164:167], v[28:31], v[224:239]
v_cvt_pk_bf16_f32 v242, v190, v222
ds_write_b32 v3, v242 offset:41088
v_cvt_pk_bf16_f32 v243, v191, v223
ds_write_b32 v3, v243 offset:45184
s_lshl_b32 s53, s43, 1
s_add_u32 s53, s53, 1
s_lshl_b32 s54, s53, 3
s_and_b32 s55, s53, 3
s_xor_b32 s54, s54, s55
s_lshl_b32 s54, s54, 4
v_xor_b32 v252, s54, v251
v_xor_b32 v253, 32, v252
v_add_u32 v254, 0x10000, v252
v_add_u32 v255, 0x10000, v253
ds_read_b64_tr_b16 v[8:9], v252 offset:0
ds_read_b64_tr_b16 v[10:11], v252 offset:16384
ds_read_b64_tr_b16 v[12:13], v254 offset:0
ds_read_b64_tr_b16 v[14:15], v254 offset:16384
ds_read_b64_tr_b16 v[16:17], v252 offset:2048
ds_read_b64_tr_b16 v[18:19], v252 offset:18432
ds_read_b64_tr_b16 v[20:21], v254 offset:2048
ds_read_b64_tr_b16 v[22:23], v254 offset:18432
ds_read_b64_tr_b16 v[24:25], v253 offset:0
ds_read_b64_tr_b16 v[26:27], v253 offset:16384
ds_read_b64_tr_b16 v[28:29], v255 offset:0
ds_read_b64_tr_b16 v[30:31], v255 offset:16384
ds_read_b64_tr_b16 v[32:33], v253 offset:2048
ds_read_b64_tr_b16 v[34:35], v253 offset:18432
ds_read_b64_tr_b16 v[36:37], v255 offset:2048
ds_read_b64_tr_b16 v[38:39], v255 offset:18432
s_lshl_b32 s53, s43, 8
s_lshl_b32 s54, s58, 11
s_add_u32 s53, s53, s54
s_add_u32 s53, s53, 17825792
s_waitcnt lgkmcnt(0)
ds_read_b128 v[176:179], v4 offset:0
ds_read_b128 v[180:183], v4 offset:32768
ds_read_b128 v[184:187], v5 offset:0
ds_read_b128 v[188:191], v5 offset:32768
s_waitcnt lgkmcnt(3)
buffer_store_dwordx4 v[176:179], v1, s[16:19], s53 offen sc1
s_add_u32 s53, s53, 2097152
s_waitcnt lgkmcnt(2)
buffer_store_dwordx4 v[180:183], v1, s[16:19], s53 offen sc1
s_add_u32 s53, s53, 2097152
s_waitcnt lgkmcnt(1)
buffer_store_dwordx4 v[184:187], v1, s[16:19], s53 offen sc1
s_add_u32 s53, s53, 2097152
s_waitcnt lgkmcnt(0)
buffer_store_dwordx4 v[188:191], v1, s[16:19], s53 offen sc1
s_add_u32 s53, s53, 2097152
s_nop 0
v_mfma_f32_32x32x16_bf16 v[176:191], v[152:155], v[8:11], 0
v_cvt_pk_bf16_f32 v240, v192, v224
ds_write_b32 v2, v240 offset:2048
v_cvt_pk_bf16_f32 v241, v193, v225
ds_write_b32 v2, v241 offset:6144
v_mfma_f32_32x32x16_bf16 v[208:223], v[152:155], v[24:27], 0
v_cvt_pk_bf16_f32 v242, v194, v226
ds_write_b32 v2, v242 offset:10368
v_cvt_pk_bf16_f32 v243, v195, v227
ds_write_b32 v2, v243 offset:14464
v_mfma_f32_32x32x16_bf16 v[176:191], v[156:159], v[12:15], v[176:191]
v_cvt_pk_bf16_f32 v240, v196, v228
ds_write_b32 v2, v240 offset:34816
v_cvt_pk_bf16_f32 v241, v197, v229
ds_write_b32 v2, v241 offset:38912
v_mfma_f32_32x32x16_bf16 v[208:223], v[156:159], v[28:31], v[208:223]
v_cvt_pk_bf16_f32 v242, v198, v230
ds_write_b32 v2, v242 offset:43136
v_cvt_pk_bf16_f32 v243, v199, v231
ds_write_b32 v2, v243 offset:47232
v_mfma_f32_32x32x16_bf16 v[176:191], v[160:163], v[16:19], v[176:191]
v_cvt_pk_bf16_f32 v240, v200, v232
ds_write_b32 v3, v240 offset:2048
v_cvt_pk_bf16_f32 v241, v201, v233
ds_write_b32 v3, v241 offset:6144
v_mfma_f32_32x32x16_bf16 v[208:223], v[160:163], v[32:35], v[208:223]
v_cvt_pk_bf16_f32 v242, v202, v234
ds_write_b32 v3, v242 offset:10368
v_cvt_pk_bf16_f32 v243, v203, v235
ds_write_b32 v3, v243 offset:14464
v_mfma_f32_32x32x16_bf16 v[176:191], v[164:167], v[20:23], v[176:191]
v_cvt_pk_bf16_f32 v240, v204, v236
ds_write_b32 v3, v240 offset:34816
v_cvt_pk_bf16_f32 v241, v205, v237
ds_write_b32 v3, v241 offset:38912
v_mfma_f32_32x32x16_bf16 v[208:223], v[164:167], v[36:39], v[208:223]
v_cvt_pk_bf16_f32 v242, v206, v238
ds_write_b32 v3, v242 offset:43136
v_cvt_pk_bf16_f32 v243, v207, v239
ds_write_b32 v3, v243 offset:47232
s_lshl_b32 s53, s43, 8
s_lshl_b32 s54, s58, 11
s_add_u32 s53, s53, s54
s_add_u32 s53, s53, 17956864
s_waitcnt lgkmcnt(0)
ds_read_b128 v[192:195], v4 offset:2048
ds_read_b128 v[196:199], v4 offset:34816
ds_read_b128 v[200:203], v5 offset:2048
ds_read_b128 v[204:207], v5 offset:34816
s_waitcnt lgkmcnt(3)
buffer_store_dwordx4 v[192:195], v1, s[16:19], s53 offen sc1
s_add_u32 s53, s53, 2097152
s_waitcnt lgkmcnt(2)
buffer_store_dwordx4 v[196:199], v1, s[16:19], s53 offen sc1
s_add_u32 s53, s53, 2097152
s_waitcnt lgkmcnt(1)
buffer_store_dwordx4 v[200:203], v1, s[16:19], s53 offen sc1
s_add_u32 s53, s53, 2097152
s_waitcnt lgkmcnt(0)
buffer_store_dwordx4 v[204:207], v1, s[16:19], s53 offen sc1
s_add_u32 s53, s53, 2097152
s_nop 0
v_xor_b32 v4, 128, v4
v_xor_b32 v5, 128, v5
v_mfma_f32_32x32x16_bf16 v[192:207], v[168:171], v[16:19], 0
v_cvt_pk_bf16_f32 v240, v176, v208
ds_write_b32 v2, v240 offset:128
v_cvt_pk_bf16_f32 v241, v177, v209
ds_write_b32 v2, v241 offset:4224
v_mfma_f32_32x32x16_bf16 v[224:239], v[168:171], v[32:35], 0
v_cvt_pk_bf16_f32 v242, v178, v210
ds_write_b32 v2, v242 offset:8192
v_cvt_pk_bf16_f32 v243, v179, v211
ds_write_b32 v2, v243 offset:12288
v_mfma_f32_32x32x16_bf16 v[192:207], v[172:175], v[20:23], v[192:207]
v_cvt_pk_bf16_f32 v240, v180, v212
ds_write_b32 v2, v240 offset:32896
v_cvt_pk_bf16_f32 v241, v181, v213
ds_write_b32 v2, v241 offset:36992
v_mfma_f32_32x32x16_bf16 v[224:239], v[172:175], v[36:39], v[224:239]
v_cvt_pk_bf16_f32 v242, v182, v214
ds_write_b32 v2, v242 offset:40960
v_cvt_pk_bf16_f32 v243, v183, v215
ds_write_b32 v2, v243 offset:45056
v_mfma_f32_32x32x16_bf16 v[192:207], v[160:163], v[8:11], v[192:207]
v_cvt_pk_bf16_f32 v240, v184, v216
ds_write_b32 v3, v240 offset:128
v_cvt_pk_bf16_f32 v241, v185, v217
ds_write_b32 v3, v241 offset:4224
v_mfma_f32_32x32x16_bf16 v[224:239], v[160:163], v[24:27], v[224:239]
v_cvt_pk_bf16_f32 v242, v186, v218
ds_write_b32 v3, v242 offset:8192
v_cvt_pk_bf16_f32 v243, v187, v219
ds_write_b32 v3, v243 offset:12288
v_mfma_f32_32x32x16_bf16 v[192:207], v[164:167], v[12:15], v[192:207]
v_cvt_pk_bf16_f32 v240, v188, v220
ds_write_b32 v3, v240 offset:32896
v_cvt_pk_bf16_f32 v241, v189, v221
ds_write_b32 v3, v241 offset:36992
v_mfma_f32_32x32x16_bf16 v[224:239], v[164:167], v[28:31], v[224:239]
v_cvt_pk_bf16_f32 v242, v190, v222
ds_write_b32 v3, v242 offset:40960
v_cvt_pk_bf16_f32 v243, v191, v223
ds_write_b32 v3, v243 offset:45056
s_lshl_b32 s53, s43, 8
s_lshl_b32 s54, s58, 11
s_add_u32 s53, s53, s54
s_add_u32 s53, s53, 17825920
s_waitcnt lgkmcnt(0)
ds_read_b128 v[176:179], v4 offset:0
ds_read_b128 v[180:183], v4 offset:32768
ds_read_b128 v[184:187], v5 offset:0
ds_read_b128 v[188:191], v5 offset:32768
s_waitcnt lgkmcnt(3)
buffer_store_dwordx4 v[176:179], v1, s[16:19], s53 offen sc1
s_add_u32 s53, s53, 2097152
s_waitcnt lgkmcnt(2)
buffer_store_dwordx4 v[180:183], v1, s[16:19], s53 offen sc1
s_add_u32 s53, s53, 2097152
s_waitcnt lgkmcnt(1)
buffer_store_dwordx4 v[184:187], v1, s[16:19], s53 offen sc1
s_add_u32 s53, s53, 2097152
s_waitcnt lgkmcnt(0)
buffer_store_dwordx4 v[188:191], v1, s[16:19], s53 offen sc1
s_add_u32 s53, s53, 2097152
s_nop 0
v_cvt_pk_bf16_f32 v240, v192, v224
ds_write_b32 v2, v240 offset:2176
v_cvt_pk_bf16_f32 v241, v193, v225
ds_write_b32 v2, v241 offset:6272
v_cvt_pk_bf16_f32 v242, v194, v226
ds_write_b32 v2, v242 offset:10240
v_cvt_pk_bf16_f32 v243, v195, v227
ds_write_b32 v2, v243 offset:14336
v_cvt_pk_bf16_f32 v240, v196, v228
ds_write_b32 v2, v240 offset:34944
v_cvt_pk_bf16_f32 v241, v197, v229
ds_write_b32 v2, v241 offset:39040
v_cvt_pk_bf16_f32 v242, v198, v230
ds_write_b32 v2, v242 offset:43008
v_cvt_pk_bf16_f32 v243, v199, v231
ds_write_b32 v2, v243 offset:47104
v_cvt_pk_bf16_f32 v240, v200, v232
ds_write_b32 v3, v240 offset:2176
v_cvt_pk_bf16_f32 v241, v201, v233
ds_write_b32 v3, v241 offset:6272
v_cvt_pk_bf16_f32 v242, v202, v234
ds_write_b32 v3, v242 offset:10240
v_cvt_pk_bf16_f32 v243, v203, v235
ds_write_b32 v3, v243 offset:14336
v_cvt_pk_bf16_f32 v240, v204, v236
ds_write_b32 v3, v240 offset:34944
v_cvt_pk_bf16_f32 v241, v205, v237
ds_write_b32 v3, v241 offset:39040
v_cvt_pk_bf16_f32 v242, v206, v238
ds_write_b32 v3, v242 offset:43008
v_cvt_pk_bf16_f32 v243, v207, v239
ds_write_b32 v3, v243 offset:47104
s_lshl_b32 s53, s43, 8
s_lshl_b32 s54, s58, 11
s_add_u32 s53, s53, s54
s_add_u32 s53, s53, 17956992
s_waitcnt lgkmcnt(0)
ds_read_b128 v[192:195], v4 offset:2048
ds_read_b128 v[196:199], v4 offset:34816
ds_read_b128 v[200:203], v5 offset:2048
ds_read_b128 v[204:207], v5 offset:34816
s_waitcnt lgkmcnt(3)
buffer_store_dwordx4 v[192:195], v1, s[16:19], s53 offen sc1
s_add_u32 s53, s53, 2097152
s_waitcnt lgkmcnt(2)
buffer_store_dwordx4 v[196:199], v1, s[16:19], s53 offen sc1
s_add_u32 s53, s53, 2097152
s_waitcnt lgkmcnt(1)
buffer_store_dwordx4 v[200:203], v1, s[16:19], s53 offen sc1
s_add_u32 s53, s53, 2097152
s_waitcnt lgkmcnt(0)
buffer_store_dwordx4 v[204:207], v1, s[16:19], s53 offen sc1
s_add_u32 s53, s53, 2097152
s_nop 0
L_fdone:
s_load_dwordx2 s[36:37], s[0:1], 96
s_mov_b32 s38, 256
s_waitcnt lgkmcnt(0)
buffer_load_dword v2, off, s[36:39], 0 sc1
s_mov_b32 s68, 200000
s_waitcnt vmcnt(0)
L_ng_19:
    v_readfirstlane_b32 s48, v2
s_nop 1
    s_cmp_lg_u32 s48, 0
    s_cbranch_scc1 L_ngd_20
    s_sub_u32 s68, s68, 1
    s_cbranch_scc1 L_ngd_20
    s_sleep 2
buffer_load_dword v2, off, s[36:39], 0 sc1
s_waitcnt vmcnt(0)
s_branch L_ng_19
L_ngd_20:

    s_waitcnt vmcnt(0) lgkmcnt(0)
    s_barrier
    s_cmp_eq_u32 s43, 0
    s_cbranch_scc0 L_fnf
    s_lshl_b32 s53, s49, 7
    s_add_u32 s53, s53, 28508160
    s_mov_b64 exec, 1
    buffer_store_dword v2, off, s[16:19], s53 sc1
    s_mov_b64 exec, -1
L_fnf:
s_add_u32 s60, s61, 0
buffer_load_dwordx4 v[244:247], v6, s[24:27], s60 offen
s_add_u32 s60, s61, 262144
buffer_load_dwordx4 v[244:247], v6, s[24:27], s60 offen
s_add_u32 s60, s61, 524288
buffer_load_dwordx4 v[244:247], v6, s[24:27], s60 offen
s_add_u32 s60, s61, 786432
buffer_load_dwordx4 v[244:247], v6, s[24:27], s60 offen
s_add_u32 s60, s61, 1048576
buffer_load_dwordx4 v[244:247], v6, s[24:27], s60 offen
s_add_u32 s60, s61, 1310720
buffer_load_dwordx4 v[244:247], v6, s[24:27], s60 offen
s_add_u32 s60, s61, 1572864
buffer_load_dwordx4 v[244:247], v6, s[24:27], s60 offen
s_add_u32 s60, s61, 1835008
buffer_load_dwordx4 v[244:247], v6, s[24:27], s60 offen
s_add_u32 s60, s61, 2097152
buffer_load_dwordx4 v[244:247], v6, s[24:27], s60 offen
s_add_u32 s60, s61, 2359296
buffer_load_dwordx4 v[244:247], v6, s[24:27], s60 offen
s_add_u32 s60, s61, 2621440
buffer_load_dwordx4 v[244:247], v6, s[24:27], s60 offen
s_add_u32 s60, s61, 2883584
buffer_load_dwordx4 v[244:247], v6, s[24:27], s60 offen
s_add_u32 s60, s61, 3145728
buffer_load_dwordx4 v[244:247], v6, s[24:27], s60 offen
s_add_u32 s60, s61, 3407872
buffer_load_dwordx4 v[244:247], v6, s[24:27], s60 offen
s_load_dwordx2 s[32:33], s[0:1], 88
s_waitcnt lgkmcnt(0)
v_and_b32 v2, 31, v0
v_lshlrev_b32 v2, 7, v2
s_mov_b32 s58, 28508160
s_mov_b32 s68, 200000
L_poll_21:
buffer_load_dword v3, v2, s[16:19], s58 offen sc1
s_sub_u32 s68, s68, 1
s_cbranch_scc1 L_polld_22
s_waitcnt vmcnt(0)
v_cmp_ne_u32 vcc, s48, v3
s_nop 1
s_cmp_eq_u64 vcc, 0
s_cbranch_scc1 L_polld_22
s_sleep 2
s_branch L_poll_21
L_polld_22:
s_waitcnt vmcnt(0)
s_mov_b32 s51, 0
s_cmp_ge_u32 s43, 4
s_cbranch_scc1 L_f_loader
s_and_b32 s44, s43, 1
s_lshr_b32 s45, s43, 1
s_mov_b32 s34, 4194304

    v_lshlrev_b32 v238, 4, v0
    v_and_b32 v2, 15, v0
    v_lshrrev_b32 v3, 4, v0
    v_lshrrev_b32 v4, 2, v2
    v_and_b32 v5, 3, v0
    v_lshl_add_u32 v6, v3, 2, v4
    v_lshrrev_b32 v7, 1, v6
    v_and_b32 v7, 3, v7
    v_lshlrev_b32 v7, 1, v7
    v_lshrrev_b32 v4, 1, v5
    v_xor_b32 v7, v7, v4
    s_lshl_b32 s53, s45, 2
    v_xor_b32 v7, s53, v7
    v_lshlrev_b32 v6, 7, v6
    v_and_b32 v5, 1, v5
    v_lshl_add_u32 v6, v5, 3, v6
    s_lshl_b32 s53, s44, 13
    s_add_u32 s53, s53, 16384
    v_add_u32 v6, s53, v6
    v_lshl_add_u32 v239, v7, 4, v6
    v_xor_b32 v7, 2, v7
    v_lshl_add_u32 v240, v7, 4, v6
v_mov_b64 v[200:201], 0
v_mov_b64 v[202:203], 0
v_mov_b64 v[204:205], 0
v_mov_b64 v[206:207], 0
v_mov_b64 v[208:209], 0
v_mov_b64 v[210:211], 0
v_mov_b64 v[212:213], 0
v_mov_b64 v[214:215], 0
v_mov_b64 v[216:217], 0
v_mov_b64 v[218:219], 0
v_mov_b64 v[220:221], 0
v_mov_b64 v[222:223], 0
v_mov_b64 v[224:225], 0
v_mov_b64 v[226:227], 0
v_mov_b64 v[228:229], 0
v_mov_b64 v[230:231], 0
s_setprio 2
s_branch L_s4_entry
L_f_loader:
s_sub_u32 s46, s43, 4
s_load_dwordx2 s[28:29], s[0:1], 8
s_load_dwordx2 s[32:33], s[0:1], 16
s_mov_b32 s30, 8388608
s_mov_b32 s34, 8388608
s_bfe_u32 s100, s2, 0x10002
s_lshl_b32 s100, s100, 1
s_add_u32 s100, s100, s2
s_and_b32 s100, s100, 3
s_mul_i32 s100, s100, 7

    s_mul_i32 s53, s40, 458752
    s_lshl_b32 s54, s46, 12
    s_add_u32 s53, s53, s54
    v_lshl_add_u32 v26, v0, 4, s53
    v_and_b32 v3, 7, v0
    v_lshrrev_b32 v4, 4, v0
    v_lshlrev_b32 v4, 1, v4
    v_xor_b32 v3, v3, v4
    v_lshlrev_b32 v3, 4, v3
    s_lshl_b32 s53, s47, 7
    v_add_u32 v3, s53, v3
    v_lshrrev_b32 v2, 3, v0
    s_lshl_b32 s53, s46, 4
    v_add_u32 v4, s53, v2
    v_lshl_add_u32 v27, v4, 11, v3
    v_add_u32 v28, 15360, v27
    v_lshrrev_b32 v4, 5, v0
    v_and_b32 v2, 3, v2
    v_lshl_add_u32 v2, v4, 3, v2
    s_lshr_b32 s53, s46, 1
    s_lshl_b32 s53, s53, 5
    s_and_b32 s54, s46, 1
    s_lshl_b32 s54, s54, 2
    s_add_u32 s53, s53, s54
    s_lshl_b32 s54, s40, 8
    s_add_u32 s53, s53, s54
    v_add_u32 v2, s53, v2
    v_lshl_add_u32 v31, v2, 11, v3
    v_add_u32 v32, 31744, v31
    v_add_u32 v33, 262144, v31
    v_add_u32 v34, 293888, v31
    v_and_b32 v2, 15, v0
    s_lshl_b32 s53, s46, 4
    v_add_u32 v2, s53, v2
    v_lshlrev_b32 v2, 17, v2
    v_lshrrev_b32 v4, 4, v0
    v_lshl_add_u32 v29, v4, 4, v2
    v_add_u32 v30, 64, v29
s_lshl_b32 s63, s46, 12
s_lshl_b32 s64, s46, 11
s_add_u32 s64, s64, 16384
s_waitcnt lgkmcnt(0)
v_mov_b32 v4, 135168
v_mov_b64 v[6:7], 0
s_cmp_eq_u32 s46, 0
s_cbranch_scc0 9f
ds_write_b64 v4, v[6:7]
s_waitcnt lgkmcnt(0)
9:
s_and_b32 s54, s46, 1
s_lshl_b32 s57, s40, 1
s_add_u32 s57, s57, s54
s_lshl_b32 s57, s57, 2
s_add_u32 s57, s57, 26214400
s_lshl_b32 s54, s54, 8
s_add_u32 m0, s54, 134656
v_lshlrev_b32 v2, 7, v0
buffer_load_dword v2, s[16:19], s57 offen sc1 lds
s_lshl_b32 s53, s46, 10
s_add_u32 s61, s51, s53
s_add_u32 s62, s51, s64
s_mov_b32 s60, 17825792
s_add_u32 m0, s61, 0
s_nop 0
buffer_load_dwordx4 v29, s[28:31], 0 offen lds
s_add_u32 m0, s61, 8192
s_nop 0
buffer_load_dwordx4 v30, s[28:31], 0 offen lds
s_add_u32 m0, s62, 0
s_nop 0
buffer_load_dwordx4 v31, s[16:19], s60 offen sc1 lds
buffer_load_dwordx4 v32, s[16:19], s60 offen offset:1024 sc1 lds
s_add_u32 m0, s62, 8192
s_nop 0
buffer_load_dwordx4 v33, s[16:19], s60 offen sc1 lds
buffer_load_dwordx4 v34, s[16:19], s60 offen offset:1024 sc1 lds
s_add_u32 s51, s51, 32768
s_and_b32 s51, s51, 131071
s_lshl_b32 s53, s46, 10
s_add_u32 s61, s51, s53
s_add_u32 s62, s51, s64
s_mov_b32 s60, 17956864
s_add_u32 m0, s61, 0
s_nop 0
buffer_load_dwordx4 v29, s[32:35], 0 offen lds
s_add_u32 m0, s61, 8192
s_nop 0
buffer_load_dwordx4 v30, s[32:35], 0 offen lds
s_add_u32 m0, s62, 0
s_nop 0
buffer_load_dwordx4 v31, s[16:19], s60 offen sc1 lds
buffer_load_dwordx4 v32, s[16:19], s60 offen offset:1024 sc1 lds
s_add_u32 m0, s62, 8192
s_nop 0
buffer_load_dwordx4 v33, s[16:19], s60 offen sc1 lds
buffer_load_dwordx4 v34, s[16:19], s60 offen offset:1024 sc1 lds
s_add_u32 s51, s51, 32768
s_and_b32 s51, s51, 131071
s_branch L_l4_entry
L_end:
s_endpgm
.section .rodata,"a"
.p2align 6
.amdhsa_kernel gated_mix__spectral_fnet__mixer_gmlp__prompt_kernel
  .amdhsa_next_free_vgpr 256
  .amdhsa_next_free_sgpr 102
  .amdhsa_accum_offset 256
  .amdhsa_group_segment_fixed_size 0
  .amdhsa_kernarg_size 112
  .amdhsa_user_sgpr_count 2
  .amdhsa_user_sgpr_kernarg_segment_ptr 1
  .amdhsa_system_sgpr_workgroup_id_x 1
  .amdhsa_float_denorm_mode_32 3
.end_amdhsa_kernel
```
